```python
import torch

def _softmax(x, axis=-1):
    return torch.softmax(x, dim=axis)

def _gelu(x):
    return torch.nn.functional.gelu(x, approximate='tanh')

def _silu(x):
    return torch.nn.functional.silu(x)

def _sigmoid(x):
    return torch.sigmoid(x)

def _layernorm(x, axis=-1, eps=1e-05):
    m = x.mean(dim=axis, keepdim=True)
    v = x.var(dim=axis, keepdim=True, unbiased=False)
    return (x - m) / torch.sqrt(v + eps)

def _scatter_add(tgt, idx, src, axis=0):
    return tgt.clone().index_add_(axis, idx, src)

def _segment_sum(src, seg, n):
    out = torch.zeros((n,) + src.shape[1:], dtype=src.dtype)
    return out.index_add_(0, seg, src)

def _pad(x, pw):
    flat = tuple((v for pair in reversed(pw) for v in pair))
    return torch.nn.functional.pad(x, flat)
kernel_name = 'adaLN_cond__mha_block__dense_activation_silu__prompt'

def setup_inputs():

    _w = lambda a: (lambda t: t.to(torch.bfloat16) if t.is_floating_point() else t)(torch.as_tensor(a))

    def _A_setup():
        B, S, D, H = (1, 2048, 576, 32)
        return {'x': _w((lambda *s: torch.randn(*s, dtype=torch.bfloat16) * 0.05)(B, S, D)), 'wqkv': _w((lambda *s: torch.randn(*s, dtype=torch.bfloat16) * 0.05)(D, 3 * D)), 'wo': _w((lambda *s: torch.randn(*s, dtype=torch.bfloat16) * 0.05)(D, D))}
    _A_in = _A_setup()

    def _B_setup():
        B, S, D, F = (1, 2048, 576, 4608)
        return {'x': _w((lambda *s: torch.randn(*s, dtype=torch.bfloat16) * 0.05)(B, S, D)), 'w1': _w((lambda *s: torch.randn(*s, dtype=torch.bfloat16) * 3.2)(D, F) * D ** (-0.5)), 'w2': _w((lambda *s: torch.randn(*s, dtype=torch.bfloat16) * 0.4)(F, D) * F ** (-0.5))}
    _B_in = _B_setup()
    return {'A_x': _A_in['x'], 'A_wqkv': _A_in['wqkv'], 'A_wo': _A_in['wo'], 'B_x': _B_in['x'], 'B_w1': _B_in['w1'], 'B_w2': _B_in['w2'], 'c': _w((lambda *s: torch.randn(*s, dtype=torch.bfloat16) * 0.1)(1, 576) * 8.0), 'w_mod': _w((lambda *s: torch.randn(*s, dtype=torch.bfloat16) * 0.1)(576, 6 * 576) * 576 ** (-0.5) * 8.0)}

def reference(A_x, A_wqkv, A_wo, B_x, B_w1, B_w2, c, w_mod):

    def _A_ref(x, wqkv, wo):
        B, S, D = x.shape
        H = 32
        Dh = D // H
        qkv = (lambda x, *d: x.permute(*d))((x @ wqkv).reshape(B, S, 3, H, Dh), 2, 0, 3, 1, 4)
        q, k, v = (qkv[0], qkv[1], qkv[2])
        scores = torch.einsum('bhqd,bhkd->bhqk', q, k) * Dh ** (-0.5)
        p = _softmax(scores, axis=-1)
        o = torch.einsum('bhqk,bhkd->bhqd', p, v)
        return (lambda x, *d: x.permute(*d))(o, 0, 2, 1, 3).reshape(B, S, D) @ wo

    def _B_ref(x, w1, w2):
        h = torch.einsum('bsd,df->bsf', x, w1)
        h = _silu(h)
        out = torch.einsum('bsf,fd->bsd', h, w2)
        return out
    x = A_x
    mod = (_silu(c) @ w_mod).reshape(c.shape[0], 6, 1, -1)
    sa, ca, ga, sb, cb, gb = (mod[:, 0].clone(), mod[:, 1].clone(), mod[:, 2].clone(), mod[:, 3].clone(), mod[:, 4].clone(), mod[:, 5].clone())
    h = _layernorm(x, axis=-1) * (1 + ca) + sa
    x = x + ga * _A_ref(h, A_wqkv, A_wo)
    h = _layernorm(x, axis=-1) * (1 + cb) + sb
    x = x + gb * _B_ref(h, B_w1, B_w2)
    return x
```

```asm
; @launch kernel=k1_kernel grid=(326,1,1) block=(256,1,1) lds=12288
; @launch kernel=k2_kernel grid=(256,1,1) block=(512,1,1) lds=120832
; @launch kernel=k3_kernel grid=(256,1,1) block=(512,1,1) lds=163840
; @launch kernel=k45_kernel grid=(256,1,1) block=(768,1,1) lds=163840
.amdgcn_target "amdgcn-amd-amdhsa--gfx950"
.text
.globl k1_kernel
.p2align 8
.type k1_kernel,@function
k1_kernel:
    s_load_dwordx2 s[4:5], s[0:1], 80
    v_lshrrev_b32 v1, 6, v0
    s_nop 0
    v_readfirstlane_b32 s3, v1
    s_cmp_ge_u32 s2, 326
    s_cbranch_scc1 L_end_3
    s_cmp_ge_u32 s2, 164
    s_cbranch_scc1 L_swz_2
    s_cmp_ge_u32 s2, 36
    s_cbranch_scc1 L_ln_1
    s_load_dwordx2 s[6:7], s[0:1], 56
    s_load_dwordx2 s[16:17], s[0:1], 48
    s_waitcnt lgkmcnt(0)
    s_mov_b32 s8, s6
    s_and_b32 s9, s7, 0xffff
    s_mov_b32 s10, 3981312
    s_mov_b32 s11, 0x20000
    s_mov_b32 s12, s16
    s_and_b32 s13, s17, 0xffff
    s_mov_b32 s14, 1152
    s_mov_b32 s15, 0x20000
    s_add_u32 s20, s4, 0
    s_addc_u32 s21, s5, 0
    s_and_b32 s21, s21, 0xffff
    s_mov_b32 s22, 55296
    s_mov_b32 s23, 0x20000
    s_and_b32 s24, s2, 3
    s_lshr_b32 s25, s2, 2
    v_and_b32 v1, 63, v0
    v_and_b32 v2, 15, v1
    v_lshrrev_b32 v3, 4, v1
    s_mul_i32 s26, s24, 144
    s_mul_i32 s27, s3, 36
    s_add_u32 s26, s26, s27
    v_add_u32 v4, s26, v3
    v_lshlrev_b32 v5, 1, v4
    v_mul_u32_u24 v6, 6912, v4
    v_lshl_add_u32 v6, v2, 4, v6
    s_lshl_b32 s27, s25, 8
    v_add_u32 v6, s27, v6
    buffer_load_ushort v10, v5, s[12:15], 0 offen offset:0
    buffer_load_ushort v11, v5, s[12:15], 0 offen offset:8
    buffer_load_ushort v12, v5, s[12:15], 0 offen offset:16
    buffer_load_ushort v13, v5, s[12:15], 0 offen offset:24
    buffer_load_ushort v14, v5, s[12:15], 0 offen offset:32
    buffer_load_ushort v15, v5, s[12:15], 0 offen offset:40
    buffer_load_ushort v16, v5, s[12:15], 0 offen offset:48
    buffer_load_ushort v17, v5, s[12:15], 0 offen offset:56
    buffer_load_ushort v18, v5, s[12:15], 0 offen offset:64
    s_mov_b32 s28, 0
    buffer_load_dwordx4 v[20:23], v6, s[8:11], s28 offen
    s_add_u32 s28, s28, 27648
    buffer_load_dwordx4 v[24:27], v6, s[8:11], s28 offen
    s_add_u32 s28, s28, 27648
    buffer_load_dwordx4 v[28:31], v6, s[8:11], s28 offen
    s_add_u32 s28, s28, 27648
    buffer_load_dwordx4 v[32:35], v6, s[8:11], s28 offen
    s_add_u32 s28, s28, 27648
    buffer_load_dwordx4 v[36:39], v6, s[8:11], s28 offen
    s_add_u32 s28, s28, 27648
    buffer_load_dwordx4 v[40:43], v6, s[8:11], s28 offen
    s_add_u32 s28, s28, 27648
    buffer_load_dwordx4 v[44:47], v6, s[8:11], s28 offen
    s_add_u32 s28, s28, 27648
    buffer_load_dwordx4 v[48:51], v6, s[8:11], s28 offen
    s_add_u32 s28, s28, 27648
    buffer_load_dwordx4 v[52:55], v6, s[8:11], s28 offen
    s_add_u32 s28, s28, 27648
    s_waitcnt vmcnt(9)
    s_mov_b32 s29, 0xbfb8aa3b
    v_lshlrev_b32 v10, 16, v10
    v_mul_f32 v60, s29, v10
    v_exp_f32 v60, v60
    s_nop 0
    v_add_f32 v60, 1.0, v60
    v_rcp_f32 v60, v60
    s_nop 0
    v_mul_f32 v10, v10, v60
    v_cvt_pk_bf16_f32 v10, v10, v10
    v_and_b32 v10, 0xffff0000, v10
    v_lshlrev_b32 v11, 16, v11
    v_mul_f32 v60, s29, v11
    v_exp_f32 v60, v60
    s_nop 0
    v_add_f32 v60, 1.0, v60
    v_rcp_f32 v60, v60
    s_nop 0
    v_mul_f32 v11, v11, v60
    v_cvt_pk_bf16_f32 v11, v11, v11
    v_and_b32 v11, 0xffff0000, v11
    v_lshlrev_b32 v12, 16, v12
    v_mul_f32 v60, s29, v12
    v_exp_f32 v60, v60
    s_nop 0
    v_add_f32 v60, 1.0, v60
    v_rcp_f32 v60, v60
    s_nop 0
    v_mul_f32 v12, v12, v60
    v_cvt_pk_bf16_f32 v12, v12, v12
    v_and_b32 v12, 0xffff0000, v12
    v_lshlrev_b32 v13, 16, v13
    v_mul_f32 v60, s29, v13
    v_exp_f32 v60, v60
    s_nop 0
    v_add_f32 v60, 1.0, v60
    v_rcp_f32 v60, v60
    s_nop 0
    v_mul_f32 v13, v13, v60
    v_cvt_pk_bf16_f32 v13, v13, v13
    v_and_b32 v13, 0xffff0000, v13
    v_lshlrev_b32 v14, 16, v14
    v_mul_f32 v60, s29, v14
    v_exp_f32 v60, v60
    s_nop 0
    v_add_f32 v60, 1.0, v60
    v_rcp_f32 v60, v60
    s_nop 0
    v_mul_f32 v14, v14, v60
    v_cvt_pk_bf16_f32 v14, v14, v14
    v_and_b32 v14, 0xffff0000, v14
    v_lshlrev_b32 v15, 16, v15
    v_mul_f32 v60, s29, v15
    v_exp_f32 v60, v60
    s_nop 0
    v_add_f32 v60, 1.0, v60
    v_rcp_f32 v60, v60
    s_nop 0
    v_mul_f32 v15, v15, v60
    v_cvt_pk_bf16_f32 v15, v15, v15
    v_and_b32 v15, 0xffff0000, v15
    v_lshlrev_b32 v16, 16, v16
    v_mul_f32 v60, s29, v16
    v_exp_f32 v60, v60
    s_nop 0
    v_add_f32 v60, 1.0, v60
    v_rcp_f32 v60, v60
    s_nop 0
    v_mul_f32 v16, v16, v60
    v_cvt_pk_bf16_f32 v16, v16, v16
    v_and_b32 v16, 0xffff0000, v16
    v_lshlrev_b32 v17, 16, v17
    v_mul_f32 v60, s29, v17
    v_exp_f32 v60, v60
    s_nop 0
    v_add_f32 v60, 1.0, v60
    v_rcp_f32 v60, v60
    s_nop 0
    v_mul_f32 v17, v17, v60
    v_cvt_pk_bf16_f32 v17, v17, v17
    v_and_b32 v17, 0xffff0000, v17
    v_lshlrev_b32 v18, 16, v18
    v_mul_f32 v60, s29, v18
    v_exp_f32 v60, v60
    s_nop 0
    v_add_f32 v60, 1.0, v60
    v_rcp_f32 v60, v60
    s_nop 0
    v_mul_f32 v18, v18, v60
    v_cvt_pk_bf16_f32 v18, v18, v18
    v_and_b32 v18, 0xffff0000, v18
    v_mov_b32 v64, 0
    v_mov_b32 v65, 0
    v_mov_b32 v66, 0
    v_mov_b32 v67, 0
    v_mov_b32 v68, 0
    v_mov_b32 v69, 0
    v_mov_b32 v70, 0
    v_mov_b32 v71, 0
    s_waitcnt vmcnt(8)
    v_lshlrev_b32 v60, 16, v20
    v_and_b32 v61, 0xffff0000, v20
    v_fmac_f32 v64, v10, v60
    v_fmac_f32 v65, v10, v61
    v_lshlrev_b32 v60, 16, v21
    v_and_b32 v61, 0xffff0000, v21
    v_fmac_f32 v66, v10, v60
    v_fmac_f32 v67, v10, v61
    v_lshlrev_b32 v60, 16, v22
    v_and_b32 v61, 0xffff0000, v22
    v_fmac_f32 v68, v10, v60
    v_fmac_f32 v69, v10, v61
    v_lshlrev_b32 v60, 16, v23
    v_and_b32 v61, 0xffff0000, v23
    v_fmac_f32 v70, v10, v60
    v_fmac_f32 v71, v10, v61
    s_waitcnt vmcnt(7)
    v_lshlrev_b32 v60, 16, v24
    v_and_b32 v61, 0xffff0000, v24
    v_fmac_f32 v64, v11, v60
    v_fmac_f32 v65, v11, v61
    v_lshlrev_b32 v60, 16, v25
    v_and_b32 v61, 0xffff0000, v25
    v_fmac_f32 v66, v11, v60
    v_fmac_f32 v67, v11, v61
    v_lshlrev_b32 v60, 16, v26
    v_and_b32 v61, 0xffff0000, v26
    v_fmac_f32 v68, v11, v60
    v_fmac_f32 v69, v11, v61
    v_lshlrev_b32 v60, 16, v27
    v_and_b32 v61, 0xffff0000, v27
    v_fmac_f32 v70, v11, v60
    v_fmac_f32 v71, v11, v61
    s_waitcnt vmcnt(6)
    v_lshlrev_b32 v60, 16, v28
    v_and_b32 v61, 0xffff0000, v28
    v_fmac_f32 v64, v12, v60
    v_fmac_f32 v65, v12, v61
    v_lshlrev_b32 v60, 16, v29
    v_and_b32 v61, 0xffff0000, v29
    v_fmac_f32 v66, v12, v60
    v_fmac_f32 v67, v12, v61
    v_lshlrev_b32 v60, 16, v30
    v_and_b32 v61, 0xffff0000, v30
    v_fmac_f32 v68, v12, v60
    v_fmac_f32 v69, v12, v61
    v_lshlrev_b32 v60, 16, v31
    v_and_b32 v61, 0xffff0000, v31
    v_fmac_f32 v70, v12, v60
    v_fmac_f32 v71, v12, v61
    s_waitcnt vmcnt(5)
    v_lshlrev_b32 v60, 16, v32
    v_and_b32 v61, 0xffff0000, v32
    v_fmac_f32 v64, v13, v60
    v_fmac_f32 v65, v13, v61
    v_lshlrev_b32 v60, 16, v33
    v_and_b32 v61, 0xffff0000, v33
    v_fmac_f32 v66, v13, v60
    v_fmac_f32 v67, v13, v61
    v_lshlrev_b32 v60, 16, v34
    v_and_b32 v61, 0xffff0000, v34
    v_fmac_f32 v68, v13, v60
    v_fmac_f32 v69, v13, v61
    v_lshlrev_b32 v60, 16, v35
    v_and_b32 v61, 0xffff0000, v35
    v_fmac_f32 v70, v13, v60
    v_fmac_f32 v71, v13, v61
    s_waitcnt vmcnt(4)
    v_lshlrev_b32 v60, 16, v36
    v_and_b32 v61, 0xffff0000, v36
    v_fmac_f32 v64, v14, v60
    v_fmac_f32 v65, v14, v61
    v_lshlrev_b32 v60, 16, v37
    v_and_b32 v61, 0xffff0000, v37
    v_fmac_f32 v66, v14, v60
    v_fmac_f32 v67, v14, v61
    v_lshlrev_b32 v60, 16, v38
    v_and_b32 v61, 0xffff0000, v38
    v_fmac_f32 v68, v14, v60
    v_fmac_f32 v69, v14, v61
    v_lshlrev_b32 v60, 16, v39
    v_and_b32 v61, 0xffff0000, v39
    v_fmac_f32 v70, v14, v60
    v_fmac_f32 v71, v14, v61
    s_waitcnt vmcnt(3)
    v_lshlrev_b32 v60, 16, v40
    v_and_b32 v61, 0xffff0000, v40
    v_fmac_f32 v64, v15, v60
    v_fmac_f32 v65, v15, v61
    v_lshlrev_b32 v60, 16, v41
    v_and_b32 v61, 0xffff0000, v41
    v_fmac_f32 v66, v15, v60
    v_fmac_f32 v67, v15, v61
    v_lshlrev_b32 v60, 16, v42
    v_and_b32 v61, 0xffff0000, v42
    v_fmac_f32 v68, v15, v60
    v_fmac_f32 v69, v15, v61
    v_lshlrev_b32 v60, 16, v43
    v_and_b32 v61, 0xffff0000, v43
    v_fmac_f32 v70, v15, v60
    v_fmac_f32 v71, v15, v61
    s_waitcnt vmcnt(2)
    v_lshlrev_b32 v60, 16, v44
    v_and_b32 v61, 0xffff0000, v44
    v_fmac_f32 v64, v16, v60
    v_fmac_f32 v65, v16, v61
    v_lshlrev_b32 v60, 16, v45
    v_and_b32 v61, 0xffff0000, v45
    v_fmac_f32 v66, v16, v60
    v_fmac_f32 v67, v16, v61
    v_lshlrev_b32 v60, 16, v46
    v_and_b32 v61, 0xffff0000, v46
    v_fmac_f32 v68, v16, v60
    v_fmac_f32 v69, v16, v61
    v_lshlrev_b32 v60, 16, v47
    v_and_b32 v61, 0xffff0000, v47
    v_fmac_f32 v70, v16, v60
    v_fmac_f32 v71, v16, v61
    s_waitcnt vmcnt(1)
    v_lshlrev_b32 v60, 16, v48
    v_and_b32 v61, 0xffff0000, v48
    v_fmac_f32 v64, v17, v60
    v_fmac_f32 v65, v17, v61
    v_lshlrev_b32 v60, 16, v49
    v_and_b32 v61, 0xffff0000, v49
    v_fmac_f32 v66, v17, v60
    v_fmac_f32 v67, v17, v61
    v_lshlrev_b32 v60, 16, v50
    v_and_b32 v61, 0xffff0000, v50
    v_fmac_f32 v68, v17, v60
    v_fmac_f32 v69, v17, v61
    v_lshlrev_b32 v60, 16, v51
    v_and_b32 v61, 0xffff0000, v51
    v_fmac_f32 v70, v17, v60
    v_fmac_f32 v71, v17, v61
    s_waitcnt vmcnt(0)
    v_lshlrev_b32 v60, 16, v52
    v_and_b32 v61, 0xffff0000, v52
    v_fmac_f32 v64, v18, v60
    v_fmac_f32 v65, v18, v61
    v_lshlrev_b32 v60, 16, v53
    v_and_b32 v61, 0xffff0000, v53
    v_fmac_f32 v66, v18, v60
    v_fmac_f32 v67, v18, v61
    v_lshlrev_b32 v60, 16, v54
    v_and_b32 v61, 0xffff0000, v54
    v_fmac_f32 v68, v18, v60
    v_fmac_f32 v69, v18, v61
    v_lshlrev_b32 v60, 16, v55
    v_and_b32 v61, 0xffff0000, v55
    v_fmac_f32 v70, v18, v60
    v_fmac_f32 v71, v18, v61
    s_lshl_b32 s27, s3, 2
    v_add_u32 v7, s27, v3
    v_lshlrev_b32 v7, 9, v7
    v_lshl_add_u32 v7, v2, 5, v7
    ds_write_b128 v7, v[64:67]
    ds_write_b128 v7, v[68:71] offset:16
    s_waitcnt lgkmcnt(0)
    s_barrier
    s_cmp_ge_u32 s3, 2
    s_cbranch_scc1 L_end_3
    v_lshlrev_b32 v8, 2, v0
    ds_read_b32 v20, v8 offset:0
    ds_read_b32 v21, v8 offset:512
    ds_read_b32 v22, v8 offset:1024
    ds_read_b32 v23, v8 offset:1536
    ds_read_b32 v24, v8 offset:2048
    ds_read_b32 v25, v8 offset:2560
    ds_read_b32 v26, v8 offset:3072
    ds_read_b32 v27, v8 offset:3584
    ds_read_b32 v28, v8 offset:4096
    ds_read_b32 v29, v8 offset:4608
    ds_read_b32 v30, v8 offset:5120
    ds_read_b32 v31, v8 offset:5632
    ds_read_b32 v32, v8 offset:6144
    ds_read_b32 v33, v8 offset:6656
    ds_read_b32 v34, v8 offset:7168
    ds_read_b32 v35, v8 offset:7680
    s_waitcnt lgkmcnt(0)
    v_add_f32 v20, v20, v21
    v_add_f32 v20, v20, v22
    v_add_f32 v20, v20, v23
    v_add_f32 v20, v20, v24
    v_add_f32 v20, v20, v25
    v_add_f32 v20, v20, v26
    v_add_f32 v20, v20, v27
    v_add_f32 v20, v20, v28
    v_add_f32 v20, v20, v29
    v_add_f32 v20, v20, v30
    v_add_f32 v20, v20, v31
    v_add_f32 v20, v20, v32
    v_add_f32 v20, v20, v33
    v_add_f32 v20, v20, v34
    v_add_f32 v20, v20, v35
    s_mul_i32 s27, s24, 13824
    s_lshl_b32 s28, s25, 9
    s_add_u32 s27, s27, s28
    buffer_store_dword v20, v8, s[20:23], s27 offen
    s_branch L_end_3
L_ln_1:
    s_load_dwordx2 s[6:7], s[0:1], 0
    s_load_dwordx2 s[32:33], s[0:1], 72
    s_waitcnt lgkmcnt(0)
    s_mov_b32 s8, s6
    s_and_b32 s9, s7, 0xffff
    s_mov_b32 s10, 2359296
    s_mov_b32 s11, 0x20000
    s_add_u32 s12, s4, 57344
    s_addc_u32 s13, s5, 0
    s_and_b32 s13, s13, 0xffff
    s_mov_b32 s14, 2359296
    s_mov_b32 s15, 0x20000
    s_sub_u32 s24, s2, 36
    v_and_b32 v1, 63, v0
    v_and_b32 v2, 15, v1
    v_lshrrev_b32 v3, 4, v1
    s_lshl_b32 s25, s24, 4
    v_add_u32 v4, s25, v2
    v_mul_u32_u24 v4, 1152, v4
    v_lshl_add_u32 v4, v3, 4, v4
    s_lshl_b32 s25, s3, 6
    v_add_u32 v4, s25, v4
    s_lshl_b32 s25, s3, 2
    v_lshlrev_b32 v5, 4, v2
    v_add3_u32 v5, v5, s25, v3
    v_lshlrev_b32 v5, 2, v5
    v_lshlrev_b32 v6, 6, v2
    s_mul_i32 s26, s24, 18
    s_add_u32 s26, s26, s3
    s_lshl_b32 s26, s26, 10
    v_lshlrev_b32 v7, 4, v1
    s_cmp_lt_u32 s3, 2
    s_cbranch_scc1 L_ln5_4
    buffer_load_dwordx4 v[16:19], v4, s[8:11], 0 offen offset:0
    buffer_load_dwordx4 v[20:23], v4, s[8:11], 0 offen offset:256
    buffer_load_dwordx4 v[24:27], v4, s[8:11], 0 offen offset:512
    buffer_load_dwordx4 v[28:31], v4, s[8:11], 0 offen offset:768
    s_waitcnt vmcnt(3)
    v_lshlrev_b32 v40, 16, v16
    v_and_b32 v41, 0xffff0000, v16
    v_lshlrev_b32 v42, 16, v17
    v_and_b32 v43, 0xffff0000, v17
    v_lshlrev_b32 v44, 16, v18
    v_and_b32 v45, 0xffff0000, v18
    v_lshlrev_b32 v46, 16, v19
    v_and_b32 v47, 0xffff0000, v19
    s_waitcnt vmcnt(2)
    v_lshlrev_b32 v48, 16, v20
    v_and_b32 v49, 0xffff0000, v20
    v_lshlrev_b32 v50, 16, v21
    v_and_b32 v51, 0xffff0000, v21
    v_lshlrev_b32 v52, 16, v22
    v_and_b32 v53, 0xffff0000, v22
    v_lshlrev_b32 v54, 16, v23
    v_and_b32 v55, 0xffff0000, v23
    s_waitcnt vmcnt(1)
    v_lshlrev_b32 v56, 16, v24
    v_and_b32 v57, 0xffff0000, v24
    v_lshlrev_b32 v58, 16, v25
    v_and_b32 v59, 0xffff0000, v25
    v_lshlrev_b32 v60, 16, v26
    v_and_b32 v61, 0xffff0000, v26
    v_lshlrev_b32 v62, 16, v27
    v_and_b32 v63, 0xffff0000, v27
    s_waitcnt vmcnt(0)
    v_lshlrev_b32 v64, 16, v28
    v_and_b32 v65, 0xffff0000, v28
    v_lshlrev_b32 v66, 16, v29
    v_and_b32 v67, 0xffff0000, v29
    v_lshlrev_b32 v68, 16, v30
    v_and_b32 v69, 0xffff0000, v30
    v_lshlrev_b32 v70, 16, v31
    v_and_b32 v71, 0xffff0000, v31
    v_add_f32 v8, v40, v41
    v_add_f32 v8, v8, v42
    v_add_f32 v8, v8, v43
    v_add_f32 v8, v8, v44
    v_add_f32 v8, v8, v45
    v_add_f32 v8, v8, v46
    v_add_f32 v8, v8, v47
    v_add_f32 v8, v8, v48
    v_add_f32 v8, v8, v49
    v_add_f32 v8, v8, v50
    v_add_f32 v8, v8, v51
    v_add_f32 v8, v8, v52
    v_add_f32 v8, v8, v53
    v_add_f32 v8, v8, v54
    v_add_f32 v8, v8, v55
    v_add_f32 v8, v8, v56
    v_add_f32 v8, v8, v57
    v_add_f32 v8, v8, v58
    v_add_f32 v8, v8, v59
    v_add_f32 v8, v8, v60
    v_add_f32 v8, v8, v61
    v_add_f32 v8, v8, v62
    v_add_f32 v8, v8, v63
    v_add_f32 v8, v8, v64
    v_add_f32 v8, v8, v65
    v_add_f32 v8, v8, v66
    v_add_f32 v8, v8, v67
    v_add_f32 v8, v8, v68
    v_add_f32 v8, v8, v69
    v_add_f32 v8, v8, v70
    v_add_f32 v8, v8, v71
    ds_write_b32 v5, v8 offset:0
    s_waitcnt lgkmcnt(0)
    s_barrier
    ds_read_b128 v[84:87], v6 offset:0
    ds_read_b128 v[88:91], v6 offset:16
    ds_read_b128 v[92:95], v6 offset:32
    ds_read_b128 v[96:99], v6 offset:48
    s_waitcnt lgkmcnt(0)
    v_add_f32 v8, v84, v85
    v_add_f32 v8, v8, v86
    v_add_f32 v8, v8, v87
    v_add_f32 v8, v8, v88
    v_add_f32 v8, v8, v89
    v_add_f32 v8, v8, v90
    v_add_f32 v8, v8, v91
    v_add_f32 v8, v8, v92
    v_add_f32 v8, v8, v93
    v_add_f32 v8, v8, v94
    v_add_f32 v8, v8, v95
    v_add_f32 v8, v8, v96
    v_add_f32 v8, v8, v97
    v_add_f32 v8, v8, v98
    v_add_f32 v8, v8, v99
    s_mov_b32 s27, 0x3ae38e39
    v_mul_f32 v9, s27, v8
    v_sub_f32 v40, v40, v9
    v_sub_f32 v41, v41, v9
    v_sub_f32 v42, v42, v9
    v_sub_f32 v43, v43, v9
    v_sub_f32 v44, v44, v9
    v_sub_f32 v45, v45, v9
    v_sub_f32 v46, v46, v9
    v_sub_f32 v47, v47, v9
    v_sub_f32 v48, v48, v9
    v_sub_f32 v49, v49, v9
    v_sub_f32 v50, v50, v9
    v_sub_f32 v51, v51, v9
    v_sub_f32 v52, v52, v9
    v_sub_f32 v53, v53, v9
    v_sub_f32 v54, v54, v9
    v_sub_f32 v55, v55, v9
    v_sub_f32 v56, v56, v9
    v_sub_f32 v57, v57, v9
    v_sub_f32 v58, v58, v9
    v_sub_f32 v59, v59, v9
    v_sub_f32 v60, v60, v9
    v_sub_f32 v61, v61, v9
    v_sub_f32 v62, v62, v9
    v_sub_f32 v63, v63, v9
    v_sub_f32 v64, v64, v9
    v_sub_f32 v65, v65, v9
    v_sub_f32 v66, v66, v9
    v_sub_f32 v67, v67, v9
    v_sub_f32 v68, v68, v9
    v_sub_f32 v69, v69, v9
    v_sub_f32 v70, v70, v9
    v_sub_f32 v71, v71, v9
    v_mul_f32 v8, v40, v40
    v_fmac_f32 v8, v41, v41
    v_fmac_f32 v8, v42, v42
    v_fmac_f32 v8, v43, v43
    v_fmac_f32 v8, v44, v44
    v_fmac_f32 v8, v45, v45
    v_fmac_f32 v8, v46, v46
    v_fmac_f32 v8, v47, v47
    v_fmac_f32 v8, v48, v48
    v_fmac_f32 v8, v49, v49
    v_fmac_f32 v8, v50, v50
    v_fmac_f32 v8, v51, v51
    v_fmac_f32 v8, v52, v52
    v_fmac_f32 v8, v53, v53
    v_fmac_f32 v8, v54, v54
    v_fmac_f32 v8, v55, v55
    v_fmac_f32 v8, v56, v56
    v_fmac_f32 v8, v57, v57
    v_fmac_f32 v8, v58, v58
    v_fmac_f32 v8, v59, v59
    v_fmac_f32 v8, v60, v60
    v_fmac_f32 v8, v61, v61
    v_fmac_f32 v8, v62, v62
    v_fmac_f32 v8, v63, v63
    v_fmac_f32 v8, v64, v64
    v_fmac_f32 v8, v65, v65
    v_fmac_f32 v8, v66, v66
    v_fmac_f32 v8, v67, v67
    v_fmac_f32 v8, v68, v68
    v_fmac_f32 v8, v69, v69
    v_fmac_f32 v8, v70, v70
    v_fmac_f32 v8, v71, v71
    ds_write_b32 v5, v8 offset:1024
    s_waitcnt lgkmcnt(0)
    s_barrier
    ds_read_b128 v[84:87], v6 offset:1024
    ds_read_b128 v[88:91], v6 offset:1040
    ds_read_b128 v[92:95], v6 offset:1056
    ds_read_b128 v[96:99], v6 offset:1072
    s_waitcnt lgkmcnt(0)
    v_add_f32 v8, v84, v85
    v_add_f32 v8, v8, v86
    v_add_f32 v8, v8, v87
    v_add_f32 v8, v8, v88
    v_add_f32 v8, v8, v89
    v_add_f32 v8, v8, v90
    v_add_f32 v8, v8, v91
    v_add_f32 v8, v8, v92
    v_add_f32 v8, v8, v93
    v_add_f32 v8, v8, v94
    v_add_f32 v8, v8, v95
    v_add_f32 v8, v8, v96
    v_add_f32 v8, v8, v97
    v_add_f32 v8, v8, v98
    v_add_f32 v8, v8, v99
    v_mov_b32 v10, 0x3727c5ac
    v_fmac_f32 v10, s27, v8
    v_rsq_f32 v10, v10
    s_nop 0
    v_mul_f32 v40, v40, v10
    v_mul_f32 v41, v41, v10
    v_mul_f32 v42, v42, v10
    v_mul_f32 v43, v43, v10
    v_mul_f32 v44, v44, v10
    v_mul_f32 v45, v45, v10
    v_mul_f32 v46, v46, v10
    v_mul_f32 v47, v47, v10
    v_mul_f32 v48, v48, v10
    v_mul_f32 v49, v49, v10
    v_mul_f32 v50, v50, v10
    v_mul_f32 v51, v51, v10
    v_mul_f32 v52, v52, v10
    v_mul_f32 v53, v53, v10
    v_mul_f32 v54, v54, v10
    v_mul_f32 v55, v55, v10
    v_mul_f32 v56, v56, v10
    v_mul_f32 v57, v57, v10
    v_mul_f32 v58, v58, v10
    v_mul_f32 v59, v59, v10
    v_mul_f32 v60, v60, v10
    v_mul_f32 v61, v61, v10
    v_mul_f32 v62, v62, v10
    v_mul_f32 v63, v63, v10
    v_mul_f32 v64, v64, v10
    v_mul_f32 v65, v65, v10
    v_mul_f32 v66, v66, v10
    v_mul_f32 v67, v67, v10
    v_mul_f32 v68, v68, v10
    v_mul_f32 v69, v69, v10
    v_mul_f32 v70, v70, v10
    v_mul_f32 v71, v71, v10
    v_cvt_pk_bf16_f32 v16, v40, v41
    v_cvt_pk_bf16_f32 v17, v42, v43
    v_cvt_pk_bf16_f32 v18, v44, v45
    v_cvt_pk_bf16_f32 v19, v46, v47
    s_add_u32 s28, s26, 0
    buffer_store_dwordx4 v[16:19], v7, s[12:15], s28 offen
    v_cvt_pk_bf16_f32 v20, v48, v49
    v_cvt_pk_bf16_f32 v21, v50, v51
    v_cvt_pk_bf16_f32 v22, v52, v53
    v_cvt_pk_bf16_f32 v23, v54, v55
    s_add_u32 s28, s26, 4096
    buffer_store_dwordx4 v[20:23], v7, s[12:15], s28 offen
    v_cvt_pk_bf16_f32 v24, v56, v57
    v_cvt_pk_bf16_f32 v25, v58, v59
    v_cvt_pk_bf16_f32 v26, v60, v61
    v_cvt_pk_bf16_f32 v27, v62, v63
    s_add_u32 s28, s26, 8192
    buffer_store_dwordx4 v[24:27], v7, s[12:15], s28 offen
    v_cvt_pk_bf16_f32 v28, v64, v65
    v_cvt_pk_bf16_f32 v29, v66, v67
    v_cvt_pk_bf16_f32 v30, v68, v69
    v_cvt_pk_bf16_f32 v31, v70, v71
    s_add_u32 s28, s26, 12288
    buffer_store_dwordx4 v[28:31], v7, s[12:15], s28 offen
    s_branch L_end_3
L_ln5_4:
    buffer_load_dwordx4 v[16:19], v4, s[8:11], 0 offen offset:0
    buffer_load_dwordx4 v[20:23], v4, s[8:11], 0 offen offset:256
    buffer_load_dwordx4 v[24:27], v4, s[8:11], 0 offen offset:512
    buffer_load_dwordx4 v[28:31], v4, s[8:11], 0 offen offset:768
    buffer_load_dwordx4 v[32:35], v4, s[8:11], 0 offen offset:1024
    s_waitcnt vmcnt(4)
    v_lshlrev_b32 v40, 16, v16
    v_and_b32 v41, 0xffff0000, v16
    v_lshlrev_b32 v42, 16, v17
    v_and_b32 v43, 0xffff0000, v17
    v_lshlrev_b32 v44, 16, v18
    v_and_b32 v45, 0xffff0000, v18
    v_lshlrev_b32 v46, 16, v19
    v_and_b32 v47, 0xffff0000, v19
    s_waitcnt vmcnt(3)
    v_lshlrev_b32 v48, 16, v20
    v_and_b32 v49, 0xffff0000, v20
    v_lshlrev_b32 v50, 16, v21
    v_and_b32 v51, 0xffff0000, v21
    v_lshlrev_b32 v52, 16, v22
    v_and_b32 v53, 0xffff0000, v22
    v_lshlrev_b32 v54, 16, v23
    v_and_b32 v55, 0xffff0000, v23
    s_waitcnt vmcnt(2)
    v_lshlrev_b32 v56, 16, v24
    v_and_b32 v57, 0xffff0000, v24
    v_lshlrev_b32 v58, 16, v25
    v_and_b32 v59, 0xffff0000, v25
    v_lshlrev_b32 v60, 16, v26
    v_and_b32 v61, 0xffff0000, v26
    v_lshlrev_b32 v62, 16, v27
    v_and_b32 v63, 0xffff0000, v27
    s_waitcnt vmcnt(1)
    v_lshlrev_b32 v64, 16, v28
    v_and_b32 v65, 0xffff0000, v28
    v_lshlrev_b32 v66, 16, v29
    v_and_b32 v67, 0xffff0000, v29
    v_lshlrev_b32 v68, 16, v30
    v_and_b32 v69, 0xffff0000, v30
    v_lshlrev_b32 v70, 16, v31
    v_and_b32 v71, 0xffff0000, v31
    s_waitcnt vmcnt(0)
    v_lshlrev_b32 v72, 16, v32
    v_and_b32 v73, 0xffff0000, v32
    v_lshlrev_b32 v74, 16, v33
    v_and_b32 v75, 0xffff0000, v33
    v_lshlrev_b32 v76, 16, v34
    v_and_b32 v77, 0xffff0000, v34
    v_lshlrev_b32 v78, 16, v35
    v_and_b32 v79, 0xffff0000, v35
    v_add_f32 v8, v40, v41
    v_add_f32 v8, v8, v42
    v_add_f32 v8, v8, v43
    v_add_f32 v8, v8, v44
    v_add_f32 v8, v8, v45
    v_add_f32 v8, v8, v46
    v_add_f32 v8, v8, v47
    v_add_f32 v8, v8, v48
    v_add_f32 v8, v8, v49
    v_add_f32 v8, v8, v50
    v_add_f32 v8, v8, v51
    v_add_f32 v8, v8, v52
    v_add_f32 v8, v8, v53
    v_add_f32 v8, v8, v54
    v_add_f32 v8, v8, v55
    v_add_f32 v8, v8, v56
    v_add_f32 v8, v8, v57
    v_add_f32 v8, v8, v58
    v_add_f32 v8, v8, v59
    v_add_f32 v8, v8, v60
    v_add_f32 v8, v8, v61
    v_add_f32 v8, v8, v62
    v_add_f32 v8, v8, v63
    v_add_f32 v8, v8, v64
    v_add_f32 v8, v8, v65
    v_add_f32 v8, v8, v66
    v_add_f32 v8, v8, v67
    v_add_f32 v8, v8, v68
    v_add_f32 v8, v8, v69
    v_add_f32 v8, v8, v70
    v_add_f32 v8, v8, v71
    v_add_f32 v8, v8, v72
    v_add_f32 v8, v8, v73
    v_add_f32 v8, v8, v74
    v_add_f32 v8, v8, v75
    v_add_f32 v8, v8, v76
    v_add_f32 v8, v8, v77
    v_add_f32 v8, v8, v78
    v_add_f32 v8, v8, v79
    ds_write_b32 v5, v8 offset:0
    s_waitcnt lgkmcnt(0)
    s_barrier
    ds_read_b128 v[84:87], v6 offset:0
    ds_read_b128 v[88:91], v6 offset:16
    ds_read_b128 v[92:95], v6 offset:32
    ds_read_b128 v[96:99], v6 offset:48
    s_waitcnt lgkmcnt(0)
    v_add_f32 v8, v84, v85
    v_add_f32 v8, v8, v86
    v_add_f32 v8, v8, v87
    v_add_f32 v8, v8, v88
    v_add_f32 v8, v8, v89
    v_add_f32 v8, v8, v90
    v_add_f32 v8, v8, v91
    v_add_f32 v8, v8, v92
    v_add_f32 v8, v8, v93
    v_add_f32 v8, v8, v94
    v_add_f32 v8, v8, v95
    v_add_f32 v8, v8, v96
    v_add_f32 v8, v8, v97
    v_add_f32 v8, v8, v98
    v_add_f32 v8, v8, v99
    s_mov_b32 s27, 0x3ae38e39
    v_mul_f32 v9, s27, v8
    v_sub_f32 v40, v40, v9
    v_sub_f32 v41, v41, v9
    v_sub_f32 v42, v42, v9
    v_sub_f32 v43, v43, v9
    v_sub_f32 v44, v44, v9
    v_sub_f32 v45, v45, v9
    v_sub_f32 v46, v46, v9
    v_sub_f32 v47, v47, v9
    v_sub_f32 v48, v48, v9
    v_sub_f32 v49, v49, v9
    v_sub_f32 v50, v50, v9
    v_sub_f32 v51, v51, v9
    v_sub_f32 v52, v52, v9
    v_sub_f32 v53, v53, v9
    v_sub_f32 v54, v54, v9
    v_sub_f32 v55, v55, v9
    v_sub_f32 v56, v56, v9
    v_sub_f32 v57, v57, v9
    v_sub_f32 v58, v58, v9
    v_sub_f32 v59, v59, v9
    v_sub_f32 v60, v60, v9
    v_sub_f32 v61, v61, v9
    v_sub_f32 v62, v62, v9
    v_sub_f32 v63, v63, v9
    v_sub_f32 v64, v64, v9
    v_sub_f32 v65, v65, v9
    v_sub_f32 v66, v66, v9
    v_sub_f32 v67, v67, v9
    v_sub_f32 v68, v68, v9
    v_sub_f32 v69, v69, v9
    v_sub_f32 v70, v70, v9
    v_sub_f32 v71, v71, v9
    v_sub_f32 v72, v72, v9
    v_sub_f32 v73, v73, v9
    v_sub_f32 v74, v74, v9
    v_sub_f32 v75, v75, v9
    v_sub_f32 v76, v76, v9
    v_sub_f32 v77, v77, v9
    v_sub_f32 v78, v78, v9
    v_sub_f32 v79, v79, v9
    v_mul_f32 v8, v40, v40
    v_fmac_f32 v8, v41, v41
    v_fmac_f32 v8, v42, v42
    v_fmac_f32 v8, v43, v43
    v_fmac_f32 v8, v44, v44
    v_fmac_f32 v8, v45, v45
    v_fmac_f32 v8, v46, v46
    v_fmac_f32 v8, v47, v47
    v_fmac_f32 v8, v48, v48
    v_fmac_f32 v8, v49, v49
    v_fmac_f32 v8, v50, v50
    v_fmac_f32 v8, v51, v51
    v_fmac_f32 v8, v52, v52
    v_fmac_f32 v8, v53, v53
    v_fmac_f32 v8, v54, v54
    v_fmac_f32 v8, v55, v55
    v_fmac_f32 v8, v56, v56
    v_fmac_f32 v8, v57, v57
    v_fmac_f32 v8, v58, v58
    v_fmac_f32 v8, v59, v59
    v_fmac_f32 v8, v60, v60
    v_fmac_f32 v8, v61, v61
    v_fmac_f32 v8, v62, v62
    v_fmac_f32 v8, v63, v63
    v_fmac_f32 v8, v64, v64
    v_fmac_f32 v8, v65, v65
    v_fmac_f32 v8, v66, v66
    v_fmac_f32 v8, v67, v67
    v_fmac_f32 v8, v68, v68
    v_fmac_f32 v8, v69, v69
    v_fmac_f32 v8, v70, v70
    v_fmac_f32 v8, v71, v71
    v_fmac_f32 v8, v72, v72
    v_fmac_f32 v8, v73, v73
    v_fmac_f32 v8, v74, v74
    v_fmac_f32 v8, v75, v75
    v_fmac_f32 v8, v76, v76
    v_fmac_f32 v8, v77, v77
    v_fmac_f32 v8, v78, v78
    v_fmac_f32 v8, v79, v79
    ds_write_b32 v5, v8 offset:1024
    s_waitcnt lgkmcnt(0)
    s_barrier
    ds_read_b128 v[84:87], v6 offset:1024
    ds_read_b128 v[88:91], v6 offset:1040
    ds_read_b128 v[92:95], v6 offset:1056
    ds_read_b128 v[96:99], v6 offset:1072
    s_waitcnt lgkmcnt(0)
    v_add_f32 v8, v84, v85
    v_add_f32 v8, v8, v86
    v_add_f32 v8, v8, v87
    v_add_f32 v8, v8, v88
    v_add_f32 v8, v8, v89
    v_add_f32 v8, v8, v90
    v_add_f32 v8, v8, v91
    v_add_f32 v8, v8, v92
    v_add_f32 v8, v8, v93
    v_add_f32 v8, v8, v94
    v_add_f32 v8, v8, v95
    v_add_f32 v8, v8, v96
    v_add_f32 v8, v8, v97
    v_add_f32 v8, v8, v98
    v_add_f32 v8, v8, v99
    v_mov_b32 v10, 0x3727c5ac
    v_fmac_f32 v10, s27, v8
    v_rsq_f32 v10, v10
    s_nop 0
    v_mul_f32 v40, v40, v10
    v_mul_f32 v41, v41, v10
    v_mul_f32 v42, v42, v10
    v_mul_f32 v43, v43, v10
    v_mul_f32 v44, v44, v10
    v_mul_f32 v45, v45, v10
    v_mul_f32 v46, v46, v10
    v_mul_f32 v47, v47, v10
    v_mul_f32 v48, v48, v10
    v_mul_f32 v49, v49, v10
    v_mul_f32 v50, v50, v10
    v_mul_f32 v51, v51, v10
    v_mul_f32 v52, v52, v10
    v_mul_f32 v53, v53, v10
    v_mul_f32 v54, v54, v10
    v_mul_f32 v55, v55, v10
    v_mul_f32 v56, v56, v10
    v_mul_f32 v57, v57, v10
    v_mul_f32 v58, v58, v10
    v_mul_f32 v59, v59, v10
    v_mul_f32 v60, v60, v10
    v_mul_f32 v61, v61, v10
    v_mul_f32 v62, v62, v10
    v_mul_f32 v63, v63, v10
    v_mul_f32 v64, v64, v10
    v_mul_f32 v65, v65, v10
    v_mul_f32 v66, v66, v10
    v_mul_f32 v67, v67, v10
    v_mul_f32 v68, v68, v10
    v_mul_f32 v69, v69, v10
    v_mul_f32 v70, v70, v10
    v_mul_f32 v71, v71, v10
    v_mul_f32 v72, v72, v10
    v_mul_f32 v73, v73, v10
    v_mul_f32 v74, v74, v10
    v_mul_f32 v75, v75, v10
    v_mul_f32 v76, v76, v10
    v_mul_f32 v77, v77, v10
    v_mul_f32 v78, v78, v10
    v_mul_f32 v79, v79, v10
    v_cvt_pk_bf16_f32 v16, v40, v41
    v_cvt_pk_bf16_f32 v17, v42, v43
    v_cvt_pk_bf16_f32 v18, v44, v45
    v_cvt_pk_bf16_f32 v19, v46, v47
    s_add_u32 s28, s26, 0
    buffer_store_dwordx4 v[16:19], v7, s[12:15], s28 offen
    v_cvt_pk_bf16_f32 v20, v48, v49
    v_cvt_pk_bf16_f32 v21, v50, v51
    v_cvt_pk_bf16_f32 v22, v52, v53
    v_cvt_pk_bf16_f32 v23, v54, v55
    s_add_u32 s28, s26, 4096
    buffer_store_dwordx4 v[20:23], v7, s[12:15], s28 offen
    v_cvt_pk_bf16_f32 v24, v56, v57
    v_cvt_pk_bf16_f32 v25, v58, v59
    v_cvt_pk_bf16_f32 v26, v60, v61
    v_cvt_pk_bf16_f32 v27, v62, v63
    s_add_u32 s28, s26, 8192
    buffer_store_dwordx4 v[24:27], v7, s[12:15], s28 offen
    v_cvt_pk_bf16_f32 v28, v64, v65
    v_cvt_pk_bf16_f32 v29, v66, v67
    v_cvt_pk_bf16_f32 v30, v68, v69
    v_cvt_pk_bf16_f32 v31, v70, v71
    s_add_u32 s28, s26, 12288
    buffer_store_dwordx4 v[28:31], v7, s[12:15], s28 offen
    v_cvt_pk_bf16_f32 v32, v72, v73
    v_cvt_pk_bf16_f32 v33, v74, v75
    v_cvt_pk_bf16_f32 v34, v76, v77
    v_cvt_pk_bf16_f32 v35, v78, v79
    s_add_u32 s28, s26, 16384
    buffer_store_dwordx4 v[32:35], v7, s[12:15], s28 offen
    s_branch L_end_3
L_swz_2:
    s_sub_u32 s18, s2, 164
    s_lshl_b32 s18, s18, 2
    s_add_u32 s18, s18, s3
    s_waitcnt lgkmcnt(0)
    s_cmp_ge_u32 s18, 648
    s_cbranch_scc1 L_swt_5
    v_and_b32 v1, 63, v0
    v_and_b32 v2, 15, v1
    v_lshrrev_b32 v3, 4, v1
    v_lshlrev_b32 v4, 4, v1
    s_cmp_ge_u32 s18, 648
    s_cbranch_scc1 L_swz_next_7
    s_sub_u32 s20, s18, 0
    s_load_dwordx2 s[6:7], s[0:1], 8
    s_waitcnt lgkmcnt(0)
    s_mov_b32 s8, s6
    s_and_b32 s9, s7, 0xffff
    s_mov_b32 s10, 1990656
    s_mov_b32 s11, 0x20000
    s_add_u32 s12, s4, 2416640
    s_addc_u32 s13, s5, 0
    s_and_b32 s13, s13, 0xffff
    s_mov_b32 s14, 1990656
    s_mov_b32 s15, 0x20000
    s_mul_i32 s21, s20, 3072
    s_mul_hi_u32 s22, s20, 1431655766
    s_mul_i32 s32, s22, 3
    s_sub_u32 s23, s20, s32
    s_mul_hi_u32 s37, s22, 238609295
    s_mul_i32 s32, s37, 18
    s_sub_u32 s38, s22, s32
    s_mul_i32 s33, s37, 288
    s_mul_i32 s34, s38, 110592
    s_add_u32 s33, s33, s34
    s_mov_b32 s36, 27648
    v_mul_lo_u32 v7, s36, v3
    v_add_u32 v7, s33, v7
    s_mul_i32 s34, s23, 108
    v_lshl_add_u32 v5, v2, 1, v7
    v_add_u32 v5, s34, v5
    v_lshrrev_b32 v8, 1, v2
    v_mul_u32_u24 v8, 36, v8
    v_and_b32 v9, 1, v2
    v_lshl_add_u32 v8, v9, 1, v8
    v_add_u32 v8, 32, v8
    v_add_u32 v8, v8, v7
    v_add_u32 v6, 72, v5
    s_cmp_eq_u32 s23, 2
    s_cselect_b64 vcc, -1, 0
    v_cndmask_b32 v6, v6, v8, vcc
    s_mov_b32 s24, 0
    s_mov_b32 s25, 3456
    s_mov_b32 s26, 6912
    s_mov_b32 s27, 10368
    s_mov_b32 s28, 13824
    s_mov_b32 s29, 17280
    s_mov_b32 s30, 20736
    s_mov_b32 s31, 24192
    buffer_load_ushort v16, v5, s[8:11], s24 offen offset:0
    buffer_load_ushort v17, v5, s[8:11], s25 offen offset:0
    buffer_load_ushort v18, v5, s[8:11], s26 offen offset:0
    buffer_load_ushort v19, v5, s[8:11], s27 offen offset:0
    buffer_load_ushort v20, v5, s[8:11], s28 offen offset:0
    buffer_load_ushort v21, v5, s[8:11], s29 offen offset:0
    buffer_load_ushort v22, v5, s[8:11], s30 offen offset:0
    buffer_load_ushort v23, v5, s[8:11], s31 offen offset:0
    buffer_load_ushort v24, v5, s[8:11], s24 offen offset:36
    buffer_load_ushort v25, v5, s[8:11], s25 offen offset:36
    buffer_load_ushort v26, v5, s[8:11], s26 offen offset:36
    buffer_load_ushort v27, v5, s[8:11], s27 offen offset:36
    buffer_load_ushort v28, v5, s[8:11], s28 offen offset:36
    buffer_load_ushort v29, v5, s[8:11], s29 offen offset:36
    buffer_load_ushort v30, v5, s[8:11], s30 offen offset:36
    buffer_load_ushort v31, v5, s[8:11], s31 offen offset:36
    buffer_load_ushort v32, v6, s[8:11], s24 offen offset:0
    buffer_load_ushort v33, v6, s[8:11], s25 offen offset:0
    buffer_load_ushort v34, v6, s[8:11], s26 offen offset:0
    buffer_load_ushort v35, v6, s[8:11], s27 offen offset:0
    buffer_load_ushort v36, v6, s[8:11], s28 offen offset:0
    buffer_load_ushort v37, v6, s[8:11], s29 offen offset:0
    buffer_load_ushort v38, v6, s[8:11], s30 offen offset:0
    buffer_load_ushort v39, v6, s[8:11], s31 offen offset:0
    s_waitcnt vmcnt(16)
    v_lshl_or_b32 v40, v17, 16, v16
    v_lshl_or_b32 v41, v19, 16, v18
    v_lshl_or_b32 v42, v21, 16, v20
    v_lshl_or_b32 v43, v23, 16, v22
    buffer_store_dwordx4 v[40:43], v4, s[12:15], s21 offen offset:0
    s_waitcnt vmcnt(9)
    v_lshl_or_b32 v44, v25, 16, v24
    v_lshl_or_b32 v45, v27, 16, v26
    v_lshl_or_b32 v46, v29, 16, v28
    v_lshl_or_b32 v47, v31, 16, v30
    buffer_store_dwordx4 v[44:47], v4, s[12:15], s21 offen offset:1024
    s_waitcnt vmcnt(2)
    v_lshl_or_b32 v48, v33, 16, v32
    v_lshl_or_b32 v49, v35, 16, v34
    v_lshl_or_b32 v50, v37, 16, v36
    v_lshl_or_b32 v51, v39, 16, v38
    buffer_store_dwordx4 v[48:51], v4, s[12:15], s21 offen offset:2048
    s_branch L_swz_end_6
L_swz_next_7:
L_swz_end_6:
    s_branch L_end_3
L_swt_5:
    s_sub_u32 s18, s18, 648
    s_mul_i32 s19, s3, 3072
    v_and_b32 v11, 63, v0
    v_add_u32 v12, 0, v11
    v_mul_u32_u24 v13, 10923, v12
    v_lshrrev_b32 v4, 16, v13
    v_mul_u32_u24 v13, 6, v4
    v_sub_u32 v13, v12, v13
    v_lshlrev_b32 v7, 4, v13
    v_add_u32 v12, 64, v11
    v_mul_u32_u24 v13, 10923, v12
    v_lshrrev_b32 v5, 16, v13
    v_mul_u32_u24 v13, 6, v5
    v_sub_u32 v13, v12, v13
    v_lshlrev_b32 v8, 4, v13
    v_add_u32 v12, 128, v11
    v_mul_u32_u24 v13, 10923, v12
    v_lshrrev_b32 v6, 16, v13
    v_mul_u32_u24 v13, 6, v6
    v_sub_u32 v13, v12, v13
    v_lshlrev_b32 v9, 4, v13
    v_lshrrev_b32 v12, 4, v11
    v_lshlrev_b32 v12, 3, v12
    v_bfe_u32 v13, v11, 2, 2
    v_add_u32 v12, v12, v13
    v_mul_u32_u24 v12, 96, v12
    v_and_b32 v13, 3, v11
    v_lshl_add_u32 v10, v13, 3, v12
    v_lshlrev_b32 v11, 4, v11
    v_add_u32 v10, s19, v10
L_end_3:
    s_endpgm
.section .rodata,"a"
.p2align 6
.amdhsa_kernel k1_kernel
.amdhsa_next_free_vgpr 104
.amdhsa_next_free_sgpr 102
.amdhsa_accum_offset 104
.amdhsa_group_segment_fixed_size 0
.amdhsa_kernarg_size 88
.amdhsa_user_sgpr_count 2
.amdhsa_user_sgpr_kernarg_segment_ptr 1
.amdhsa_system_sgpr_workgroup_id_x 1
.end_amdhsa_kernel
.text
.globl k2_kernel
.p2align 8
.type k2_kernel,@function
k2_kernel:
    s_cmp_ge_u32 s2, 256
    s_cbranch_scc1 L_end_8
    s_load_dwordx2 s[4:5], s[0:1], 80
    s_cmp_ge_u32 s2, 192
    s_cbranch_scc1 L_modr_9
    v_lshrrev_b32 v1, 6, v0
    v_and_b32 v2, 63, v0
    v_readfirstlane_b32 s3, v1
    v_lshlrev_b32 v3, 4, v2
    s_and_b32 s6, s2, 3
    s_lshl_b32 s6, s6, 2
    s_bfe_u32 s7, s2, 0x20003
    s_add_u32 s6, s6, s7
    s_bfe_u32 s20, s2, 0x10002
    s_mul_i32 s20, s20, 6
    s_lshr_b32 s21, s2, 5
    s_mov_b32 s28, s7
    s_add_u32 s7, s20, s21
    s_add_u32 s21, s21, s3
    s_and_b32 s21, s21, 7
    s_lshl_b32 s6, s6, 3
    s_add_u32 s6, s6, s21
    s_lshl_b32 s28, s28, 1
    s_add_u32 s28, s28, s3
    s_and_b32 s28, s28, 7
    s_waitcnt lgkmcnt(0)
    s_add_u32 s8, s4, 0
    s_addc_u32 s9, s5, 0
    s_and_b32 s9, s9, 0xffff
    s_mov_b32 s10, 55296
    s_mov_b32 s11, 0x20000
    s_add_u32 s12, s4, 57344
    s_addc_u32 s13, s5, 0
    s_and_b32 s13, s13, 0xffff
    s_mov_b32 s14, 2359296
    s_mov_b32 s15, 0x20000
    s_add_u32 s16, s4, 2416640
    s_addc_u32 s17, s5, 0
    s_and_b32 s17, s17, 0xffff
    s_mov_b32 s18, 1990656
    s_mov_b32 s19, 0x20000
    v_lshlrev_b32 v4, 4, v0
    s_mov_b32 s20, 0
    buffer_load_dwordx4 v[196:199], v4, s[8:11], s20 offen
    s_mov_b32 s20, 13824
    buffer_load_dwordx4 v[200:203], v4, s[8:11], s20 offen
    s_mov_b32 s20, 27648
    buffer_load_dwordx4 v[204:207], v4, s[8:11], s20 offen
    s_mov_b32 s20, 41472
    buffer_load_dwordx4 v[208:211], v4, s[8:11], s20 offen
    s_mul_i32 s21, s6, 18432
    s_add_u32 s25, s21, 0
    buffer_load_dwordx4 v[16:19], v3, s[12:15], s25 offen offset:0
    s_add_u32 s25, s21, 0
    buffer_load_dwordx4 v[20:23], v3, s[12:15], s25 offen offset:1024
    s_add_u32 s25, s21, 0
    buffer_load_dwordx4 v[24:27], v3, s[12:15], s25 offen offset:2048
    s_add_u32 s25, s21, 0
    buffer_load_dwordx4 v[28:31], v3, s[12:15], s25 offen offset:3072
    s_add_u32 s25, s21, 4096
    buffer_load_dwordx4 v[32:35], v3, s[12:15], s25 offen offset:0
    s_add_u32 s25, s21, 4096
    buffer_load_dwordx4 v[36:39], v3, s[12:15], s25 offen offset:1024
    s_mul_i32 s22, s7, 165888
    s_mul_i32 s23, s28, 7168
    s_add_u32 s22, s22, s23
    s_add_u32 m0, s23, 0
    s_add_u32 s24, s22, 0
    buffer_load_dwordx4 v3, s[16:19], s24 offen offset:0 lds
    buffer_load_dwordx4 v3, s[16:19], s24 offen offset:1024 lds
    buffer_load_dwordx4 v3, s[16:19], s24 offen offset:2048 lds
    buffer_load_dwordx4 v3, s[16:19], s24 offen offset:3072 lds
    s_add_u32 m0, s23, 4096
    s_add_u32 s24, s22, 4096
    buffer_load_dwordx4 v3, s[16:19], s24 offen offset:0 lds
    buffer_load_dwordx4 v3, s[16:19], s24 offen offset:1024 lds
    buffer_load_dwordx4 v3, s[16:19], s24 offen offset:2048 lds
    v_cmp_le_u32 vcc, 144, v0
    v_mov_b32 v5, 0
    v_add_u32 v4, 114688, v4
    v_cndmask_b32 v5, v5, 1.0, vcc
    s_waitcnt vmcnt(13)
    v_add_f32 v196, v196, v200
    v_add_f32 v204, v204, v208
    v_add_f32 v197, v197, v201
    v_add_f32 v205, v205, v209
    v_add_f32 v198, v198, v202
    v_add_f32 v206, v206, v210
    v_add_f32 v199, v199, v203
    v_add_f32 v207, v207, v211
    v_add_f32 v196, v196, v204
    v_add_f32 v197, v197, v205
    v_add_f32 v198, v198, v206
    v_add_f32 v199, v199, v207
    v_add_f32 v196, v196, v5
    v_add_f32 v197, v197, v5
    v_add_f32 v198, v198, v5
    v_add_f32 v199, v199, v5
    v_cmp_gt_u32 vcc, 288, v0
    s_and_saveexec_b64 s[26:27], vcc
    ds_write_b128 v4, v[196:199]
    s_mov_b64 exec, s[26:27]
    s_waitcnt lgkmcnt(0)
    s_barrier
    v_lshrrev_b32 v6, 4, v2
    v_lshlrev_b32 v7, 5, v6
    v_add_u32 v7, 114688, v7
    v_add_u32 v8, 57344, v3
    v_mov_b32 v88, 0
    v_mov_b32 v89, 0
    v_mov_b32 v90, 0
    v_mov_b32 v91, 0
    v_mov_b32 v92, 0
    v_mov_b32 v93, 0
    v_mov_b32 v94, 0
    v_mov_b32 v95, 0
    v_mov_b32 v96, 0
    v_mov_b32 v97, 0
    v_mov_b32 v98, 0
    v_mov_b32 v99, 0
    v_mov_b32 v100, 0
    v_mov_b32 v101, 0
    v_mov_b32 v102, 0
    v_mov_b32 v103, 0
    v_mov_b32 v104, 0
    v_mov_b32 v105, 0
    v_mov_b32 v106, 0
    v_mov_b32 v107, 0
    v_mov_b32 v108, 0
    v_mov_b32 v109, 0
    v_mov_b32 v110, 0
    v_mov_b32 v111, 0
    v_mov_b32 v112, 0
    v_mov_b32 v113, 0
    v_mov_b32 v114, 0
    v_mov_b32 v115, 0
    v_mov_b32 v116, 0
    v_mov_b32 v117, 0
    v_mov_b32 v118, 0
    v_mov_b32 v119, 0
    v_mov_b32 v120, 0
    v_mov_b32 v121, 0
    v_mov_b32 v122, 0
    v_mov_b32 v123, 0
    s_cmp_ge_u32 s7, 8
    s_cbranch_scc1 L_vtype_12
    ds_read_b128 v[196:199], v7 offset:0
    ds_read_b128 v[200:203], v7 offset:16
    ds_read_b128 v[204:207], v7 offset:2304
    ds_read_b128 v[208:211], v7 offset:2320
    ds_read_b128 v[212:215], v7 offset:128
    ds_read_b128 v[216:219], v7 offset:144
    ds_read_b128 v[220:223], v7 offset:2432
    ds_read_b128 v[224:227], v7 offset:2448
    s_add_u32 s25, s21, 4096
    buffer_load_dwordx4 v[40:43], v3, s[12:15], s25 offen offset:2048
    s_add_u32 m0, s23, 57344
    s_add_u32 s24, s22, 55296
    buffer_load_dwordx4 v3, s[16:19], s24 offen lds
    s_waitcnt vmcnt(14) lgkmcnt(4)
    v_lshlrev_b32 v228, 16, v16
    v_and_b32 v229, 0xffff0000, v16
    v_lshlrev_b32 v230, 16, v17
    v_and_b32 v231, 0xffff0000, v17
    v_lshlrev_b32 v232, 16, v18
    v_and_b32 v233, 0xffff0000, v18
    v_lshlrev_b32 v234, 16, v19
    v_and_b32 v235, 0xffff0000, v19
    v_pk_fma_f32 v[228:229], v[228:229], v[204:205], v[196:197]
    v_pk_fma_f32 v[230:231], v[230:231], v[206:207], v[198:199]
    v_pk_fma_f32 v[232:233], v[232:233], v[208:209], v[200:201]
    v_pk_fma_f32 v[234:235], v[234:235], v[210:211], v[202:203]
    v_cvt_pk_bf16_f32 v16, v228, v229
    v_cvt_pk_bf16_f32 v17, v230, v231
    v_cvt_pk_bf16_f32 v18, v232, v233
    v_cvt_pk_bf16_f32 v19, v234, v235
    ds_read_b128 v[196:199], v7 offset:256
    ds_read_b128 v[200:203], v7 offset:272
    ds_read_b128 v[204:207], v7 offset:2560
    ds_read_b128 v[208:211], v7 offset:2576
    s_add_u32 s25, s21, 4096
    buffer_load_dwordx4 v[44:47], v3, s[12:15], s25 offen offset:3072
    s_add_u32 m0, s23, 58368
    s_add_u32 s24, s22, 56320
    buffer_load_dwordx4 v3, s[16:19], s24 offen lds
    s_waitcnt vmcnt(15) lgkmcnt(4)
    v_lshlrev_b32 v228, 16, v20
    v_and_b32 v229, 0xffff0000, v20
    v_lshlrev_b32 v230, 16, v21
    v_and_b32 v231, 0xffff0000, v21
    v_lshlrev_b32 v232, 16, v22
    v_and_b32 v233, 0xffff0000, v22
    v_lshlrev_b32 v234, 16, v23
    v_and_b32 v235, 0xffff0000, v23
    v_pk_fma_f32 v[228:229], v[228:229], v[220:221], v[212:213]
    v_pk_fma_f32 v[230:231], v[230:231], v[222:223], v[214:215]
    v_pk_fma_f32 v[232:233], v[232:233], v[224:225], v[216:217]
    v_pk_fma_f32 v[234:235], v[234:235], v[226:227], v[218:219]
    v_cvt_pk_bf16_f32 v20, v228, v229
    v_cvt_pk_bf16_f32 v21, v230, v231
    v_cvt_pk_bf16_f32 v22, v232, v233
    v_cvt_pk_bf16_f32 v23, v234, v235
    ds_read_b128 v[212:215], v7 offset:384
    ds_read_b128 v[216:219], v7 offset:400
    ds_read_b128 v[220:223], v7 offset:2688
    ds_read_b128 v[224:227], v7 offset:2704
    s_add_u32 s25, s21, 8192
    buffer_load_dwordx4 v[48:51], v3, s[12:15], s25 offen offset:0
    s_add_u32 m0, s23, 59392
    s_add_u32 s24, s22, 57344
    buffer_load_dwordx4 v3, s[16:19], s24 offen lds
    s_waitcnt vmcnt(16) lgkmcnt(4)
    v_lshlrev_b32 v228, 16, v24
    v_and_b32 v229, 0xffff0000, v24
    v_lshlrev_b32 v230, 16, v25
    v_and_b32 v231, 0xffff0000, v25
    v_lshlrev_b32 v232, 16, v26
    v_and_b32 v233, 0xffff0000, v26
    v_lshlrev_b32 v234, 16, v27
    v_and_b32 v235, 0xffff0000, v27
    v_pk_fma_f32 v[228:229], v[228:229], v[204:205], v[196:197]
    v_pk_fma_f32 v[230:231], v[230:231], v[206:207], v[198:199]
    v_pk_fma_f32 v[232:233], v[232:233], v[208:209], v[200:201]
    v_pk_fma_f32 v[234:235], v[234:235], v[210:211], v[202:203]
    v_cvt_pk_bf16_f32 v24, v228, v229
    v_cvt_pk_bf16_f32 v25, v230, v231
    v_cvt_pk_bf16_f32 v26, v232, v233
    v_cvt_pk_bf16_f32 v27, v234, v235
    ds_read_b128 v[196:199], v7 offset:512
    ds_read_b128 v[200:203], v7 offset:528
    ds_read_b128 v[204:207], v7 offset:2816
    ds_read_b128 v[208:211], v7 offset:2832
    s_add_u32 s25, s21, 8192
    buffer_load_dwordx4 v[52:55], v3, s[12:15], s25 offen offset:1024
    s_add_u32 m0, s23, 60416
    s_add_u32 s24, s22, 58368
    buffer_load_dwordx4 v3, s[16:19], s24 offen lds
    s_waitcnt vmcnt(17) lgkmcnt(4)
    v_lshlrev_b32 v228, 16, v28
    v_and_b32 v229, 0xffff0000, v28
    v_lshlrev_b32 v230, 16, v29
    v_and_b32 v231, 0xffff0000, v29
    v_lshlrev_b32 v232, 16, v30
    v_and_b32 v233, 0xffff0000, v30
    v_lshlrev_b32 v234, 16, v31
    v_and_b32 v235, 0xffff0000, v31
    v_pk_fma_f32 v[228:229], v[228:229], v[220:221], v[212:213]
    v_pk_fma_f32 v[230:231], v[230:231], v[222:223], v[214:215]
    v_pk_fma_f32 v[232:233], v[232:233], v[224:225], v[216:217]
    v_pk_fma_f32 v[234:235], v[234:235], v[226:227], v[218:219]
    v_cvt_pk_bf16_f32 v28, v228, v229
    v_cvt_pk_bf16_f32 v29, v230, v231
    v_cvt_pk_bf16_f32 v30, v232, v233
    v_cvt_pk_bf16_f32 v31, v234, v235
    ds_read_b128 v[212:215], v7 offset:640
    ds_read_b128 v[216:219], v7 offset:656
    ds_read_b128 v[220:223], v7 offset:2944
    ds_read_b128 v[224:227], v7 offset:2960
    s_add_u32 s25, s21, 8192
    buffer_load_dwordx4 v[56:59], v3, s[12:15], s25 offen offset:2048
    s_add_u32 m0, s23, 61440
    s_add_u32 s24, s22, 59392
    buffer_load_dwordx4 v3, s[16:19], s24 offen lds
    s_waitcnt vmcnt(18) lgkmcnt(4)
    v_lshlrev_b32 v228, 16, v32
    v_and_b32 v229, 0xffff0000, v32
    v_lshlrev_b32 v230, 16, v33
    v_and_b32 v231, 0xffff0000, v33
    v_lshlrev_b32 v232, 16, v34
    v_and_b32 v233, 0xffff0000, v34
    v_lshlrev_b32 v234, 16, v35
    v_and_b32 v235, 0xffff0000, v35
    v_pk_fma_f32 v[228:229], v[228:229], v[204:205], v[196:197]
    v_pk_fma_f32 v[230:231], v[230:231], v[206:207], v[198:199]
    v_pk_fma_f32 v[232:233], v[232:233], v[208:209], v[200:201]
    v_pk_fma_f32 v[234:235], v[234:235], v[210:211], v[202:203]
    v_cvt_pk_bf16_f32 v32, v228, v229
    v_cvt_pk_bf16_f32 v33, v230, v231
    v_cvt_pk_bf16_f32 v34, v232, v233
    v_cvt_pk_bf16_f32 v35, v234, v235
    s_add_u32 s25, s21, 8192
    buffer_load_dwordx4 v[60:63], v3, s[12:15], s25 offen offset:3072
    s_add_u32 m0, s23, 62464
    s_add_u32 s24, s22, 60416
    buffer_load_dwordx4 v3, s[16:19], s24 offen lds
    s_add_u32 m0, s23, 63488
    s_add_u32 s24, s22, 61440
    buffer_load_dwordx4 v3, s[16:19], s24 offen lds
    s_waitcnt vmcnt(20) lgkmcnt(0)
    v_lshlrev_b32 v228, 16, v36
    v_and_b32 v229, 0xffff0000, v36
    v_lshlrev_b32 v230, 16, v37
    v_and_b32 v231, 0xffff0000, v37
    v_lshlrev_b32 v232, 16, v38
    v_and_b32 v233, 0xffff0000, v38
    v_lshlrev_b32 v234, 16, v39
    v_and_b32 v235, 0xffff0000, v39
    v_pk_fma_f32 v[228:229], v[228:229], v[220:221], v[212:213]
    v_pk_fma_f32 v[230:231], v[230:231], v[222:223], v[214:215]
    v_pk_fma_f32 v[232:233], v[232:233], v[224:225], v[216:217]
    v_pk_fma_f32 v[234:235], v[234:235], v[226:227], v[218:219]
    v_cvt_pk_bf16_f32 v36, v228, v229
    v_cvt_pk_bf16_f32 v37, v230, v231
    v_cvt_pk_bf16_f32 v38, v232, v233
    v_cvt_pk_bf16_f32 v39, v234, v235
    s_cmp_ge_u32 s3, 4
    s_cbranch_scc1 L_grpB_13
    s_waitcnt vmcnt(13)
    s_barrier
    s_add_u32 s25, s21, 12288
    buffer_load_dwordx4 v[64:67], v3, s[12:15], s25 offen offset:0
    s_add_u32 s25, s21, 12288
    buffer_load_dwordx4 v[68:71], v3, s[12:15], s25 offen offset:1024
    s_add_u32 s25, s21, 12288
    buffer_load_dwordx4 v[72:75], v3, s[12:15], s25 offen offset:2048
    s_add_u32 s25, s21, 12288
    buffer_load_dwordx4 v[76:79], v3, s[12:15], s25 offen offset:3072
    s_add_u32 s25, s21, 16384
    buffer_load_dwordx4 v[80:83], v3, s[12:15], s25 offen offset:0
    s_add_u32 s25, s21, 16384
    buffer_load_dwordx4 v[84:87], v3, s[12:15], s25 offen offset:1024
    ds_read_b128 v[124:127], v3 offset:0
    ds_read_b128 v[128:131], v3 offset:1024
    ds_read_b128 v[132:135], v3 offset:2048
    ds_read_b128 v[136:139], v3 offset:3072
    ds_read_b128 v[140:143], v3 offset:4096
    ds_read_b128 v[144:147], v3 offset:5120
    ds_read_b128 v[148:151], v3 offset:6144
    ds_read_b128 v[152:155], v3 offset:7168
    ds_read_b128 v[156:159], v3 offset:8192
    s_waitcnt lgkmcnt(6)
    v_mfma_f32_16x16x32_bf16 v[88:91], v[124:127], v[16:19], v[88:91]
    ds_read_b128 v[160:163], v3 offset:9216
    v_mfma_f32_16x16x32_bf16 v[92:95], v[128:131], v[16:19], v[92:95]
    ds_read_b128 v[164:167], v3 offset:10240
    v_mfma_f32_16x16x32_bf16 v[96:99], v[132:135], v[16:19], v[96:99]
    ds_read_b128 v[168:171], v3 offset:11264
    s_waitcnt lgkmcnt(6)
    v_mfma_f32_16x16x32_bf16 v[100:103], v[136:139], v[16:19], v[100:103]
    ds_read_b128 v[172:175], v3 offset:12288
    v_mfma_f32_16x16x32_bf16 v[104:107], v[140:143], v[16:19], v[104:107]
    ds_read_b128 v[176:179], v3 offset:13312
    v_mfma_f32_16x16x32_bf16 v[108:111], v[144:147], v[16:19], v[108:111]
    ds_read_b128 v[180:183], v3 offset:14336
    s_waitcnt lgkmcnt(6)
    v_mfma_f32_16x16x32_bf16 v[112:115], v[148:151], v[16:19], v[112:115]
    ds_read_b128 v[184:187], v3 offset:15360
    v_mfma_f32_16x16x32_bf16 v[116:119], v[152:155], v[16:19], v[116:119]
    ds_read_b128 v[188:191], v3 offset:16384
    v_mfma_f32_16x16x32_bf16 v[120:123], v[156:159], v[16:19], v[120:123]
    ds_read_b128 v[192:195], v3 offset:17408
    s_waitcnt lgkmcnt(6)
    v_mfma_f32_16x16x32_bf16 v[88:91], v[160:163], v[20:23], v[88:91]
    ds_read_b128 v[124:127], v3 offset:18432
    v_mfma_f32_16x16x32_bf16 v[92:95], v[164:167], v[20:23], v[92:95]
    ds_read_b128 v[128:131], v3 offset:19456
    v_mfma_f32_16x16x32_bf16 v[96:99], v[168:171], v[20:23], v[96:99]
    ds_read_b128 v[132:135], v3 offset:20480
    s_waitcnt lgkmcnt(6)
    v_mfma_f32_16x16x32_bf16 v[100:103], v[172:175], v[20:23], v[100:103]
    ds_read_b128 v[136:139], v3 offset:21504
    v_mfma_f32_16x16x32_bf16 v[104:107], v[176:179], v[20:23], v[104:107]
    ds_read_b128 v[140:143], v3 offset:22528
    v_mfma_f32_16x16x32_bf16 v[108:111], v[180:183], v[20:23], v[108:111]
    ds_read_b128 v[144:147], v3 offset:23552
    s_waitcnt lgkmcnt(6)
    v_mfma_f32_16x16x32_bf16 v[112:115], v[184:187], v[20:23], v[112:115]
    ds_read_b128 v[148:151], v3 offset:24576
    v_mfma_f32_16x16x32_bf16 v[116:119], v[188:191], v[20:23], v[116:119]
    ds_read_b128 v[152:155], v3 offset:25600
    v_mfma_f32_16x16x32_bf16 v[120:123], v[192:195], v[20:23], v[120:123]
    ds_read_b128 v[156:159], v3 offset:26624
    s_waitcnt lgkmcnt(6)
    v_mfma_f32_16x16x32_bf16 v[88:91], v[124:127], v[24:27], v[88:91]
    ds_read_b128 v[160:163], v3 offset:27648
    v_mfma_f32_16x16x32_bf16 v[92:95], v[128:131], v[24:27], v[92:95]
    ds_read_b128 v[164:167], v3 offset:28672
    v_mfma_f32_16x16x32_bf16 v[96:99], v[132:135], v[24:27], v[96:99]
    ds_read_b128 v[168:171], v3 offset:29696
    s_waitcnt lgkmcnt(6)
    v_mfma_f32_16x16x32_bf16 v[100:103], v[136:139], v[24:27], v[100:103]
    ds_read_b128 v[172:175], v3 offset:30720
    v_mfma_f32_16x16x32_bf16 v[104:107], v[140:143], v[24:27], v[104:107]
    ds_read_b128 v[176:179], v3 offset:31744
    v_mfma_f32_16x16x32_bf16 v[108:111], v[144:147], v[24:27], v[108:111]
    ds_read_b128 v[180:183], v3 offset:32768
    s_waitcnt lgkmcnt(6)
    v_mfma_f32_16x16x32_bf16 v[112:115], v[148:151], v[24:27], v[112:115]
    ds_read_b128 v[184:187], v3 offset:33792
    v_mfma_f32_16x16x32_bf16 v[116:119], v[152:155], v[24:27], v[116:119]
    ds_read_b128 v[188:191], v3 offset:34816
    v_mfma_f32_16x16x32_bf16 v[120:123], v[156:159], v[24:27], v[120:123]
    ds_read_b128 v[192:195], v3 offset:35840
    s_waitcnt lgkmcnt(6)
    v_mfma_f32_16x16x32_bf16 v[88:91], v[160:163], v[28:31], v[88:91]
    ds_read_b128 v[124:127], v3 offset:36864
    v_mfma_f32_16x16x32_bf16 v[92:95], v[164:167], v[28:31], v[92:95]
    ds_read_b128 v[128:131], v3 offset:37888
    v_mfma_f32_16x16x32_bf16 v[96:99], v[168:171], v[28:31], v[96:99]
    ds_read_b128 v[132:135], v3 offset:38912
    s_waitcnt lgkmcnt(6)
    v_mfma_f32_16x16x32_bf16 v[100:103], v[172:175], v[28:31], v[100:103]
    ds_read_b128 v[136:139], v3 offset:39936
    v_mfma_f32_16x16x32_bf16 v[104:107], v[176:179], v[28:31], v[104:107]
    ds_read_b128 v[140:143], v3 offset:40960
    v_mfma_f32_16x16x32_bf16 v[108:111], v[180:183], v[28:31], v[108:111]
    ds_read_b128 v[144:147], v3 offset:41984
    s_waitcnt lgkmcnt(6)
    v_mfma_f32_16x16x32_bf16 v[112:115], v[184:187], v[28:31], v[112:115]
    ds_read_b128 v[148:151], v3 offset:43008
    v_mfma_f32_16x16x32_bf16 v[116:119], v[188:191], v[28:31], v[116:119]
    ds_read_b128 v[152:155], v3 offset:44032
    v_mfma_f32_16x16x32_bf16 v[120:123], v[192:195], v[28:31], v[120:123]
    ds_read_b128 v[156:159], v3 offset:45056
    s_waitcnt lgkmcnt(6)
    v_mfma_f32_16x16x32_bf16 v[88:91], v[124:127], v[32:35], v[88:91]
    ds_read_b128 v[160:163], v3 offset:46080
    v_mfma_f32_16x16x32_bf16 v[92:95], v[128:131], v[32:35], v[92:95]
    ds_read_b128 v[164:167], v3 offset:47104
    v_mfma_f32_16x16x32_bf16 v[96:99], v[132:135], v[32:35], v[96:99]
    ds_read_b128 v[168:171], v3 offset:48128
    s_waitcnt lgkmcnt(6)
    v_mfma_f32_16x16x32_bf16 v[100:103], v[136:139], v[32:35], v[100:103]
    ds_read_b128 v[172:175], v3 offset:49152
    v_mfma_f32_16x16x32_bf16 v[104:107], v[140:143], v[32:35], v[104:107]
    ds_read_b128 v[176:179], v3 offset:50176
    v_mfma_f32_16x16x32_bf16 v[108:111], v[144:147], v[32:35], v[108:111]
    ds_read_b128 v[180:183], v3 offset:51200
    s_waitcnt lgkmcnt(6)
    v_mfma_f32_16x16x32_bf16 v[112:115], v[148:151], v[32:35], v[112:115]
    ds_read_b128 v[184:187], v3 offset:52224
    v_mfma_f32_16x16x32_bf16 v[116:119], v[152:155], v[32:35], v[116:119]
    ds_read_b128 v[188:191], v3 offset:53248
    v_mfma_f32_16x16x32_bf16 v[120:123], v[156:159], v[32:35], v[120:123]
    ds_read_b128 v[192:195], v3 offset:54272
    s_waitcnt lgkmcnt(6)
    v_mfma_f32_16x16x32_bf16 v[88:91], v[160:163], v[36:39], v[88:91]
    v_mfma_f32_16x16x32_bf16 v[92:95], v[164:167], v[36:39], v[92:95]
    v_mfma_f32_16x16x32_bf16 v[96:99], v[168:171], v[36:39], v[96:99]
    s_waitcnt lgkmcnt(3)
    v_mfma_f32_16x16x32_bf16 v[100:103], v[172:175], v[36:39], v[100:103]
    v_mfma_f32_16x16x32_bf16 v[104:107], v[176:179], v[36:39], v[104:107]
    v_mfma_f32_16x16x32_bf16 v[108:111], v[180:183], v[36:39], v[108:111]
    s_waitcnt lgkmcnt(0)
    v_mfma_f32_16x16x32_bf16 v[112:115], v[184:187], v[36:39], v[112:115]
    v_mfma_f32_16x16x32_bf16 v[116:119], v[188:191], v[36:39], v[116:119]
    v_mfma_f32_16x16x32_bf16 v[120:123], v[192:195], v[36:39], v[120:123]
    ds_read_b128 v[196:199], v7 offset:768
    ds_read_b128 v[200:203], v7 offset:784
    ds_read_b128 v[204:207], v7 offset:3072
    ds_read_b128 v[208:211], v7 offset:3088
    ds_read_b128 v[212:215], v7 offset:896
    ds_read_b128 v[216:219], v7 offset:912
    ds_read_b128 v[220:223], v7 offset:3200
    ds_read_b128 v[224:227], v7 offset:3216
    s_waitcnt vmcnt(18) lgkmcnt(4)
    v_lshlrev_b32 v228, 16, v40
    v_and_b32 v229, 0xffff0000, v40
    v_lshlrev_b32 v230, 16, v41
    v_and_b32 v231, 0xffff0000, v41
    v_lshlrev_b32 v232, 16, v42
    v_and_b32 v233, 0xffff0000, v42
    v_lshlrev_b32 v234, 16, v43
    v_and_b32 v235, 0xffff0000, v43
    v_pk_fma_f32 v[228:229], v[228:229], v[204:205], v[196:197]
    v_pk_fma_f32 v[230:231], v[230:231], v[206:207], v[198:199]
    v_pk_fma_f32 v[232:233], v[232:233], v[208:209], v[200:201]
    v_pk_fma_f32 v[234:235], v[234:235], v[210:211], v[202:203]
    v_cvt_pk_bf16_f32 v40, v228, v229
    v_cvt_pk_bf16_f32 v41, v230, v231
    v_cvt_pk_bf16_f32 v42, v232, v233
    v_cvt_pk_bf16_f32 v43, v234, v235
    ds_read_b128 v[196:199], v7 offset:1024
    ds_read_b128 v[200:203], v7 offset:1040
    ds_read_b128 v[204:207], v7 offset:3328
    ds_read_b128 v[208:211], v7 offset:3344
    s_waitcnt vmcnt(16) lgkmcnt(4)
    v_lshlrev_b32 v228, 16, v44
    v_and_b32 v229, 0xffff0000, v44
    v_lshlrev_b32 v230, 16, v45
    v_and_b32 v231, 0xffff0000, v45
    v_lshlrev_b32 v232, 16, v46
    v_and_b32 v233, 0xffff0000, v46
    v_lshlrev_b32 v234, 16, v47
    v_and_b32 v235, 0xffff0000, v47
    v_pk_fma_f32 v[228:229], v[228:229], v[220:221], v[212:213]
    v_pk_fma_f32 v[230:231], v[230:231], v[222:223], v[214:215]
    v_pk_fma_f32 v[232:233], v[232:233], v[224:225], v[216:217]
    v_pk_fma_f32 v[234:235], v[234:235], v[226:227], v[218:219]
    v_cvt_pk_bf16_f32 v44, v228, v229
    v_cvt_pk_bf16_f32 v45, v230, v231
    v_cvt_pk_bf16_f32 v46, v232, v233
    v_cvt_pk_bf16_f32 v47, v234, v235
    ds_read_b128 v[212:215], v7 offset:1152
    ds_read_b128 v[216:219], v7 offset:1168
    ds_read_b128 v[220:223], v7 offset:3456
    ds_read_b128 v[224:227], v7 offset:3472
    s_waitcnt vmcnt(14) lgkmcnt(4)
    v_lshlrev_b32 v228, 16, v48
    v_and_b32 v229, 0xffff0000, v48
    v_lshlrev_b32 v230, 16, v49
    v_and_b32 v231, 0xffff0000, v49
    v_lshlrev_b32 v232, 16, v50
    v_and_b32 v233, 0xffff0000, v50
    v_lshlrev_b32 v234, 16, v51
    v_and_b32 v235, 0xffff0000, v51
    v_pk_fma_f32 v[228:229], v[228:229], v[204:205], v[196:197]
    v_pk_fma_f32 v[230:231], v[230:231], v[206:207], v[198:199]
    v_pk_fma_f32 v[232:233], v[232:233], v[208:209], v[200:201]
    v_pk_fma_f32 v[234:235], v[234:235], v[210:211], v[202:203]
    v_cvt_pk_bf16_f32 v48, v228, v229
    v_cvt_pk_bf16_f32 v49, v230, v231
    v_cvt_pk_bf16_f32 v50, v232, v233
    v_cvt_pk_bf16_f32 v51, v234, v235
    ds_read_b128 v[196:199], v7 offset:1280
    ds_read_b128 v[200:203], v7 offset:1296
    ds_read_b128 v[204:207], v7 offset:3584
    ds_read_b128 v[208:211], v7 offset:3600
    s_waitcnt vmcnt(12) lgkmcnt(4)
    v_lshlrev_b32 v228, 16, v52
    v_and_b32 v229, 0xffff0000, v52
    v_lshlrev_b32 v230, 16, v53
    v_and_b32 v231, 0xffff0000, v53
    v_lshlrev_b32 v232, 16, v54
    v_and_b32 v233, 0xffff0000, v54
    v_lshlrev_b32 v234, 16, v55
    v_and_b32 v235, 0xffff0000, v55
    v_pk_fma_f32 v[228:229], v[228:229], v[220:221], v[212:213]
    v_pk_fma_f32 v[230:231], v[230:231], v[222:223], v[214:215]
    v_pk_fma_f32 v[232:233], v[232:233], v[224:225], v[216:217]
    v_pk_fma_f32 v[234:235], v[234:235], v[226:227], v[218:219]
    v_cvt_pk_bf16_f32 v52, v228, v229
    v_cvt_pk_bf16_f32 v53, v230, v231
    v_cvt_pk_bf16_f32 v54, v232, v233
    v_cvt_pk_bf16_f32 v55, v234, v235
    ds_read_b128 v[212:215], v7 offset:1408
    ds_read_b128 v[216:219], v7 offset:1424
    ds_read_b128 v[220:223], v7 offset:3712
    ds_read_b128 v[224:227], v7 offset:3728
    s_waitcnt vmcnt(10) lgkmcnt(4)
    v_lshlrev_b32 v228, 16, v56
    v_and_b32 v229, 0xffff0000, v56
    v_lshlrev_b32 v230, 16, v57
    v_and_b32 v231, 0xffff0000, v57
    v_lshlrev_b32 v232, 16, v58
    v_and_b32 v233, 0xffff0000, v58
    v_lshlrev_b32 v234, 16, v59
    v_and_b32 v235, 0xffff0000, v59
    v_pk_fma_f32 v[228:229], v[228:229], v[204:205], v[196:197]
    v_pk_fma_f32 v[230:231], v[230:231], v[206:207], v[198:199]
    v_pk_fma_f32 v[232:233], v[232:233], v[208:209], v[200:201]
    v_pk_fma_f32 v[234:235], v[234:235], v[210:211], v[202:203]
    v_cvt_pk_bf16_f32 v56, v228, v229
    v_cvt_pk_bf16_f32 v57, v230, v231
    v_cvt_pk_bf16_f32 v58, v232, v233
    v_cvt_pk_bf16_f32 v59, v234, v235
    s_waitcnt vmcnt(8) lgkmcnt(0)
    v_lshlrev_b32 v228, 16, v60
    v_and_b32 v229, 0xffff0000, v60
    v_lshlrev_b32 v230, 16, v61
    v_and_b32 v231, 0xffff0000, v61
    v_lshlrev_b32 v232, 16, v62
    v_and_b32 v233, 0xffff0000, v62
    v_lshlrev_b32 v234, 16, v63
    v_and_b32 v235, 0xffff0000, v63
    v_pk_fma_f32 v[228:229], v[228:229], v[220:221], v[212:213]
    v_pk_fma_f32 v[230:231], v[230:231], v[222:223], v[214:215]
    v_pk_fma_f32 v[232:233], v[232:233], v[224:225], v[216:217]
    v_pk_fma_f32 v[234:235], v[234:235], v[226:227], v[218:219]
    v_cvt_pk_bf16_f32 v60, v228, v229
    v_cvt_pk_bf16_f32 v61, v230, v231
    v_cvt_pk_bf16_f32 v62, v232, v233
    v_cvt_pk_bf16_f32 v63, v234, v235
    s_waitcnt vmcnt(6)
    s_barrier
    s_add_u32 m0, s23, 0
    s_add_u32 s24, s22, 110592
    buffer_load_dwordx4 v3, s[16:19], s24 offen offset:0 lds
    buffer_load_dwordx4 v3, s[16:19], s24 offen offset:1024 lds
    buffer_load_dwordx4 v3, s[16:19], s24 offen offset:2048 lds
    buffer_load_dwordx4 v3, s[16:19], s24 offen offset:3072 lds
    s_add_u32 m0, s23, 4096
    s_add_u32 s24, s22, 114688
    buffer_load_dwordx4 v3, s[16:19], s24 offen offset:0 lds
    buffer_load_dwordx4 v3, s[16:19], s24 offen offset:1024 lds
    buffer_load_dwordx4 v3, s[16:19], s24 offen offset:2048 lds
    ds_read_b128 v[124:127], v8 offset:0
    ds_read_b128 v[128:131], v8 offset:1024
    ds_read_b128 v[132:135], v8 offset:2048
    ds_read_b128 v[136:139], v8 offset:3072
    ds_read_b128 v[140:143], v8 offset:4096
    ds_read_b128 v[144:147], v8 offset:5120
    ds_read_b128 v[148:151], v8 offset:6144
    ds_read_b128 v[152:155], v8 offset:7168
    ds_read_b128 v[156:159], v8 offset:8192
    s_waitcnt lgkmcnt(6)
    v_mfma_f32_16x16x32_bf16 v[88:91], v[124:127], v[40:43], v[88:91]
    ds_read_b128 v[160:163], v8 offset:9216
    v_mfma_f32_16x16x32_bf16 v[92:95], v[128:131], v[40:43], v[92:95]
    ds_read_b128 v[164:167], v8 offset:10240
    v_mfma_f32_16x16x32_bf16 v[96:99], v[132:135], v[40:43], v[96:99]
    ds_read_b128 v[168:171], v8 offset:11264
    s_waitcnt lgkmcnt(6)
    v_mfma_f32_16x16x32_bf16 v[100:103], v[136:139], v[40:43], v[100:103]
    ds_read_b128 v[172:175], v8 offset:12288
    v_mfma_f32_16x16x32_bf16 v[104:107], v[140:143], v[40:43], v[104:107]
    ds_read_b128 v[176:179], v8 offset:13312
    v_mfma_f32_16x16x32_bf16 v[108:111], v[144:147], v[40:43], v[108:111]
    ds_read_b128 v[180:183], v8 offset:14336
    s_waitcnt lgkmcnt(6)
    v_mfma_f32_16x16x32_bf16 v[112:115], v[148:151], v[40:43], v[112:115]
    ds_read_b128 v[184:187], v8 offset:15360
    v_mfma_f32_16x16x32_bf16 v[116:119], v[152:155], v[40:43], v[116:119]
    ds_read_b128 v[188:191], v8 offset:16384
    v_mfma_f32_16x16x32_bf16 v[120:123], v[156:159], v[40:43], v[120:123]
    ds_read_b128 v[192:195], v8 offset:17408
    s_waitcnt lgkmcnt(6)
    v_mfma_f32_16x16x32_bf16 v[88:91], v[160:163], v[44:47], v[88:91]
    ds_read_b128 v[124:127], v8 offset:18432
    v_mfma_f32_16x16x32_bf16 v[92:95], v[164:167], v[44:47], v[92:95]
    ds_read_b128 v[128:131], v8 offset:19456
    v_mfma_f32_16x16x32_bf16 v[96:99], v[168:171], v[44:47], v[96:99]
    ds_read_b128 v[132:135], v8 offset:20480
    s_waitcnt lgkmcnt(6)
    v_mfma_f32_16x16x32_bf16 v[100:103], v[172:175], v[44:47], v[100:103]
    ds_read_b128 v[136:139], v8 offset:21504
    v_mfma_f32_16x16x32_bf16 v[104:107], v[176:179], v[44:47], v[104:107]
    ds_read_b128 v[140:143], v8 offset:22528
    v_mfma_f32_16x16x32_bf16 v[108:111], v[180:183], v[44:47], v[108:111]
    ds_read_b128 v[144:147], v8 offset:23552
    s_waitcnt lgkmcnt(6)
    v_mfma_f32_16x16x32_bf16 v[112:115], v[184:187], v[44:47], v[112:115]
    ds_read_b128 v[148:151], v8 offset:24576
    v_mfma_f32_16x16x32_bf16 v[116:119], v[188:191], v[44:47], v[116:119]
    ds_read_b128 v[152:155], v8 offset:25600
    v_mfma_f32_16x16x32_bf16 v[120:123], v[192:195], v[44:47], v[120:123]
    ds_read_b128 v[156:159], v8 offset:26624
    s_waitcnt lgkmcnt(6)
    v_mfma_f32_16x16x32_bf16 v[88:91], v[124:127], v[48:51], v[88:91]
    ds_read_b128 v[160:163], v8 offset:27648
    v_mfma_f32_16x16x32_bf16 v[92:95], v[128:131], v[48:51], v[92:95]
    ds_read_b128 v[164:167], v8 offset:28672
    v_mfma_f32_16x16x32_bf16 v[96:99], v[132:135], v[48:51], v[96:99]
    ds_read_b128 v[168:171], v8 offset:29696
    s_waitcnt lgkmcnt(6)
    v_mfma_f32_16x16x32_bf16 v[100:103], v[136:139], v[48:51], v[100:103]
    ds_read_b128 v[172:175], v8 offset:30720
    v_mfma_f32_16x16x32_bf16 v[104:107], v[140:143], v[48:51], v[104:107]
    ds_read_b128 v[176:179], v8 offset:31744
    v_mfma_f32_16x16x32_bf16 v[108:111], v[144:147], v[48:51], v[108:111]
    ds_read_b128 v[180:183], v8 offset:32768
    s_waitcnt lgkmcnt(6)
    v_mfma_f32_16x16x32_bf16 v[112:115], v[148:151], v[48:51], v[112:115]
    ds_read_b128 v[184:187], v8 offset:33792
    v_mfma_f32_16x16x32_bf16 v[116:119], v[152:155], v[48:51], v[116:119]
    ds_read_b128 v[188:191], v8 offset:34816
    v_mfma_f32_16x16x32_bf16 v[120:123], v[156:159], v[48:51], v[120:123]
    ds_read_b128 v[192:195], v8 offset:35840
    s_waitcnt lgkmcnt(6)
    v_mfma_f32_16x16x32_bf16 v[88:91], v[160:163], v[52:55], v[88:91]
    ds_read_b128 v[124:127], v8 offset:36864
    v_mfma_f32_16x16x32_bf16 v[92:95], v[164:167], v[52:55], v[92:95]
    ds_read_b128 v[128:131], v8 offset:37888
    v_mfma_f32_16x16x32_bf16 v[96:99], v[168:171], v[52:55], v[96:99]
    ds_read_b128 v[132:135], v8 offset:38912
    s_waitcnt lgkmcnt(6)
    v_mfma_f32_16x16x32_bf16 v[100:103], v[172:175], v[52:55], v[100:103]
    ds_read_b128 v[136:139], v8 offset:39936
    v_mfma_f32_16x16x32_bf16 v[104:107], v[176:179], v[52:55], v[104:107]
    ds_read_b128 v[140:143], v8 offset:40960
    v_mfma_f32_16x16x32_bf16 v[108:111], v[180:183], v[52:55], v[108:111]
    ds_read_b128 v[144:147], v8 offset:41984
    s_waitcnt lgkmcnt(6)
    v_mfma_f32_16x16x32_bf16 v[112:115], v[184:187], v[52:55], v[112:115]
    ds_read_b128 v[148:151], v8 offset:43008
    v_mfma_f32_16x16x32_bf16 v[116:119], v[188:191], v[52:55], v[116:119]
    ds_read_b128 v[152:155], v8 offset:44032
    v_mfma_f32_16x16x32_bf16 v[120:123], v[192:195], v[52:55], v[120:123]
    ds_read_b128 v[156:159], v8 offset:45056
    s_waitcnt lgkmcnt(6)
    v_mfma_f32_16x16x32_bf16 v[88:91], v[124:127], v[56:59], v[88:91]
    ds_read_b128 v[160:163], v8 offset:46080
    v_mfma_f32_16x16x32_bf16 v[92:95], v[128:131], v[56:59], v[92:95]
    ds_read_b128 v[164:167], v8 offset:47104
    v_mfma_f32_16x16x32_bf16 v[96:99], v[132:135], v[56:59], v[96:99]
    ds_read_b128 v[168:171], v8 offset:48128
    s_waitcnt lgkmcnt(6)
    v_mfma_f32_16x16x32_bf16 v[100:103], v[136:139], v[56:59], v[100:103]
    ds_read_b128 v[172:175], v8 offset:49152
    v_mfma_f32_16x16x32_bf16 v[104:107], v[140:143], v[56:59], v[104:107]
    ds_read_b128 v[176:179], v8 offset:50176
    v_mfma_f32_16x16x32_bf16 v[108:111], v[144:147], v[56:59], v[108:111]
    ds_read_b128 v[180:183], v8 offset:51200
    s_waitcnt lgkmcnt(6)
    v_mfma_f32_16x16x32_bf16 v[112:115], v[148:151], v[56:59], v[112:115]
    ds_read_b128 v[184:187], v8 offset:52224
    v_mfma_f32_16x16x32_bf16 v[116:119], v[152:155], v[56:59], v[116:119]
    ds_read_b128 v[188:191], v8 offset:53248
    v_mfma_f32_16x16x32_bf16 v[120:123], v[156:159], v[56:59], v[120:123]
    ds_read_b128 v[192:195], v8 offset:54272
    s_waitcnt lgkmcnt(6)
    v_mfma_f32_16x16x32_bf16 v[88:91], v[160:163], v[60:63], v[88:91]
    v_mfma_f32_16x16x32_bf16 v[92:95], v[164:167], v[60:63], v[92:95]
    v_mfma_f32_16x16x32_bf16 v[96:99], v[168:171], v[60:63], v[96:99]
    s_waitcnt lgkmcnt(3)
    v_mfma_f32_16x16x32_bf16 v[100:103], v[172:175], v[60:63], v[100:103]
    v_mfma_f32_16x16x32_bf16 v[104:107], v[176:179], v[60:63], v[104:107]
    v_mfma_f32_16x16x32_bf16 v[108:111], v[180:183], v[60:63], v[108:111]
    s_waitcnt lgkmcnt(0)
    v_mfma_f32_16x16x32_bf16 v[112:115], v[184:187], v[60:63], v[112:115]
    v_mfma_f32_16x16x32_bf16 v[116:119], v[188:191], v[60:63], v[116:119]
    v_mfma_f32_16x16x32_bf16 v[120:123], v[192:195], v[60:63], v[120:123]
    ds_read_b128 v[196:199], v7 offset:1536
    ds_read_b128 v[200:203], v7 offset:1552
    ds_read_b128 v[204:207], v7 offset:3840
    ds_read_b128 v[208:211], v7 offset:3856
    ds_read_b128 v[212:215], v7 offset:1664
    ds_read_b128 v[216:219], v7 offset:1680
    ds_read_b128 v[220:223], v7 offset:3968
    ds_read_b128 v[224:227], v7 offset:3984
    s_waitcnt vmcnt(12) lgkmcnt(4)
    v_lshlrev_b32 v228, 16, v64
    v_and_b32 v229, 0xffff0000, v64
    v_lshlrev_b32 v230, 16, v65
    v_and_b32 v231, 0xffff0000, v65
    v_lshlrev_b32 v232, 16, v66
    v_and_b32 v233, 0xffff0000, v66
    v_lshlrev_b32 v234, 16, v67
    v_and_b32 v235, 0xffff0000, v67
    v_pk_fma_f32 v[228:229], v[228:229], v[204:205], v[196:197]
    v_pk_fma_f32 v[230:231], v[230:231], v[206:207], v[198:199]
    v_pk_fma_f32 v[232:233], v[232:233], v[208:209], v[200:201]
    v_pk_fma_f32 v[234:235], v[234:235], v[210:211], v[202:203]
    v_cvt_pk_bf16_f32 v64, v228, v229
    v_cvt_pk_bf16_f32 v65, v230, v231
    v_cvt_pk_bf16_f32 v66, v232, v233
    v_cvt_pk_bf16_f32 v67, v234, v235
    ds_read_b128 v[196:199], v7 offset:1792
    ds_read_b128 v[200:203], v7 offset:1808
    ds_read_b128 v[204:207], v7 offset:4096
    ds_read_b128 v[208:211], v7 offset:4112
    s_waitcnt vmcnt(11) lgkmcnt(4)
    v_lshlrev_b32 v228, 16, v68
    v_and_b32 v229, 0xffff0000, v68
    v_lshlrev_b32 v230, 16, v69
    v_and_b32 v231, 0xffff0000, v69
    v_lshlrev_b32 v232, 16, v70
    v_and_b32 v233, 0xffff0000, v70
    v_lshlrev_b32 v234, 16, v71
    v_and_b32 v235, 0xffff0000, v71
    v_pk_fma_f32 v[228:229], v[228:229], v[220:221], v[212:213]
    v_pk_fma_f32 v[230:231], v[230:231], v[222:223], v[214:215]
    v_pk_fma_f32 v[232:233], v[232:233], v[224:225], v[216:217]
    v_pk_fma_f32 v[234:235], v[234:235], v[226:227], v[218:219]
    v_cvt_pk_bf16_f32 v68, v228, v229
    v_cvt_pk_bf16_f32 v69, v230, v231
    v_cvt_pk_bf16_f32 v70, v232, v233
    v_cvt_pk_bf16_f32 v71, v234, v235
    ds_read_b128 v[212:215], v7 offset:1920
    ds_read_b128 v[216:219], v7 offset:1936
    ds_read_b128 v[220:223], v7 offset:4224
    ds_read_b128 v[224:227], v7 offset:4240
    s_waitcnt vmcnt(10) lgkmcnt(4)
    v_lshlrev_b32 v228, 16, v72
    v_and_b32 v229, 0xffff0000, v72
    v_lshlrev_b32 v230, 16, v73
    v_and_b32 v231, 0xffff0000, v73
    v_lshlrev_b32 v232, 16, v74
    v_and_b32 v233, 0xffff0000, v74
    v_lshlrev_b32 v234, 16, v75
    v_and_b32 v235, 0xffff0000, v75
    v_pk_fma_f32 v[228:229], v[228:229], v[204:205], v[196:197]
    v_pk_fma_f32 v[230:231], v[230:231], v[206:207], v[198:199]
    v_pk_fma_f32 v[232:233], v[232:233], v[208:209], v[200:201]
    v_pk_fma_f32 v[234:235], v[234:235], v[210:211], v[202:203]
    v_cvt_pk_bf16_f32 v72, v228, v229
    v_cvt_pk_bf16_f32 v73, v230, v231
    v_cvt_pk_bf16_f32 v74, v232, v233
    v_cvt_pk_bf16_f32 v75, v234, v235
    ds_read_b128 v[196:199], v7 offset:2048
    ds_read_b128 v[200:203], v7 offset:2064
    ds_read_b128 v[204:207], v7 offset:4352
    ds_read_b128 v[208:211], v7 offset:4368
    s_waitcnt vmcnt(9) lgkmcnt(4)
    v_lshlrev_b32 v228, 16, v76
    v_and_b32 v229, 0xffff0000, v76
    v_lshlrev_b32 v230, 16, v77
    v_and_b32 v231, 0xffff0000, v77
    v_lshlrev_b32 v232, 16, v78
    v_and_b32 v233, 0xffff0000, v78
    v_lshlrev_b32 v234, 16, v79
    v_and_b32 v235, 0xffff0000, v79
    v_pk_fma_f32 v[228:229], v[228:229], v[220:221], v[212:213]
    v_pk_fma_f32 v[230:231], v[230:231], v[222:223], v[214:215]
    v_pk_fma_f32 v[232:233], v[232:233], v[224:225], v[216:217]
    v_pk_fma_f32 v[234:235], v[234:235], v[226:227], v[218:219]
    v_cvt_pk_bf16_f32 v76, v228, v229
    v_cvt_pk_bf16_f32 v77, v230, v231
    v_cvt_pk_bf16_f32 v78, v232, v233
    v_cvt_pk_bf16_f32 v79, v234, v235
    ds_read_b128 v[212:215], v7 offset:2176
    ds_read_b128 v[216:219], v7 offset:2192
    ds_read_b128 v[220:223], v7 offset:4480
    ds_read_b128 v[224:227], v7 offset:4496
    s_waitcnt vmcnt(8) lgkmcnt(4)
    v_lshlrev_b32 v228, 16, v80
    v_and_b32 v229, 0xffff0000, v80
    v_lshlrev_b32 v230, 16, v81
    v_and_b32 v231, 0xffff0000, v81
    v_lshlrev_b32 v232, 16, v82
    v_and_b32 v233, 0xffff0000, v82
    v_lshlrev_b32 v234, 16, v83
    v_and_b32 v235, 0xffff0000, v83
    v_pk_fma_f32 v[228:229], v[228:229], v[204:205], v[196:197]
    v_pk_fma_f32 v[230:231], v[230:231], v[206:207], v[198:199]
    v_pk_fma_f32 v[232:233], v[232:233], v[208:209], v[200:201]
    v_pk_fma_f32 v[234:235], v[234:235], v[210:211], v[202:203]
    v_cvt_pk_bf16_f32 v80, v228, v229
    v_cvt_pk_bf16_f32 v81, v230, v231
    v_cvt_pk_bf16_f32 v82, v232, v233
    v_cvt_pk_bf16_f32 v83, v234, v235
    s_waitcnt vmcnt(7) lgkmcnt(0)
    v_lshlrev_b32 v228, 16, v84
    v_and_b32 v229, 0xffff0000, v84
    v_lshlrev_b32 v230, 16, v85
    v_and_b32 v231, 0xffff0000, v85
    v_lshlrev_b32 v232, 16, v86
    v_and_b32 v233, 0xffff0000, v86
    v_lshlrev_b32 v234, 16, v87
    v_and_b32 v235, 0xffff0000, v87
    v_pk_fma_f32 v[228:229], v[228:229], v[220:221], v[212:213]
    v_pk_fma_f32 v[230:231], v[230:231], v[222:223], v[214:215]
    v_pk_fma_f32 v[232:233], v[232:233], v[224:225], v[216:217]
    v_pk_fma_f32 v[234:235], v[234:235], v[226:227], v[218:219]
    v_cvt_pk_bf16_f32 v84, v228, v229
    v_cvt_pk_bf16_f32 v85, v230, v231
    v_cvt_pk_bf16_f32 v86, v232, v233
    v_cvt_pk_bf16_f32 v87, v234, v235
    s_waitcnt vmcnt(0)
    s_barrier
    ds_read_b128 v[124:127], v3 offset:0
    ds_read_b128 v[128:131], v3 offset:1024
    ds_read_b128 v[132:135], v3 offset:2048
    ds_read_b128 v[136:139], v3 offset:3072
    ds_read_b128 v[140:143], v3 offset:4096
    ds_read_b128 v[144:147], v3 offset:5120
    ds_read_b128 v[148:151], v3 offset:6144
    ds_read_b128 v[152:155], v3 offset:7168
    ds_read_b128 v[156:159], v3 offset:8192
    s_waitcnt lgkmcnt(6)
    v_mfma_f32_16x16x32_bf16 v[88:91], v[124:127], v[64:67], v[88:91]
    ds_read_b128 v[160:163], v3 offset:9216
    v_mfma_f32_16x16x32_bf16 v[92:95], v[128:131], v[64:67], v[92:95]
    ds_read_b128 v[164:167], v3 offset:10240
    v_mfma_f32_16x16x32_bf16 v[96:99], v[132:135], v[64:67], v[96:99]
    ds_read_b128 v[168:171], v3 offset:11264
    s_waitcnt lgkmcnt(6)
    v_mfma_f32_16x16x32_bf16 v[100:103], v[136:139], v[64:67], v[100:103]
    ds_read_b128 v[172:175], v3 offset:12288
    v_mfma_f32_16x16x32_bf16 v[104:107], v[140:143], v[64:67], v[104:107]
    ds_read_b128 v[176:179], v3 offset:13312
    v_mfma_f32_16x16x32_bf16 v[108:111], v[144:147], v[64:67], v[108:111]
    ds_read_b128 v[180:183], v3 offset:14336
    s_waitcnt lgkmcnt(6)
    v_mfma_f32_16x16x32_bf16 v[112:115], v[148:151], v[64:67], v[112:115]
    ds_read_b128 v[184:187], v3 offset:15360
    v_mfma_f32_16x16x32_bf16 v[116:119], v[152:155], v[64:67], v[116:119]
    ds_read_b128 v[188:191], v3 offset:16384
    v_mfma_f32_16x16x32_bf16 v[120:123], v[156:159], v[64:67], v[120:123]
    ds_read_b128 v[192:195], v3 offset:17408
    s_waitcnt lgkmcnt(6)
    v_mfma_f32_16x16x32_bf16 v[88:91], v[160:163], v[68:71], v[88:91]
    ds_read_b128 v[124:127], v3 offset:18432
    v_mfma_f32_16x16x32_bf16 v[92:95], v[164:167], v[68:71], v[92:95]
    ds_read_b128 v[128:131], v3 offset:19456
    v_mfma_f32_16x16x32_bf16 v[96:99], v[168:171], v[68:71], v[96:99]
    ds_read_b128 v[132:135], v3 offset:20480
    s_waitcnt lgkmcnt(6)
    v_mfma_f32_16x16x32_bf16 v[100:103], v[172:175], v[68:71], v[100:103]
    ds_read_b128 v[136:139], v3 offset:21504
    v_mfma_f32_16x16x32_bf16 v[104:107], v[176:179], v[68:71], v[104:107]
    ds_read_b128 v[140:143], v3 offset:22528
    v_mfma_f32_16x16x32_bf16 v[108:111], v[180:183], v[68:71], v[108:111]
    ds_read_b128 v[144:147], v3 offset:23552
    s_waitcnt lgkmcnt(6)
    v_mfma_f32_16x16x32_bf16 v[112:115], v[184:187], v[68:71], v[112:115]
    ds_read_b128 v[148:151], v3 offset:24576
    v_mfma_f32_16x16x32_bf16 v[116:119], v[188:191], v[68:71], v[116:119]
    ds_read_b128 v[152:155], v3 offset:25600
    v_mfma_f32_16x16x32_bf16 v[120:123], v[192:195], v[68:71], v[120:123]
    ds_read_b128 v[156:159], v3 offset:26624
    s_waitcnt lgkmcnt(6)
    v_mfma_f32_16x16x32_bf16 v[88:91], v[124:127], v[72:75], v[88:91]
    ds_read_b128 v[160:163], v3 offset:27648
    v_mfma_f32_16x16x32_bf16 v[92:95], v[128:131], v[72:75], v[92:95]
    ds_read_b128 v[164:167], v3 offset:28672
    v_mfma_f32_16x16x32_bf16 v[96:99], v[132:135], v[72:75], v[96:99]
    ds_read_b128 v[168:171], v3 offset:29696
    s_waitcnt lgkmcnt(6)
    v_mfma_f32_16x16x32_bf16 v[100:103], v[136:139], v[72:75], v[100:103]
    ds_read_b128 v[172:175], v3 offset:30720
    v_mfma_f32_16x16x32_bf16 v[104:107], v[140:143], v[72:75], v[104:107]
    ds_read_b128 v[176:179], v3 offset:31744
    v_mfma_f32_16x16x32_bf16 v[108:111], v[144:147], v[72:75], v[108:111]
    ds_read_b128 v[180:183], v3 offset:32768
    s_waitcnt lgkmcnt(6)
    v_mfma_f32_16x16x32_bf16 v[112:115], v[148:151], v[72:75], v[112:115]
    ds_read_b128 v[184:187], v3 offset:33792
    v_mfma_f32_16x16x32_bf16 v[116:119], v[152:155], v[72:75], v[116:119]
    ds_read_b128 v[188:191], v3 offset:34816
    v_mfma_f32_16x16x32_bf16 v[120:123], v[156:159], v[72:75], v[120:123]
    ds_read_b128 v[192:195], v3 offset:35840
    s_waitcnt lgkmcnt(6)
    v_mfma_f32_16x16x32_bf16 v[88:91], v[160:163], v[76:79], v[88:91]
    ds_read_b128 v[124:127], v3 offset:36864
    v_mfma_f32_16x16x32_bf16 v[92:95], v[164:167], v[76:79], v[92:95]
    ds_read_b128 v[128:131], v3 offset:37888
    v_mfma_f32_16x16x32_bf16 v[96:99], v[168:171], v[76:79], v[96:99]
    ds_read_b128 v[132:135], v3 offset:38912
    s_waitcnt lgkmcnt(6)
    v_mfma_f32_16x16x32_bf16 v[100:103], v[172:175], v[76:79], v[100:103]
    ds_read_b128 v[136:139], v3 offset:39936
    v_mfma_f32_16x16x32_bf16 v[104:107], v[176:179], v[76:79], v[104:107]
    ds_read_b128 v[140:143], v3 offset:40960
    v_mfma_f32_16x16x32_bf16 v[108:111], v[180:183], v[76:79], v[108:111]
    ds_read_b128 v[144:147], v3 offset:41984
    s_waitcnt lgkmcnt(6)
    v_mfma_f32_16x16x32_bf16 v[112:115], v[184:187], v[76:79], v[112:115]
    ds_read_b128 v[148:151], v3 offset:43008
    v_mfma_f32_16x16x32_bf16 v[116:119], v[188:191], v[76:79], v[116:119]
    ds_read_b128 v[152:155], v3 offset:44032
    v_mfma_f32_16x16x32_bf16 v[120:123], v[192:195], v[76:79], v[120:123]
    ds_read_b128 v[156:159], v3 offset:45056
    s_waitcnt lgkmcnt(6)
    v_mfma_f32_16x16x32_bf16 v[88:91], v[124:127], v[80:83], v[88:91]
    ds_read_b128 v[160:163], v3 offset:46080
    v_mfma_f32_16x16x32_bf16 v[92:95], v[128:131], v[80:83], v[92:95]
    ds_read_b128 v[164:167], v3 offset:47104
    v_mfma_f32_16x16x32_bf16 v[96:99], v[132:135], v[80:83], v[96:99]
    ds_read_b128 v[168:171], v3 offset:48128
    s_waitcnt lgkmcnt(6)
    v_mfma_f32_16x16x32_bf16 v[100:103], v[136:139], v[80:83], v[100:103]
    ds_read_b128 v[172:175], v3 offset:49152
    v_mfma_f32_16x16x32_bf16 v[104:107], v[140:143], v[80:83], v[104:107]
    ds_read_b128 v[176:179], v3 offset:50176
    v_mfma_f32_16x16x32_bf16 v[108:111], v[144:147], v[80:83], v[108:111]
    ds_read_b128 v[180:183], v3 offset:51200
    s_waitcnt lgkmcnt(6)
    v_mfma_f32_16x16x32_bf16 v[112:115], v[148:151], v[80:83], v[112:115]
    ds_read_b128 v[184:187], v3 offset:52224
    v_mfma_f32_16x16x32_bf16 v[116:119], v[152:155], v[80:83], v[116:119]
    ds_read_b128 v[188:191], v3 offset:53248
    v_mfma_f32_16x16x32_bf16 v[120:123], v[156:159], v[80:83], v[120:123]
    ds_read_b128 v[192:195], v3 offset:54272
    s_waitcnt lgkmcnt(6)
    v_mfma_f32_16x16x32_bf16 v[88:91], v[160:163], v[84:87], v[88:91]
    v_mfma_f32_16x16x32_bf16 v[92:95], v[164:167], v[84:87], v[92:95]
    v_mfma_f32_16x16x32_bf16 v[96:99], v[168:171], v[84:87], v[96:99]
    s_waitcnt lgkmcnt(3)
    v_mfma_f32_16x16x32_bf16 v[100:103], v[172:175], v[84:87], v[100:103]
    v_mfma_f32_16x16x32_bf16 v[104:107], v[176:179], v[84:87], v[104:107]
    v_mfma_f32_16x16x32_bf16 v[108:111], v[180:183], v[84:87], v[108:111]
    s_waitcnt lgkmcnt(0)
    v_mfma_f32_16x16x32_bf16 v[112:115], v[184:187], v[84:87], v[112:115]
    v_mfma_f32_16x16x32_bf16 v[116:119], v[188:191], v[84:87], v[116:119]
    v_mfma_f32_16x16x32_bf16 v[120:123], v[192:195], v[84:87], v[120:123]
    s_branch L_grpJ_14
L_grpB_13:
    s_waitcnt vmcnt(13)
    s_barrier
    s_add_u32 s25, s21, 12288
    buffer_load_dwordx4 v[64:67], v3, s[12:15], s25 offen offset:0
    s_add_u32 s25, s21, 12288
    buffer_load_dwordx4 v[68:71], v3, s[12:15], s25 offen offset:1024
    s_add_u32 s25, s21, 12288
    buffer_load_dwordx4 v[72:75], v3, s[12:15], s25 offen offset:2048
    s_add_u32 s25, s21, 12288
    buffer_load_dwordx4 v[76:79], v3, s[12:15], s25 offen offset:3072
    s_add_u32 s25, s21, 16384
    buffer_load_dwordx4 v[80:83], v3, s[12:15], s25 offen offset:0
    s_add_u32 s25, s21, 16384
    buffer_load_dwordx4 v[84:87], v3, s[12:15], s25 offen offset:1024
    ds_read_b128 v[196:199], v7 offset:768
    ds_read_b128 v[200:203], v7 offset:784
    ds_read_b128 v[204:207], v7 offset:3072
    ds_read_b128 v[208:211], v7 offset:3088
    ds_read_b128 v[212:215], v7 offset:896
    ds_read_b128 v[216:219], v7 offset:912
    ds_read_b128 v[220:223], v7 offset:3200
    ds_read_b128 v[224:227], v7 offset:3216
    s_waitcnt vmcnt(18) lgkmcnt(4)
    v_lshlrev_b32 v228, 16, v40
    v_and_b32 v229, 0xffff0000, v40
    v_lshlrev_b32 v230, 16, v41
    v_and_b32 v231, 0xffff0000, v41
    v_lshlrev_b32 v232, 16, v42
    v_and_b32 v233, 0xffff0000, v42
    v_lshlrev_b32 v234, 16, v43
    v_and_b32 v235, 0xffff0000, v43
    v_pk_fma_f32 v[228:229], v[228:229], v[204:205], v[196:197]
    v_pk_fma_f32 v[230:231], v[230:231], v[206:207], v[198:199]
    v_pk_fma_f32 v[232:233], v[232:233], v[208:209], v[200:201]
    v_pk_fma_f32 v[234:235], v[234:235], v[210:211], v[202:203]
    v_cvt_pk_bf16_f32 v40, v228, v229
    v_cvt_pk_bf16_f32 v41, v230, v231
    v_cvt_pk_bf16_f32 v42, v232, v233
    v_cvt_pk_bf16_f32 v43, v234, v235
    ds_read_b128 v[196:199], v7 offset:1024
    ds_read_b128 v[200:203], v7 offset:1040
    ds_read_b128 v[204:207], v7 offset:3328
    ds_read_b128 v[208:211], v7 offset:3344
    s_waitcnt vmcnt(16) lgkmcnt(4)
    v_lshlrev_b32 v228, 16, v44
    v_and_b32 v229, 0xffff0000, v44
    v_lshlrev_b32 v230, 16, v45
    v_and_b32 v231, 0xffff0000, v45
    v_lshlrev_b32 v232, 16, v46
    v_and_b32 v233, 0xffff0000, v46
    v_lshlrev_b32 v234, 16, v47
    v_and_b32 v235, 0xffff0000, v47
    v_pk_fma_f32 v[228:229], v[228:229], v[220:221], v[212:213]
    v_pk_fma_f32 v[230:231], v[230:231], v[222:223], v[214:215]
    v_pk_fma_f32 v[232:233], v[232:233], v[224:225], v[216:217]
    v_pk_fma_f32 v[234:235], v[234:235], v[226:227], v[218:219]
    v_cvt_pk_bf16_f32 v44, v228, v229
    v_cvt_pk_bf16_f32 v45, v230, v231
    v_cvt_pk_bf16_f32 v46, v232, v233
    v_cvt_pk_bf16_f32 v47, v234, v235
    ds_read_b128 v[212:215], v7 offset:1152
    ds_read_b128 v[216:219], v7 offset:1168
    ds_read_b128 v[220:223], v7 offset:3456
    ds_read_b128 v[224:227], v7 offset:3472
    s_waitcnt vmcnt(14) lgkmcnt(4)
    v_lshlrev_b32 v228, 16, v48
    v_and_b32 v229, 0xffff0000, v48
    v_lshlrev_b32 v230, 16, v49
    v_and_b32 v231, 0xffff0000, v49
    v_lshlrev_b32 v232, 16, v50
    v_and_b32 v233, 0xffff0000, v50
    v_lshlrev_b32 v234, 16, v51
    v_and_b32 v235, 0xffff0000, v51
    v_pk_fma_f32 v[228:229], v[228:229], v[204:205], v[196:197]
    v_pk_fma_f32 v[230:231], v[230:231], v[206:207], v[198:199]
    v_pk_fma_f32 v[232:233], v[232:233], v[208:209], v[200:201]
    v_pk_fma_f32 v[234:235], v[234:235], v[210:211], v[202:203]
    v_cvt_pk_bf16_f32 v48, v228, v229
    v_cvt_pk_bf16_f32 v49, v230, v231
    v_cvt_pk_bf16_f32 v50, v232, v233
    v_cvt_pk_bf16_f32 v51, v234, v235
    ds_read_b128 v[196:199], v7 offset:1280
    ds_read_b128 v[200:203], v7 offset:1296
    ds_read_b128 v[204:207], v7 offset:3584
    ds_read_b128 v[208:211], v7 offset:3600
    s_waitcnt vmcnt(12) lgkmcnt(4)
    v_lshlrev_b32 v228, 16, v52
    v_and_b32 v229, 0xffff0000, v52
    v_lshlrev_b32 v230, 16, v53
    v_and_b32 v231, 0xffff0000, v53
    v_lshlrev_b32 v232, 16, v54
    v_and_b32 v233, 0xffff0000, v54
    v_lshlrev_b32 v234, 16, v55
    v_and_b32 v235, 0xffff0000, v55
    v_pk_fma_f32 v[228:229], v[228:229], v[220:221], v[212:213]
    v_pk_fma_f32 v[230:231], v[230:231], v[222:223], v[214:215]
    v_pk_fma_f32 v[232:233], v[232:233], v[224:225], v[216:217]
    v_pk_fma_f32 v[234:235], v[234:235], v[226:227], v[218:219]
    v_cvt_pk_bf16_f32 v52, v228, v229
    v_cvt_pk_bf16_f32 v53, v230, v231
    v_cvt_pk_bf16_f32 v54, v232, v233
    v_cvt_pk_bf16_f32 v55, v234, v235
    ds_read_b128 v[212:215], v7 offset:1408
    ds_read_b128 v[216:219], v7 offset:1424
    ds_read_b128 v[220:223], v7 offset:3712
    ds_read_b128 v[224:227], v7 offset:3728
    s_waitcnt vmcnt(10) lgkmcnt(4)
    v_lshlrev_b32 v228, 16, v56
    v_and_b32 v229, 0xffff0000, v56
    v_lshlrev_b32 v230, 16, v57
    v_and_b32 v231, 0xffff0000, v57
    v_lshlrev_b32 v232, 16, v58
    v_and_b32 v233, 0xffff0000, v58
    v_lshlrev_b32 v234, 16, v59
    v_and_b32 v235, 0xffff0000, v59
    v_pk_fma_f32 v[228:229], v[228:229], v[204:205], v[196:197]
    v_pk_fma_f32 v[230:231], v[230:231], v[206:207], v[198:199]
    v_pk_fma_f32 v[232:233], v[232:233], v[208:209], v[200:201]
    v_pk_fma_f32 v[234:235], v[234:235], v[210:211], v[202:203]
    v_cvt_pk_bf16_f32 v56, v228, v229
    v_cvt_pk_bf16_f32 v57, v230, v231
    v_cvt_pk_bf16_f32 v58, v232, v233
    v_cvt_pk_bf16_f32 v59, v234, v235
    s_waitcnt vmcnt(8) lgkmcnt(0)
    v_lshlrev_b32 v228, 16, v60
    v_and_b32 v229, 0xffff0000, v60
    v_lshlrev_b32 v230, 16, v61
    v_and_b32 v231, 0xffff0000, v61
    v_lshlrev_b32 v232, 16, v62
    v_and_b32 v233, 0xffff0000, v62
    v_lshlrev_b32 v234, 16, v63
    v_and_b32 v235, 0xffff0000, v63
    v_pk_fma_f32 v[228:229], v[228:229], v[220:221], v[212:213]
    v_pk_fma_f32 v[230:231], v[230:231], v[222:223], v[214:215]
    v_pk_fma_f32 v[232:233], v[232:233], v[224:225], v[216:217]
    v_pk_fma_f32 v[234:235], v[234:235], v[226:227], v[218:219]
    v_cvt_pk_bf16_f32 v60, v228, v229
    v_cvt_pk_bf16_f32 v61, v230, v231
    v_cvt_pk_bf16_f32 v62, v232, v233
    v_cvt_pk_bf16_f32 v63, v234, v235
    ds_read_b128 v[124:127], v3 offset:0
    ds_read_b128 v[128:131], v3 offset:1024
    ds_read_b128 v[132:135], v3 offset:2048
    ds_read_b128 v[136:139], v3 offset:3072
    ds_read_b128 v[140:143], v3 offset:4096
    ds_read_b128 v[144:147], v3 offset:5120
    ds_read_b128 v[148:151], v3 offset:6144
    ds_read_b128 v[152:155], v3 offset:7168
    ds_read_b128 v[156:159], v3 offset:8192
    s_waitcnt lgkmcnt(6)
    v_mfma_f32_16x16x32_bf16 v[88:91], v[124:127], v[16:19], v[88:91]
    ds_read_b128 v[160:163], v3 offset:9216
    v_mfma_f32_16x16x32_bf16 v[92:95], v[128:131], v[16:19], v[92:95]
    ds_read_b128 v[164:167], v3 offset:10240
    v_mfma_f32_16x16x32_bf16 v[96:99], v[132:135], v[16:19], v[96:99]
    ds_read_b128 v[168:171], v3 offset:11264
    s_waitcnt lgkmcnt(6)
    v_mfma_f32_16x16x32_bf16 v[100:103], v[136:139], v[16:19], v[100:103]
    ds_read_b128 v[172:175], v3 offset:12288
    v_mfma_f32_16x16x32_bf16 v[104:107], v[140:143], v[16:19], v[104:107]
    ds_read_b128 v[176:179], v3 offset:13312
    v_mfma_f32_16x16x32_bf16 v[108:111], v[144:147], v[16:19], v[108:111]
    ds_read_b128 v[180:183], v3 offset:14336
    s_waitcnt lgkmcnt(6)
    v_mfma_f32_16x16x32_bf16 v[112:115], v[148:151], v[16:19], v[112:115]
    ds_read_b128 v[184:187], v3 offset:15360
    v_mfma_f32_16x16x32_bf16 v[116:119], v[152:155], v[16:19], v[116:119]
    ds_read_b128 v[188:191], v3 offset:16384
    v_mfma_f32_16x16x32_bf16 v[120:123], v[156:159], v[16:19], v[120:123]
    ds_read_b128 v[192:195], v3 offset:17408
    s_waitcnt lgkmcnt(6)
    v_mfma_f32_16x16x32_bf16 v[88:91], v[160:163], v[20:23], v[88:91]
    ds_read_b128 v[124:127], v3 offset:18432
    v_mfma_f32_16x16x32_bf16 v[92:95], v[164:167], v[20:23], v[92:95]
    ds_read_b128 v[128:131], v3 offset:19456
    v_mfma_f32_16x16x32_bf16 v[96:99], v[168:171], v[20:23], v[96:99]
    ds_read_b128 v[132:135], v3 offset:20480
    s_waitcnt lgkmcnt(6)
    v_mfma_f32_16x16x32_bf16 v[100:103], v[172:175], v[20:23], v[100:103]
    ds_read_b128 v[136:139], v3 offset:21504
    v_mfma_f32_16x16x32_bf16 v[104:107], v[176:179], v[20:23], v[104:107]
    ds_read_b128 v[140:143], v3 offset:22528
    v_mfma_f32_16x16x32_bf16 v[108:111], v[180:183], v[20:23], v[108:111]
    ds_read_b128 v[144:147], v3 offset:23552
    s_waitcnt lgkmcnt(6)
    v_mfma_f32_16x16x32_bf16 v[112:115], v[184:187], v[20:23], v[112:115]
    ds_read_b128 v[148:151], v3 offset:24576
    v_mfma_f32_16x16x32_bf16 v[116:119], v[188:191], v[20:23], v[116:119]
    ds_read_b128 v[152:155], v3 offset:25600
    v_mfma_f32_16x16x32_bf16 v[120:123], v[192:195], v[20:23], v[120:123]
    ds_read_b128 v[156:159], v3 offset:26624
    s_waitcnt lgkmcnt(6)
    v_mfma_f32_16x16x32_bf16 v[88:91], v[124:127], v[24:27], v[88:91]
    ds_read_b128 v[160:163], v3 offset:27648
    v_mfma_f32_16x16x32_bf16 v[92:95], v[128:131], v[24:27], v[92:95]
    ds_read_b128 v[164:167], v3 offset:28672
    v_mfma_f32_16x16x32_bf16 v[96:99], v[132:135], v[24:27], v[96:99]
    ds_read_b128 v[168:171], v3 offset:29696
    s_waitcnt lgkmcnt(6)
    v_mfma_f32_16x16x32_bf16 v[100:103], v[136:139], v[24:27], v[100:103]
    ds_read_b128 v[172:175], v3 offset:30720
    v_mfma_f32_16x16x32_bf16 v[104:107], v[140:143], v[24:27], v[104:107]
    ds_read_b128 v[176:179], v3 offset:31744
    v_mfma_f32_16x16x32_bf16 v[108:111], v[144:147], v[24:27], v[108:111]
    ds_read_b128 v[180:183], v3 offset:32768
    s_waitcnt lgkmcnt(6)
    v_mfma_f32_16x16x32_bf16 v[112:115], v[148:151], v[24:27], v[112:115]
    ds_read_b128 v[184:187], v3 offset:33792
    v_mfma_f32_16x16x32_bf16 v[116:119], v[152:155], v[24:27], v[116:119]
    ds_read_b128 v[188:191], v3 offset:34816
    v_mfma_f32_16x16x32_bf16 v[120:123], v[156:159], v[24:27], v[120:123]
    ds_read_b128 v[192:195], v3 offset:35840
    s_waitcnt lgkmcnt(6)
    v_mfma_f32_16x16x32_bf16 v[88:91], v[160:163], v[28:31], v[88:91]
    ds_read_b128 v[124:127], v3 offset:36864
    v_mfma_f32_16x16x32_bf16 v[92:95], v[164:167], v[28:31], v[92:95]
    ds_read_b128 v[128:131], v3 offset:37888
    v_mfma_f32_16x16x32_bf16 v[96:99], v[168:171], v[28:31], v[96:99]
    ds_read_b128 v[132:135], v3 offset:38912
    s_waitcnt lgkmcnt(6)
    v_mfma_f32_16x16x32_bf16 v[100:103], v[172:175], v[28:31], v[100:103]
    ds_read_b128 v[136:139], v3 offset:39936
    v_mfma_f32_16x16x32_bf16 v[104:107], v[176:179], v[28:31], v[104:107]
    ds_read_b128 v[140:143], v3 offset:40960
    v_mfma_f32_16x16x32_bf16 v[108:111], v[180:183], v[28:31], v[108:111]
    ds_read_b128 v[144:147], v3 offset:41984
    s_waitcnt lgkmcnt(6)
    v_mfma_f32_16x16x32_bf16 v[112:115], v[184:187], v[28:31], v[112:115]
    ds_read_b128 v[148:151], v3 offset:43008
    v_mfma_f32_16x16x32_bf16 v[116:119], v[188:191], v[28:31], v[116:119]
    ds_read_b128 v[152:155], v3 offset:44032
    v_mfma_f32_16x16x32_bf16 v[120:123], v[192:195], v[28:31], v[120:123]
    ds_read_b128 v[156:159], v3 offset:45056
    s_waitcnt lgkmcnt(6)
    v_mfma_f32_16x16x32_bf16 v[88:91], v[124:127], v[32:35], v[88:91]
    ds_read_b128 v[160:163], v3 offset:46080
    v_mfma_f32_16x16x32_bf16 v[92:95], v[128:131], v[32:35], v[92:95]
    ds_read_b128 v[164:167], v3 offset:47104
    v_mfma_f32_16x16x32_bf16 v[96:99], v[132:135], v[32:35], v[96:99]
    ds_read_b128 v[168:171], v3 offset:48128
    s_waitcnt lgkmcnt(6)
    v_mfma_f32_16x16x32_bf16 v[100:103], v[136:139], v[32:35], v[100:103]
    ds_read_b128 v[172:175], v3 offset:49152
    v_mfma_f32_16x16x32_bf16 v[104:107], v[140:143], v[32:35], v[104:107]
    ds_read_b128 v[176:179], v3 offset:50176
    v_mfma_f32_16x16x32_bf16 v[108:111], v[144:147], v[32:35], v[108:111]
    ds_read_b128 v[180:183], v3 offset:51200
    s_waitcnt lgkmcnt(6)
    v_mfma_f32_16x16x32_bf16 v[112:115], v[148:151], v[32:35], v[112:115]
    ds_read_b128 v[184:187], v3 offset:52224
    v_mfma_f32_16x16x32_bf16 v[116:119], v[152:155], v[32:35], v[116:119]
    ds_read_b128 v[188:191], v3 offset:53248
    v_mfma_f32_16x16x32_bf16 v[120:123], v[156:159], v[32:35], v[120:123]
    ds_read_b128 v[192:195], v3 offset:54272
    s_waitcnt lgkmcnt(6)
    v_mfma_f32_16x16x32_bf16 v[88:91], v[160:163], v[36:39], v[88:91]
    v_mfma_f32_16x16x32_bf16 v[92:95], v[164:167], v[36:39], v[92:95]
    v_mfma_f32_16x16x32_bf16 v[96:99], v[168:171], v[36:39], v[96:99]
    s_waitcnt lgkmcnt(3)
    v_mfma_f32_16x16x32_bf16 v[100:103], v[172:175], v[36:39], v[100:103]
    v_mfma_f32_16x16x32_bf16 v[104:107], v[176:179], v[36:39], v[104:107]
    v_mfma_f32_16x16x32_bf16 v[108:111], v[180:183], v[36:39], v[108:111]
    s_waitcnt lgkmcnt(0)
    v_mfma_f32_16x16x32_bf16 v[112:115], v[184:187], v[36:39], v[112:115]
    v_mfma_f32_16x16x32_bf16 v[116:119], v[188:191], v[36:39], v[116:119]
    v_mfma_f32_16x16x32_bf16 v[120:123], v[192:195], v[36:39], v[120:123]
    s_waitcnt vmcnt(6)
    s_barrier
    s_add_u32 m0, s23, 0
    s_add_u32 s24, s22, 110592
    buffer_load_dwordx4 v3, s[16:19], s24 offen offset:0 lds
    buffer_load_dwordx4 v3, s[16:19], s24 offen offset:1024 lds
    buffer_load_dwordx4 v3, s[16:19], s24 offen offset:2048 lds
    buffer_load_dwordx4 v3, s[16:19], s24 offen offset:3072 lds
    s_add_u32 m0, s23, 4096
    s_add_u32 s24, s22, 114688
    buffer_load_dwordx4 v3, s[16:19], s24 offen offset:0 lds
    buffer_load_dwordx4 v3, s[16:19], s24 offen offset:1024 lds
    buffer_load_dwordx4 v3, s[16:19], s24 offen offset:2048 lds
    ds_read_b128 v[196:199], v7 offset:1536
    ds_read_b128 v[200:203], v7 offset:1552
    ds_read_b128 v[204:207], v7 offset:3840
    ds_read_b128 v[208:211], v7 offset:3856
    ds_read_b128 v[212:215], v7 offset:1664
    ds_read_b128 v[216:219], v7 offset:1680
    ds_read_b128 v[220:223], v7 offset:3968
    ds_read_b128 v[224:227], v7 offset:3984
    s_waitcnt vmcnt(12) lgkmcnt(4)
    v_lshlrev_b32 v228, 16, v64
    v_and_b32 v229, 0xffff0000, v64
    v_lshlrev_b32 v230, 16, v65
    v_and_b32 v231, 0xffff0000, v65
    v_lshlrev_b32 v232, 16, v66
    v_and_b32 v233, 0xffff0000, v66
    v_lshlrev_b32 v234, 16, v67
    v_and_b32 v235, 0xffff0000, v67
    v_pk_fma_f32 v[228:229], v[228:229], v[204:205], v[196:197]
    v_pk_fma_f32 v[230:231], v[230:231], v[206:207], v[198:199]
    v_pk_fma_f32 v[232:233], v[232:233], v[208:209], v[200:201]
    v_pk_fma_f32 v[234:235], v[234:235], v[210:211], v[202:203]
    v_cvt_pk_bf16_f32 v64, v228, v229
    v_cvt_pk_bf16_f32 v65, v230, v231
    v_cvt_pk_bf16_f32 v66, v232, v233
    v_cvt_pk_bf16_f32 v67, v234, v235
    ds_read_b128 v[196:199], v7 offset:1792
    ds_read_b128 v[200:203], v7 offset:1808
    ds_read_b128 v[204:207], v7 offset:4096
    ds_read_b128 v[208:211], v7 offset:4112
    s_waitcnt vmcnt(11) lgkmcnt(4)
    v_lshlrev_b32 v228, 16, v68
    v_and_b32 v229, 0xffff0000, v68
    v_lshlrev_b32 v230, 16, v69
    v_and_b32 v231, 0xffff0000, v69
    v_lshlrev_b32 v232, 16, v70
    v_and_b32 v233, 0xffff0000, v70
    v_lshlrev_b32 v234, 16, v71
    v_and_b32 v235, 0xffff0000, v71
    v_pk_fma_f32 v[228:229], v[228:229], v[220:221], v[212:213]
    v_pk_fma_f32 v[230:231], v[230:231], v[222:223], v[214:215]
    v_pk_fma_f32 v[232:233], v[232:233], v[224:225], v[216:217]
    v_pk_fma_f32 v[234:235], v[234:235], v[226:227], v[218:219]
    v_cvt_pk_bf16_f32 v68, v228, v229
    v_cvt_pk_bf16_f32 v69, v230, v231
    v_cvt_pk_bf16_f32 v70, v232, v233
    v_cvt_pk_bf16_f32 v71, v234, v235
    ds_read_b128 v[212:215], v7 offset:1920
    ds_read_b128 v[216:219], v7 offset:1936
    ds_read_b128 v[220:223], v7 offset:4224
    ds_read_b128 v[224:227], v7 offset:4240
    s_waitcnt vmcnt(10) lgkmcnt(4)
    v_lshlrev_b32 v228, 16, v72
    v_and_b32 v229, 0xffff0000, v72
    v_lshlrev_b32 v230, 16, v73
    v_and_b32 v231, 0xffff0000, v73
    v_lshlrev_b32 v232, 16, v74
    v_and_b32 v233, 0xffff0000, v74
    v_lshlrev_b32 v234, 16, v75
    v_and_b32 v235, 0xffff0000, v75
    v_pk_fma_f32 v[228:229], v[228:229], v[204:205], v[196:197]
    v_pk_fma_f32 v[230:231], v[230:231], v[206:207], v[198:199]
    v_pk_fma_f32 v[232:233], v[232:233], v[208:209], v[200:201]
    v_pk_fma_f32 v[234:235], v[234:235], v[210:211], v[202:203]
    v_cvt_pk_bf16_f32 v72, v228, v229
    v_cvt_pk_bf16_f32 v73, v230, v231
    v_cvt_pk_bf16_f32 v74, v232, v233
    v_cvt_pk_bf16_f32 v75, v234, v235
    ds_read_b128 v[196:199], v7 offset:2048
    ds_read_b128 v[200:203], v7 offset:2064
    ds_read_b128 v[204:207], v7 offset:4352
    ds_read_b128 v[208:211], v7 offset:4368
    s_waitcnt vmcnt(9) lgkmcnt(4)
    v_lshlrev_b32 v228, 16, v76
    v_and_b32 v229, 0xffff0000, v76
    v_lshlrev_b32 v230, 16, v77
    v_and_b32 v231, 0xffff0000, v77
    v_lshlrev_b32 v232, 16, v78
    v_and_b32 v233, 0xffff0000, v78
    v_lshlrev_b32 v234, 16, v79
    v_and_b32 v235, 0xffff0000, v79
    v_pk_fma_f32 v[228:229], v[228:229], v[220:221], v[212:213]
    v_pk_fma_f32 v[230:231], v[230:231], v[222:223], v[214:215]
    v_pk_fma_f32 v[232:233], v[232:233], v[224:225], v[216:217]
    v_pk_fma_f32 v[234:235], v[234:235], v[226:227], v[218:219]
    v_cvt_pk_bf16_f32 v76, v228, v229
    v_cvt_pk_bf16_f32 v77, v230, v231
    v_cvt_pk_bf16_f32 v78, v232, v233
    v_cvt_pk_bf16_f32 v79, v234, v235
    ds_read_b128 v[212:215], v7 offset:2176
    ds_read_b128 v[216:219], v7 offset:2192
    ds_read_b128 v[220:223], v7 offset:4480
    ds_read_b128 v[224:227], v7 offset:4496
    s_waitcnt vmcnt(8) lgkmcnt(4)
    v_lshlrev_b32 v228, 16, v80
    v_and_b32 v229, 0xffff0000, v80
    v_lshlrev_b32 v230, 16, v81
    v_and_b32 v231, 0xffff0000, v81
    v_lshlrev_b32 v232, 16, v82
    v_and_b32 v233, 0xffff0000, v82
    v_lshlrev_b32 v234, 16, v83
    v_and_b32 v235, 0xffff0000, v83
    v_pk_fma_f32 v[228:229], v[228:229], v[204:205], v[196:197]
    v_pk_fma_f32 v[230:231], v[230:231], v[206:207], v[198:199]
    v_pk_fma_f32 v[232:233], v[232:233], v[208:209], v[200:201]
    v_pk_fma_f32 v[234:235], v[234:235], v[210:211], v[202:203]
    v_cvt_pk_bf16_f32 v80, v228, v229
    v_cvt_pk_bf16_f32 v81, v230, v231
    v_cvt_pk_bf16_f32 v82, v232, v233
    v_cvt_pk_bf16_f32 v83, v234, v235
    s_waitcnt vmcnt(7) lgkmcnt(0)
    v_lshlrev_b32 v228, 16, v84
    v_and_b32 v229, 0xffff0000, v84
    v_lshlrev_b32 v230, 16, v85
    v_and_b32 v231, 0xffff0000, v85
    v_lshlrev_b32 v232, 16, v86
    v_and_b32 v233, 0xffff0000, v86
    v_lshlrev_b32 v234, 16, v87
    v_and_b32 v235, 0xffff0000, v87
    v_pk_fma_f32 v[228:229], v[228:229], v[220:221], v[212:213]
    v_pk_fma_f32 v[230:231], v[230:231], v[222:223], v[214:215]
    v_pk_fma_f32 v[232:233], v[232:233], v[224:225], v[216:217]
    v_pk_fma_f32 v[234:235], v[234:235], v[226:227], v[218:219]
    v_cvt_pk_bf16_f32 v84, v228, v229
    v_cvt_pk_bf16_f32 v85, v230, v231
    v_cvt_pk_bf16_f32 v86, v232, v233
    v_cvt_pk_bf16_f32 v87, v234, v235
    ds_read_b128 v[124:127], v8 offset:0
    ds_read_b128 v[128:131], v8 offset:1024
    ds_read_b128 v[132:135], v8 offset:2048
    ds_read_b128 v[136:139], v8 offset:3072
    ds_read_b128 v[140:143], v8 offset:4096
    ds_read_b128 v[144:147], v8 offset:5120
    ds_read_b128 v[148:151], v8 offset:6144
    ds_read_b128 v[152:155], v8 offset:7168
    ds_read_b128 v[156:159], v8 offset:8192
    s_waitcnt lgkmcnt(6)
    v_mfma_f32_16x16x32_bf16 v[88:91], v[124:127], v[40:43], v[88:91]
    ds_read_b128 v[160:163], v8 offset:9216
    v_mfma_f32_16x16x32_bf16 v[92:95], v[128:131], v[40:43], v[92:95]
    ds_read_b128 v[164:167], v8 offset:10240
    v_mfma_f32_16x16x32_bf16 v[96:99], v[132:135], v[40:43], v[96:99]
    ds_read_b128 v[168:171], v8 offset:11264
    s_waitcnt lgkmcnt(6)
    v_mfma_f32_16x16x32_bf16 v[100:103], v[136:139], v[40:43], v[100:103]
    ds_read_b128 v[172:175], v8 offset:12288
    v_mfma_f32_16x16x32_bf16 v[104:107], v[140:143], v[40:43], v[104:107]
    ds_read_b128 v[176:179], v8 offset:13312
    v_mfma_f32_16x16x32_bf16 v[108:111], v[144:147], v[40:43], v[108:111]
    ds_read_b128 v[180:183], v8 offset:14336
    s_waitcnt lgkmcnt(6)
    v_mfma_f32_16x16x32_bf16 v[112:115], v[148:151], v[40:43], v[112:115]
    ds_read_b128 v[184:187], v8 offset:15360
    v_mfma_f32_16x16x32_bf16 v[116:119], v[152:155], v[40:43], v[116:119]
    ds_read_b128 v[188:191], v8 offset:16384
    v_mfma_f32_16x16x32_bf16 v[120:123], v[156:159], v[40:43], v[120:123]
    ds_read_b128 v[192:195], v8 offset:17408
    s_waitcnt lgkmcnt(6)
    v_mfma_f32_16x16x32_bf16 v[88:91], v[160:163], v[44:47], v[88:91]
    ds_read_b128 v[124:127], v8 offset:18432
    v_mfma_f32_16x16x32_bf16 v[92:95], v[164:167], v[44:47], v[92:95]
    ds_read_b128 v[128:131], v8 offset:19456
    v_mfma_f32_16x16x32_bf16 v[96:99], v[168:171], v[44:47], v[96:99]
    ds_read_b128 v[132:135], v8 offset:20480
    s_waitcnt lgkmcnt(6)
    v_mfma_f32_16x16x32_bf16 v[100:103], v[172:175], v[44:47], v[100:103]
    ds_read_b128 v[136:139], v8 offset:21504
    v_mfma_f32_16x16x32_bf16 v[104:107], v[176:179], v[44:47], v[104:107]
    ds_read_b128 v[140:143], v8 offset:22528
    v_mfma_f32_16x16x32_bf16 v[108:111], v[180:183], v[44:47], v[108:111]
    ds_read_b128 v[144:147], v8 offset:23552
    s_waitcnt lgkmcnt(6)
    v_mfma_f32_16x16x32_bf16 v[112:115], v[184:187], v[44:47], v[112:115]
    ds_read_b128 v[148:151], v8 offset:24576
    v_mfma_f32_16x16x32_bf16 v[116:119], v[188:191], v[44:47], v[116:119]
    ds_read_b128 v[152:155], v8 offset:25600
    v_mfma_f32_16x16x32_bf16 v[120:123], v[192:195], v[44:47], v[120:123]
    ds_read_b128 v[156:159], v8 offset:26624
    s_waitcnt lgkmcnt(6)
    v_mfma_f32_16x16x32_bf16 v[88:91], v[124:127], v[48:51], v[88:91]
    ds_read_b128 v[160:163], v8 offset:27648
    v_mfma_f32_16x16x32_bf16 v[92:95], v[128:131], v[48:51], v[92:95]
    ds_read_b128 v[164:167], v8 offset:28672
    v_mfma_f32_16x16x32_bf16 v[96:99], v[132:135], v[48:51], v[96:99]
    ds_read_b128 v[168:171], v8 offset:29696
    s_waitcnt lgkmcnt(6)
    v_mfma_f32_16x16x32_bf16 v[100:103], v[136:139], v[48:51], v[100:103]
    ds_read_b128 v[172:175], v8 offset:30720
    v_mfma_f32_16x16x32_bf16 v[104:107], v[140:143], v[48:51], v[104:107]
    ds_read_b128 v[176:179], v8 offset:31744
    v_mfma_f32_16x16x32_bf16 v[108:111], v[144:147], v[48:51], v[108:111]
    ds_read_b128 v[180:183], v8 offset:32768
    s_waitcnt lgkmcnt(6)
    v_mfma_f32_16x16x32_bf16 v[112:115], v[148:151], v[48:51], v[112:115]
    ds_read_b128 v[184:187], v8 offset:33792
    v_mfma_f32_16x16x32_bf16 v[116:119], v[152:155], v[48:51], v[116:119]
    ds_read_b128 v[188:191], v8 offset:34816
    v_mfma_f32_16x16x32_bf16 v[120:123], v[156:159], v[48:51], v[120:123]
    ds_read_b128 v[192:195], v8 offset:35840
    s_waitcnt lgkmcnt(6)
    v_mfma_f32_16x16x32_bf16 v[88:91], v[160:163], v[52:55], v[88:91]
    ds_read_b128 v[124:127], v8 offset:36864
    v_mfma_f32_16x16x32_bf16 v[92:95], v[164:167], v[52:55], v[92:95]
    ds_read_b128 v[128:131], v8 offset:37888
    v_mfma_f32_16x16x32_bf16 v[96:99], v[168:171], v[52:55], v[96:99]
    ds_read_b128 v[132:135], v8 offset:38912
    s_waitcnt lgkmcnt(6)
    v_mfma_f32_16x16x32_bf16 v[100:103], v[172:175], v[52:55], v[100:103]
    ds_read_b128 v[136:139], v8 offset:39936
    v_mfma_f32_16x16x32_bf16 v[104:107], v[176:179], v[52:55], v[104:107]
    ds_read_b128 v[140:143], v8 offset:40960
    v_mfma_f32_16x16x32_bf16 v[108:111], v[180:183], v[52:55], v[108:111]
    ds_read_b128 v[144:147], v8 offset:41984
    s_waitcnt lgkmcnt(6)
    v_mfma_f32_16x16x32_bf16 v[112:115], v[184:187], v[52:55], v[112:115]
    ds_read_b128 v[148:151], v8 offset:43008
    v_mfma_f32_16x16x32_bf16 v[116:119], v[188:191], v[52:55], v[116:119]
    ds_read_b128 v[152:155], v8 offset:44032
    v_mfma_f32_16x16x32_bf16 v[120:123], v[192:195], v[52:55], v[120:123]
    ds_read_b128 v[156:159], v8 offset:45056
    s_waitcnt lgkmcnt(6)
    v_mfma_f32_16x16x32_bf16 v[88:91], v[124:127], v[56:59], v[88:91]
    ds_read_b128 v[160:163], v8 offset:46080
    v_mfma_f32_16x16x32_bf16 v[92:95], v[128:131], v[56:59], v[92:95]
    ds_read_b128 v[164:167], v8 offset:47104
    v_mfma_f32_16x16x32_bf16 v[96:99], v[132:135], v[56:59], v[96:99]
    ds_read_b128 v[168:171], v8 offset:48128
    s_waitcnt lgkmcnt(6)
    v_mfma_f32_16x16x32_bf16 v[100:103], v[136:139], v[56:59], v[100:103]
    ds_read_b128 v[172:175], v8 offset:49152
    v_mfma_f32_16x16x32_bf16 v[104:107], v[140:143], v[56:59], v[104:107]
    ds_read_b128 v[176:179], v8 offset:50176
    v_mfma_f32_16x16x32_bf16 v[108:111], v[144:147], v[56:59], v[108:111]
    ds_read_b128 v[180:183], v8 offset:51200
    s_waitcnt lgkmcnt(6)
    v_mfma_f32_16x16x32_bf16 v[112:115], v[148:151], v[56:59], v[112:115]
    ds_read_b128 v[184:187], v8 offset:52224
    v_mfma_f32_16x16x32_bf16 v[116:119], v[152:155], v[56:59], v[116:119]
    ds_read_b128 v[188:191], v8 offset:53248
    v_mfma_f32_16x16x32_bf16 v[120:123], v[156:159], v[56:59], v[120:123]
    ds_read_b128 v[192:195], v8 offset:54272
    s_waitcnt lgkmcnt(6)
    v_mfma_f32_16x16x32_bf16 v[88:91], v[160:163], v[60:63], v[88:91]
    v_mfma_f32_16x16x32_bf16 v[92:95], v[164:167], v[60:63], v[92:95]
    v_mfma_f32_16x16x32_bf16 v[96:99], v[168:171], v[60:63], v[96:99]
    s_waitcnt lgkmcnt(3)
    v_mfma_f32_16x16x32_bf16 v[100:103], v[172:175], v[60:63], v[100:103]
    v_mfma_f32_16x16x32_bf16 v[104:107], v[176:179], v[60:63], v[104:107]
    v_mfma_f32_16x16x32_bf16 v[108:111], v[180:183], v[60:63], v[108:111]
    s_waitcnt lgkmcnt(0)
    v_mfma_f32_16x16x32_bf16 v[112:115], v[184:187], v[60:63], v[112:115]
    v_mfma_f32_16x16x32_bf16 v[116:119], v[188:191], v[60:63], v[116:119]
    v_mfma_f32_16x16x32_bf16 v[120:123], v[192:195], v[60:63], v[120:123]
    s_waitcnt vmcnt(0)
    s_barrier
    ds_read_b128 v[124:127], v3 offset:0
    ds_read_b128 v[128:131], v3 offset:1024
    ds_read_b128 v[132:135], v3 offset:2048
    ds_read_b128 v[136:139], v3 offset:3072
    ds_read_b128 v[140:143], v3 offset:4096
    ds_read_b128 v[144:147], v3 offset:5120
    ds_read_b128 v[148:151], v3 offset:6144
    ds_read_b128 v[152:155], v3 offset:7168
    ds_read_b128 v[156:159], v3 offset:8192
    s_waitcnt lgkmcnt(6)
    v_mfma_f32_16x16x32_bf16 v[88:91], v[124:127], v[64:67], v[88:91]
    ds_read_b128 v[160:163], v3 offset:9216
    v_mfma_f32_16x16x32_bf16 v[92:95], v[128:131], v[64:67], v[92:95]
    ds_read_b128 v[164:167], v3 offset:10240
    v_mfma_f32_16x16x32_bf16 v[96:99], v[132:135], v[64:67], v[96:99]
    ds_read_b128 v[168:171], v3 offset:11264
    s_waitcnt lgkmcnt(6)
    v_mfma_f32_16x16x32_bf16 v[100:103], v[136:139], v[64:67], v[100:103]
    ds_read_b128 v[172:175], v3 offset:12288
    v_mfma_f32_16x16x32_bf16 v[104:107], v[140:143], v[64:67], v[104:107]
    ds_read_b128 v[176:179], v3 offset:13312
    v_mfma_f32_16x16x32_bf16 v[108:111], v[144:147], v[64:67], v[108:111]
    ds_read_b128 v[180:183], v3 offset:14336
    s_waitcnt lgkmcnt(6)
    v_mfma_f32_16x16x32_bf16 v[112:115], v[148:151], v[64:67], v[112:115]
    ds_read_b128 v[184:187], v3 offset:15360
    v_mfma_f32_16x16x32_bf16 v[116:119], v[152:155], v[64:67], v[116:119]
    ds_read_b128 v[188:191], v3 offset:16384
    v_mfma_f32_16x16x32_bf16 v[120:123], v[156:159], v[64:67], v[120:123]
    ds_read_b128 v[192:195], v3 offset:17408
    s_waitcnt lgkmcnt(6)
    v_mfma_f32_16x16x32_bf16 v[88:91], v[160:163], v[68:71], v[88:91]
    ds_read_b128 v[124:127], v3 offset:18432
    v_mfma_f32_16x16x32_bf16 v[92:95], v[164:167], v[68:71], v[92:95]
    ds_read_b128 v[128:131], v3 offset:19456
    v_mfma_f32_16x16x32_bf16 v[96:99], v[168:171], v[68:71], v[96:99]
    ds_read_b128 v[132:135], v3 offset:20480
    s_waitcnt lgkmcnt(6)
    v_mfma_f32_16x16x32_bf16 v[100:103], v[172:175], v[68:71], v[100:103]
    ds_read_b128 v[136:139], v3 offset:21504
    v_mfma_f32_16x16x32_bf16 v[104:107], v[176:179], v[68:71], v[104:107]
    ds_read_b128 v[140:143], v3 offset:22528
    v_mfma_f32_16x16x32_bf16 v[108:111], v[180:183], v[68:71], v[108:111]
    ds_read_b128 v[144:147], v3 offset:23552
    s_waitcnt lgkmcnt(6)
    v_mfma_f32_16x16x32_bf16 v[112:115], v[184:187], v[68:71], v[112:115]
    ds_read_b128 v[148:151], v3 offset:24576
    v_mfma_f32_16x16x32_bf16 v[116:119], v[188:191], v[68:71], v[116:119]
    ds_read_b128 v[152:155], v3 offset:25600
    v_mfma_f32_16x16x32_bf16 v[120:123], v[192:195], v[68:71], v[120:123]
    ds_read_b128 v[156:159], v3 offset:26624
    s_waitcnt lgkmcnt(6)
    v_mfma_f32_16x16x32_bf16 v[88:91], v[124:127], v[72:75], v[88:91]
    ds_read_b128 v[160:163], v3 offset:27648
    v_mfma_f32_16x16x32_bf16 v[92:95], v[128:131], v[72:75], v[92:95]
    ds_read_b128 v[164:167], v3 offset:28672
    v_mfma_f32_16x16x32_bf16 v[96:99], v[132:135], v[72:75], v[96:99]
    ds_read_b128 v[168:171], v3 offset:29696
    s_waitcnt lgkmcnt(6)
    v_mfma_f32_16x16x32_bf16 v[100:103], v[136:139], v[72:75], v[100:103]
    ds_read_b128 v[172:175], v3 offset:30720
    v_mfma_f32_16x16x32_bf16 v[104:107], v[140:143], v[72:75], v[104:107]
    ds_read_b128 v[176:179], v3 offset:31744
    v_mfma_f32_16x16x32_bf16 v[108:111], v[144:147], v[72:75], v[108:111]
    ds_read_b128 v[180:183], v3 offset:32768
    s_waitcnt lgkmcnt(6)
    v_mfma_f32_16x16x32_bf16 v[112:115], v[148:151], v[72:75], v[112:115]
    ds_read_b128 v[184:187], v3 offset:33792
    v_mfma_f32_16x16x32_bf16 v[116:119], v[152:155], v[72:75], v[116:119]
    ds_read_b128 v[188:191], v3 offset:34816
    v_mfma_f32_16x16x32_bf16 v[120:123], v[156:159], v[72:75], v[120:123]
    ds_read_b128 v[192:195], v3 offset:35840
    s_waitcnt lgkmcnt(6)
    v_mfma_f32_16x16x32_bf16 v[88:91], v[160:163], v[76:79], v[88:91]
    ds_read_b128 v[124:127], v3 offset:36864
    v_mfma_f32_16x16x32_bf16 v[92:95], v[164:167], v[76:79], v[92:95]
    ds_read_b128 v[128:131], v3 offset:37888
    v_mfma_f32_16x16x32_bf16 v[96:99], v[168:171], v[76:79], v[96:99]
    ds_read_b128 v[132:135], v3 offset:38912
    s_waitcnt lgkmcnt(6)
    v_mfma_f32_16x16x32_bf16 v[100:103], v[172:175], v[76:79], v[100:103]
    ds_read_b128 v[136:139], v3 offset:39936
    v_mfma_f32_16x16x32_bf16 v[104:107], v[176:179], v[76:79], v[104:107]
    ds_read_b128 v[140:143], v3 offset:40960
    v_mfma_f32_16x16x32_bf16 v[108:111], v[180:183], v[76:79], v[108:111]
    ds_read_b128 v[144:147], v3 offset:41984
    s_waitcnt lgkmcnt(6)
    v_mfma_f32_16x16x32_bf16 v[112:115], v[184:187], v[76:79], v[112:115]
    ds_read_b128 v[148:151], v3 offset:43008
    v_mfma_f32_16x16x32_bf16 v[116:119], v[188:191], v[76:79], v[116:119]
    ds_read_b128 v[152:155], v3 offset:44032
    v_mfma_f32_16x16x32_bf16 v[120:123], v[192:195], v[76:79], v[120:123]
    ds_read_b128 v[156:159], v3 offset:45056
    s_waitcnt lgkmcnt(6)
    v_mfma_f32_16x16x32_bf16 v[88:91], v[124:127], v[80:83], v[88:91]
    ds_read_b128 v[160:163], v3 offset:46080
    v_mfma_f32_16x16x32_bf16 v[92:95], v[128:131], v[80:83], v[92:95]
    ds_read_b128 v[164:167], v3 offset:47104
    v_mfma_f32_16x16x32_bf16 v[96:99], v[132:135], v[80:83], v[96:99]
    ds_read_b128 v[168:171], v3 offset:48128
    s_waitcnt lgkmcnt(6)
    v_mfma_f32_16x16x32_bf16 v[100:103], v[136:139], v[80:83], v[100:103]
    ds_read_b128 v[172:175], v3 offset:49152
    v_mfma_f32_16x16x32_bf16 v[104:107], v[140:143], v[80:83], v[104:107]
    ds_read_b128 v[176:179], v3 offset:50176
    v_mfma_f32_16x16x32_bf16 v[108:111], v[144:147], v[80:83], v[108:111]
    ds_read_b128 v[180:183], v3 offset:51200
    s_waitcnt lgkmcnt(6)
    v_mfma_f32_16x16x32_bf16 v[112:115], v[148:151], v[80:83], v[112:115]
    ds_read_b128 v[184:187], v3 offset:52224
    v_mfma_f32_16x16x32_bf16 v[116:119], v[152:155], v[80:83], v[116:119]
    ds_read_b128 v[188:191], v3 offset:53248
    v_mfma_f32_16x16x32_bf16 v[120:123], v[156:159], v[80:83], v[120:123]
    ds_read_b128 v[192:195], v3 offset:54272
    s_waitcnt lgkmcnt(6)
    v_mfma_f32_16x16x32_bf16 v[88:91], v[160:163], v[84:87], v[88:91]
    v_mfma_f32_16x16x32_bf16 v[92:95], v[164:167], v[84:87], v[92:95]
    v_mfma_f32_16x16x32_bf16 v[96:99], v[168:171], v[84:87], v[96:99]
    s_waitcnt lgkmcnt(3)
    v_mfma_f32_16x16x32_bf16 v[100:103], v[172:175], v[84:87], v[100:103]
    v_mfma_f32_16x16x32_bf16 v[104:107], v[176:179], v[84:87], v[104:107]
    v_mfma_f32_16x16x32_bf16 v[108:111], v[180:183], v[84:87], v[108:111]
    s_waitcnt lgkmcnt(0)
    v_mfma_f32_16x16x32_bf16 v[112:115], v[184:187], v[84:87], v[112:115]
    v_mfma_f32_16x16x32_bf16 v[116:119], v[188:191], v[84:87], v[116:119]
    v_mfma_f32_16x16x32_bf16 v[120:123], v[192:195], v[84:87], v[120:123]
L_grpJ_14:
    s_nop 7
    v_and_b32 v9, 15, v2
    v_lshrrev_b32 v10, 1, v6
    v_and_b32 v11, 1, v6
    v_lshlrev_b32 v12, 9, v10
    v_lshl_add_u32 v12, v9, 4, v12
    v_lshl_add_u32 v12, v11, 3, v12
    s_lshr_b32 s25, s6, 1
    s_and_b32 s26, s6, 1
    s_cmp_ge_u32 s7, 4
    s_cbranch_scc1 L_ktype_15
    s_add_u32 s8, s4, 15687680
    s_addc_u32 s9, s5, 0
    s_and_b32 s9, s9, 0xffff
    s_mov_b32 s10, 2097152
    s_mov_b32 s11, 0x20000
    s_add_u32 s12, s4, 17784832
    s_addc_u32 s13, s5, 0
    s_and_b32 s13, s13, 0xffff
    s_mov_b32 s14, 262144
    s_mov_b32 s15, 0x20000
    s_mov_b32 s27, 0x3eae1a93
    v_mul_f32 v88, s27, v88
    v_mul_f32 v89, s27, v89
    v_mul_f32 v90, s27, v90
    v_mul_f32 v91, s27, v91
    v_mul_f32 v92, s27, v92
    v_mul_f32 v93, s27, v93
    v_mul_f32 v94, s27, v94
    v_mul_f32 v95, s27, v95
    v_mul_f32 v96, s27, v96
    v_mul_f32 v97, s27, v97
    v_mul_f32 v98, s27, v98
    v_mul_f32 v99, s27, v99
    v_mul_f32 v100, s27, v100
    v_mul_f32 v101, s27, v101
    v_mul_f32 v102, s27, v102
    v_mul_f32 v103, s27, v103
    v_mul_f32 v104, s27, v104
    v_mul_f32 v105, s27, v105
    v_mul_f32 v106, s27, v106
    v_mul_f32 v107, s27, v107
    v_mul_f32 v108, s27, v108
    v_mul_f32 v109, s27, v109
    v_mul_f32 v110, s27, v110
    v_mul_f32 v111, s27, v111
    v_mul_f32 v112, s27, v112
    v_mul_f32 v113, s27, v113
    v_mul_f32 v114, s27, v114
    v_mul_f32 v115, s27, v115
    v_mul_f32 v116, s27, v116
    v_mul_f32 v117, s27, v117
    v_mul_f32 v118, s27, v118
    v_mul_f32 v119, s27, v119
    v_mul_f32 v120, s27, v120
    v_mul_f32 v121, s27, v121
    v_mul_f32 v122, s27, v122
    v_mul_f32 v123, s27, v123
    v_cvt_pk_bf16_f32 v124, v88, v89
    v_cvt_pk_bf16_f32 v125, v90, v91
    v_cvt_pk_bf16_f32 v126, v92, v93
    v_cvt_pk_bf16_f32 v127, v94, v95
    v_cvt_pk_bf16_f32 v128, v96, v97
    v_cvt_pk_bf16_f32 v129, v98, v99
    v_cvt_pk_bf16_f32 v130, v100, v101
    v_cvt_pk_bf16_f32 v131, v102, v103
    v_cvt_pk_bf16_f32 v132, v104, v105
    v_cvt_pk_bf16_f32 v133, v106, v107
    v_cvt_pk_bf16_f32 v134, v108, v109
    v_cvt_pk_bf16_f32 v135, v110, v111
    v_cvt_pk_bf16_f32 v136, v112, v113
    v_cvt_pk_bf16_f32 v137, v114, v115
    v_cvt_pk_bf16_f32 v138, v116, v117
    v_cvt_pk_bf16_f32 v139, v118, v119
    v_cvt_pk_bf16_f32 v140, v120, v121
    v_cvt_pk_bf16_f32 v141, v122, v123
    s_lshl_b32 s28, s7, 3
    s_lshl_b32 s29, s28, 6
    s_add_u32 s29, s29, s25
    s_lshl_b32 s29, s29, 10
    s_lshl_b32 s30, s26, 8
    s_add_u32 s29, s29, s30
    buffer_store_dwordx2 v[124:125], v12, s[8:11], s29 offen
    s_add_u32 s29, s29, 65536
    buffer_store_dwordx2 v[126:127], v12, s[8:11], s29 offen
    s_add_u32 s29, s29, 65536
    buffer_store_dwordx2 v[128:129], v12, s[8:11], s29 offen
    s_add_u32 s29, s29, 65536
    buffer_store_dwordx2 v[130:131], v12, s[8:11], s29 offen
    s_add_u32 s29, s29, 65536
    buffer_store_dwordx2 v[132:133], v12, s[8:11], s29 offen
    s_add_u32 s29, s29, 65536
    buffer_store_dwordx2 v[134:135], v12, s[8:11], s29 offen
    s_add_u32 s29, s29, 65536
    buffer_store_dwordx2 v[136:137], v12, s[8:11], s29 offen
    s_add_u32 s29, s29, 65536
    buffer_store_dwordx2 v[138:139], v12, s[8:11], s29 offen
    v_lshlrev_b32 v13, 14, v6
    v_lshl_add_u32 v13, v9, 2, v13
    s_lshl_b32 s29, s28, 13
    s_lshl_b32 s30, s6, 6
    s_add_u32 s29, s29, s30
    buffer_store_dword v140, v13, s[12:15], s29 offen
    s_add_u32 s29, s29, 8192
    buffer_store_dword v141, v13, s[12:15], s29 offen
    s_branch L_end_8
L_ktype_15:
    s_add_u32 s8, s4, 18046976
    s_addc_u32 s9, s5, 0
    s_and_b32 s9, s9, 0xffff
    s_mov_b32 s10, 4849664
    s_mov_b32 s11, 0x20000
    v_cvt_pk_bf16_f32 v124, v88, v89
    v_cvt_pk_bf16_f32 v125, v90, v91
    v_cvt_pk_bf16_f32 v126, v92, v93
    v_cvt_pk_bf16_f32 v127, v94, v95
    v_cvt_pk_bf16_f32 v128, v96, v97
    v_cvt_pk_bf16_f32 v129, v98, v99
    v_cvt_pk_bf16_f32 v130, v100, v101
    v_cvt_pk_bf16_f32 v131, v102, v103
    v_cvt_pk_bf16_f32 v132, v104, v105
    v_cvt_pk_bf16_f32 v133, v106, v107
    v_cvt_pk_bf16_f32 v134, v108, v109
    v_cvt_pk_bf16_f32 v135, v110, v111
    v_cvt_pk_bf16_f32 v136, v112, v113
    v_cvt_pk_bf16_f32 v137, v114, v115
    v_cvt_pk_bf16_f32 v138, v116, v117
    v_cvt_pk_bf16_f32 v139, v118, v119
    v_cvt_pk_bf16_f32 v140, v120, v121
    v_cvt_pk_bf16_f32 v141, v122, v123
    s_sub_u32 s28, s7, 4
    s_lshl_b32 s28, s28, 9
    s_add_u32 s28, s28, s25
    s_mul_i32 s28, s28, 2368
    s_lshl_b32 s30, s26, 8
    s_add_u32 s29, s28, s30
    buffer_store_dwordx2 v[124:125], v12, s[8:11], s29 offen
    s_add_u32 s29, s29, 151552
    buffer_store_dwordx2 v[126:127], v12, s[8:11], s29 offen
    s_add_u32 s29, s29, 151552
    buffer_store_dwordx2 v[128:129], v12, s[8:11], s29 offen
    s_add_u32 s29, s29, 151552
    buffer_store_dwordx2 v[130:131], v12, s[8:11], s29 offen
    s_add_u32 s29, s29, 151552
    buffer_store_dwordx2 v[132:133], v12, s[8:11], s29 offen
    s_add_u32 s29, s29, 151552
    buffer_store_dwordx2 v[134:135], v12, s[8:11], s29 offen
    s_add_u32 s29, s29, 151552
    buffer_store_dwordx2 v[136:137], v12, s[8:11], s29 offen
    s_add_u32 s29, s29, 151552
    buffer_store_dwordx2 v[138:139], v12, s[8:11], s29 offen
    v_mul_u32_u24 v13, 303104, v6
    v_lshl_add_u32 v13, v9, 2, v13
    s_lshl_b32 s30, s26, 6
    s_add_u32 s29, s28, s30
    s_add_u32 s29, s29, 1024
    buffer_store_dword v140, v13, s[8:11], s29 offen
    s_add_u32 s29, s29, 151552
    buffer_store_dword v141, v13, s[8:11], s29 offen
    s_branch L_end_8
L_vtype_12:
    ds_read_b128 v[196:199], v7 offset:0
    ds_read_b128 v[200:203], v7 offset:16
    ds_read_b128 v[204:207], v7 offset:2304
    ds_read_b128 v[208:211], v7 offset:2320
    ds_read_b128 v[212:215], v7 offset:128
    ds_read_b128 v[216:219], v7 offset:144
    ds_read_b128 v[220:223], v7 offset:2432
    ds_read_b128 v[224:227], v7 offset:2448
    s_add_u32 s25, s21, 4096
    buffer_load_dwordx4 v[40:43], v3, s[12:15], s25 offen offset:2048
    s_add_u32 m0, s23, 57344
    s_add_u32 s24, s22, 55296
    buffer_load_dwordx4 v3, s[16:19], s24 offen lds
    s_waitcnt vmcnt(14) lgkmcnt(4)
    v_lshlrev_b32 v228, 16, v16
    v_and_b32 v229, 0xffff0000, v16
    v_lshlrev_b32 v230, 16, v17
    v_and_b32 v231, 0xffff0000, v17
    v_lshlrev_b32 v232, 16, v18
    v_and_b32 v233, 0xffff0000, v18
    v_lshlrev_b32 v234, 16, v19
    v_and_b32 v235, 0xffff0000, v19
    v_pk_fma_f32 v[228:229], v[228:229], v[204:205], v[196:197]
    v_pk_fma_f32 v[230:231], v[230:231], v[206:207], v[198:199]
    v_pk_fma_f32 v[232:233], v[232:233], v[208:209], v[200:201]
    v_pk_fma_f32 v[234:235], v[234:235], v[210:211], v[202:203]
    v_cvt_pk_bf16_f32 v16, v228, v229
    v_cvt_pk_bf16_f32 v17, v230, v231
    v_cvt_pk_bf16_f32 v18, v232, v233
    v_cvt_pk_bf16_f32 v19, v234, v235
    ds_read_b128 v[196:199], v7 offset:256
    ds_read_b128 v[200:203], v7 offset:272
    ds_read_b128 v[204:207], v7 offset:2560
    ds_read_b128 v[208:211], v7 offset:2576
    s_add_u32 s25, s21, 4096
    buffer_load_dwordx4 v[44:47], v3, s[12:15], s25 offen offset:3072
    s_add_u32 m0, s23, 58368
    s_add_u32 s24, s22, 56320
    buffer_load_dwordx4 v3, s[16:19], s24 offen lds
    s_waitcnt vmcnt(15) lgkmcnt(4)
    v_lshlrev_b32 v228, 16, v20
    v_and_b32 v229, 0xffff0000, v20
    v_lshlrev_b32 v230, 16, v21
    v_and_b32 v231, 0xffff0000, v21
    v_lshlrev_b32 v232, 16, v22
    v_and_b32 v233, 0xffff0000, v22
    v_lshlrev_b32 v234, 16, v23
    v_and_b32 v235, 0xffff0000, v23
    v_pk_fma_f32 v[228:229], v[228:229], v[220:221], v[212:213]
    v_pk_fma_f32 v[230:231], v[230:231], v[222:223], v[214:215]
    v_pk_fma_f32 v[232:233], v[232:233], v[224:225], v[216:217]
    v_pk_fma_f32 v[234:235], v[234:235], v[226:227], v[218:219]
    v_cvt_pk_bf16_f32 v20, v228, v229
    v_cvt_pk_bf16_f32 v21, v230, v231
    v_cvt_pk_bf16_f32 v22, v232, v233
    v_cvt_pk_bf16_f32 v23, v234, v235
    ds_read_b128 v[212:215], v7 offset:384
    ds_read_b128 v[216:219], v7 offset:400
    ds_read_b128 v[220:223], v7 offset:2688
    ds_read_b128 v[224:227], v7 offset:2704
    s_add_u32 s25, s21, 8192
    buffer_load_dwordx4 v[48:51], v3, s[12:15], s25 offen offset:0
    s_add_u32 m0, s23, 59392
    s_add_u32 s24, s22, 57344
    buffer_load_dwordx4 v3, s[16:19], s24 offen lds
    s_waitcnt vmcnt(16) lgkmcnt(4)
    v_lshlrev_b32 v228, 16, v24
    v_and_b32 v229, 0xffff0000, v24
    v_lshlrev_b32 v230, 16, v25
    v_and_b32 v231, 0xffff0000, v25
    v_lshlrev_b32 v232, 16, v26
    v_and_b32 v233, 0xffff0000, v26
    v_lshlrev_b32 v234, 16, v27
    v_and_b32 v235, 0xffff0000, v27
    v_pk_fma_f32 v[228:229], v[228:229], v[204:205], v[196:197]
    v_pk_fma_f32 v[230:231], v[230:231], v[206:207], v[198:199]
    v_pk_fma_f32 v[232:233], v[232:233], v[208:209], v[200:201]
    v_pk_fma_f32 v[234:235], v[234:235], v[210:211], v[202:203]
    v_cvt_pk_bf16_f32 v24, v228, v229
    v_cvt_pk_bf16_f32 v25, v230, v231
    v_cvt_pk_bf16_f32 v26, v232, v233
    v_cvt_pk_bf16_f32 v27, v234, v235
    ds_read_b128 v[196:199], v7 offset:512
    ds_read_b128 v[200:203], v7 offset:528
    ds_read_b128 v[204:207], v7 offset:2816
    ds_read_b128 v[208:211], v7 offset:2832
    s_add_u32 s25, s21, 8192
    buffer_load_dwordx4 v[52:55], v3, s[12:15], s25 offen offset:1024
    s_add_u32 m0, s23, 60416
    s_add_u32 s24, s22, 58368
    buffer_load_dwordx4 v3, s[16:19], s24 offen lds
    s_waitcnt vmcnt(17) lgkmcnt(4)
    v_lshlrev_b32 v228, 16, v28
    v_and_b32 v229, 0xffff0000, v28
    v_lshlrev_b32 v230, 16, v29
    v_and_b32 v231, 0xffff0000, v29
    v_lshlrev_b32 v232, 16, v30
    v_and_b32 v233, 0xffff0000, v30
    v_lshlrev_b32 v234, 16, v31
    v_and_b32 v235, 0xffff0000, v31
    v_pk_fma_f32 v[228:229], v[228:229], v[220:221], v[212:213]
    v_pk_fma_f32 v[230:231], v[230:231], v[222:223], v[214:215]
    v_pk_fma_f32 v[232:233], v[232:233], v[224:225], v[216:217]
    v_pk_fma_f32 v[234:235], v[234:235], v[226:227], v[218:219]
    v_cvt_pk_bf16_f32 v28, v228, v229
    v_cvt_pk_bf16_f32 v29, v230, v231
    v_cvt_pk_bf16_f32 v30, v232, v233
    v_cvt_pk_bf16_f32 v31, v234, v235
    ds_read_b128 v[212:215], v7 offset:640
    ds_read_b128 v[216:219], v7 offset:656
    ds_read_b128 v[220:223], v7 offset:2944
    ds_read_b128 v[224:227], v7 offset:2960
    s_add_u32 s25, s21, 8192
    buffer_load_dwordx4 v[56:59], v3, s[12:15], s25 offen offset:2048
    s_add_u32 m0, s23, 61440
    s_add_u32 s24, s22, 59392
    buffer_load_dwordx4 v3, s[16:19], s24 offen lds
    s_waitcnt vmcnt(18) lgkmcnt(4)
    v_lshlrev_b32 v228, 16, v32
    v_and_b32 v229, 0xffff0000, v32
    v_lshlrev_b32 v230, 16, v33
    v_and_b32 v231, 0xffff0000, v33
    v_lshlrev_b32 v232, 16, v34
    v_and_b32 v233, 0xffff0000, v34
    v_lshlrev_b32 v234, 16, v35
    v_and_b32 v235, 0xffff0000, v35
    v_pk_fma_f32 v[228:229], v[228:229], v[204:205], v[196:197]
    v_pk_fma_f32 v[230:231], v[230:231], v[206:207], v[198:199]
    v_pk_fma_f32 v[232:233], v[232:233], v[208:209], v[200:201]
    v_pk_fma_f32 v[234:235], v[234:235], v[210:211], v[202:203]
    v_cvt_pk_bf16_f32 v32, v228, v229
    v_cvt_pk_bf16_f32 v33, v230, v231
    v_cvt_pk_bf16_f32 v34, v232, v233
    v_cvt_pk_bf16_f32 v35, v234, v235
    s_add_u32 s25, s21, 8192
    buffer_load_dwordx4 v[60:63], v3, s[12:15], s25 offen offset:3072
    s_add_u32 m0, s23, 62464
    s_add_u32 s24, s22, 60416
    buffer_load_dwordx4 v3, s[16:19], s24 offen lds
    s_add_u32 m0, s23, 63488
    s_add_u32 s24, s22, 61440
    buffer_load_dwordx4 v3, s[16:19], s24 offen lds
    s_waitcnt vmcnt(20) lgkmcnt(0)
    v_lshlrev_b32 v228, 16, v36
    v_and_b32 v229, 0xffff0000, v36
    v_lshlrev_b32 v230, 16, v37
    v_and_b32 v231, 0xffff0000, v37
    v_lshlrev_b32 v232, 16, v38
    v_and_b32 v233, 0xffff0000, v38
    v_lshlrev_b32 v234, 16, v39
    v_and_b32 v235, 0xffff0000, v39
    v_pk_fma_f32 v[228:229], v[228:229], v[220:221], v[212:213]
    v_pk_fma_f32 v[230:231], v[230:231], v[222:223], v[214:215]
    v_pk_fma_f32 v[232:233], v[232:233], v[224:225], v[216:217]
    v_pk_fma_f32 v[234:235], v[234:235], v[226:227], v[218:219]
    v_cvt_pk_bf16_f32 v36, v228, v229
    v_cvt_pk_bf16_f32 v37, v230, v231
    v_cvt_pk_bf16_f32 v38, v232, v233
    v_cvt_pk_bf16_f32 v39, v234, v235
    s_cmp_ge_u32 s3, 4
    s_cbranch_scc1 L_grpB_16
    s_waitcnt vmcnt(13)
    s_barrier
    s_add_u32 s25, s21, 12288
    buffer_load_dwordx4 v[64:67], v3, s[12:15], s25 offen offset:0
    s_add_u32 s25, s21, 12288
    buffer_load_dwordx4 v[68:71], v3, s[12:15], s25 offen offset:1024
    s_add_u32 s25, s21, 12288
    buffer_load_dwordx4 v[72:75], v3, s[12:15], s25 offen offset:2048
    s_add_u32 s25, s21, 12288
    buffer_load_dwordx4 v[76:79], v3, s[12:15], s25 offen offset:3072
    s_add_u32 s25, s21, 16384
    buffer_load_dwordx4 v[80:83], v3, s[12:15], s25 offen offset:0
    s_add_u32 s25, s21, 16384
    buffer_load_dwordx4 v[84:87], v3, s[12:15], s25 offen offset:1024
    ds_read_b128 v[124:127], v3 offset:0
    ds_read_b128 v[128:131], v3 offset:1024
    ds_read_b128 v[132:135], v3 offset:2048
    ds_read_b128 v[136:139], v3 offset:3072
    ds_read_b128 v[140:143], v3 offset:4096
    ds_read_b128 v[144:147], v3 offset:5120
    ds_read_b128 v[148:151], v3 offset:6144
    ds_read_b128 v[152:155], v3 offset:7168
    ds_read_b128 v[156:159], v3 offset:8192
    s_waitcnt lgkmcnt(6)
    v_mfma_f32_16x16x32_bf16 v[88:91], v[16:19], v[124:127], v[88:91]
    ds_read_b128 v[160:163], v3 offset:9216
    v_mfma_f32_16x16x32_bf16 v[92:95], v[16:19], v[128:131], v[92:95]
    ds_read_b128 v[164:167], v3 offset:10240
    v_mfma_f32_16x16x32_bf16 v[96:99], v[16:19], v[132:135], v[96:99]
    ds_read_b128 v[168:171], v3 offset:11264
    s_waitcnt lgkmcnt(6)
    v_mfma_f32_16x16x32_bf16 v[100:103], v[16:19], v[136:139], v[100:103]
    ds_read_b128 v[172:175], v3 offset:12288
    v_mfma_f32_16x16x32_bf16 v[104:107], v[16:19], v[140:143], v[104:107]
    ds_read_b128 v[176:179], v3 offset:13312
    v_mfma_f32_16x16x32_bf16 v[108:111], v[16:19], v[144:147], v[108:111]
    ds_read_b128 v[180:183], v3 offset:14336
    s_waitcnt lgkmcnt(6)
    v_mfma_f32_16x16x32_bf16 v[112:115], v[16:19], v[148:151], v[112:115]
    ds_read_b128 v[184:187], v3 offset:15360
    v_mfma_f32_16x16x32_bf16 v[116:119], v[16:19], v[152:155], v[116:119]
    ds_read_b128 v[188:191], v3 offset:16384
    v_mfma_f32_16x16x32_bf16 v[120:123], v[16:19], v[156:159], v[120:123]
    ds_read_b128 v[192:195], v3 offset:17408
    s_waitcnt lgkmcnt(6)
    v_mfma_f32_16x16x32_bf16 v[88:91], v[20:23], v[160:163], v[88:91]
    ds_read_b128 v[124:127], v3 offset:18432
    v_mfma_f32_16x16x32_bf16 v[92:95], v[20:23], v[164:167], v[92:95]
    ds_read_b128 v[128:131], v3 offset:19456
    v_mfma_f32_16x16x32_bf16 v[96:99], v[20:23], v[168:171], v[96:99]
    ds_read_b128 v[132:135], v3 offset:20480
    s_waitcnt lgkmcnt(6)
    v_mfma_f32_16x16x32_bf16 v[100:103], v[20:23], v[172:175], v[100:103]
    ds_read_b128 v[136:139], v3 offset:21504
    v_mfma_f32_16x16x32_bf16 v[104:107], v[20:23], v[176:179], v[104:107]
    ds_read_b128 v[140:143], v3 offset:22528
    v_mfma_f32_16x16x32_bf16 v[108:111], v[20:23], v[180:183], v[108:111]
    ds_read_b128 v[144:147], v3 offset:23552
    s_waitcnt lgkmcnt(6)
    v_mfma_f32_16x16x32_bf16 v[112:115], v[20:23], v[184:187], v[112:115]
    ds_read_b128 v[148:151], v3 offset:24576
    v_mfma_f32_16x16x32_bf16 v[116:119], v[20:23], v[188:191], v[116:119]
    ds_read_b128 v[152:155], v3 offset:25600
    v_mfma_f32_16x16x32_bf16 v[120:123], v[20:23], v[192:195], v[120:123]
    ds_read_b128 v[156:159], v3 offset:26624
    s_waitcnt lgkmcnt(6)
    v_mfma_f32_16x16x32_bf16 v[88:91], v[24:27], v[124:127], v[88:91]
    ds_read_b128 v[160:163], v3 offset:27648
    v_mfma_f32_16x16x32_bf16 v[92:95], v[24:27], v[128:131], v[92:95]
    ds_read_b128 v[164:167], v3 offset:28672
    v_mfma_f32_16x16x32_bf16 v[96:99], v[24:27], v[132:135], v[96:99]
    ds_read_b128 v[168:171], v3 offset:29696
    s_waitcnt lgkmcnt(6)
    v_mfma_f32_16x16x32_bf16 v[100:103], v[24:27], v[136:139], v[100:103]
    ds_read_b128 v[172:175], v3 offset:30720
    v_mfma_f32_16x16x32_bf16 v[104:107], v[24:27], v[140:143], v[104:107]
    ds_read_b128 v[176:179], v3 offset:31744
    v_mfma_f32_16x16x32_bf16 v[108:111], v[24:27], v[144:147], v[108:111]
    ds_read_b128 v[180:183], v3 offset:32768
    s_waitcnt lgkmcnt(6)
    v_mfma_f32_16x16x32_bf16 v[112:115], v[24:27], v[148:151], v[112:115]
    ds_read_b128 v[184:187], v3 offset:33792
    v_mfma_f32_16x16x32_bf16 v[116:119], v[24:27], v[152:155], v[116:119]
    ds_read_b128 v[188:191], v3 offset:34816
    v_mfma_f32_16x16x32_bf16 v[120:123], v[24:27], v[156:159], v[120:123]
    ds_read_b128 v[192:195], v3 offset:35840
    s_waitcnt lgkmcnt(6)
    v_mfma_f32_16x16x32_bf16 v[88:91], v[28:31], v[160:163], v[88:91]
    ds_read_b128 v[124:127], v3 offset:36864
    v_mfma_f32_16x16x32_bf16 v[92:95], v[28:31], v[164:167], v[92:95]
    ds_read_b128 v[128:131], v3 offset:37888
    v_mfma_f32_16x16x32_bf16 v[96:99], v[28:31], v[168:171], v[96:99]
    ds_read_b128 v[132:135], v3 offset:38912
    s_waitcnt lgkmcnt(6)
    v_mfma_f32_16x16x32_bf16 v[100:103], v[28:31], v[172:175], v[100:103]
    ds_read_b128 v[136:139], v3 offset:39936
    v_mfma_f32_16x16x32_bf16 v[104:107], v[28:31], v[176:179], v[104:107]
    ds_read_b128 v[140:143], v3 offset:40960
    v_mfma_f32_16x16x32_bf16 v[108:111], v[28:31], v[180:183], v[108:111]
    ds_read_b128 v[144:147], v3 offset:41984
    s_waitcnt lgkmcnt(6)
    v_mfma_f32_16x16x32_bf16 v[112:115], v[28:31], v[184:187], v[112:115]
    ds_read_b128 v[148:151], v3 offset:43008
    v_mfma_f32_16x16x32_bf16 v[116:119], v[28:31], v[188:191], v[116:119]
    ds_read_b128 v[152:155], v3 offset:44032
    v_mfma_f32_16x16x32_bf16 v[120:123], v[28:31], v[192:195], v[120:123]
    ds_read_b128 v[156:159], v3 offset:45056
    s_waitcnt lgkmcnt(6)
    v_mfma_f32_16x16x32_bf16 v[88:91], v[32:35], v[124:127], v[88:91]
    ds_read_b128 v[160:163], v3 offset:46080
    v_mfma_f32_16x16x32_bf16 v[92:95], v[32:35], v[128:131], v[92:95]
    ds_read_b128 v[164:167], v3 offset:47104
    v_mfma_f32_16x16x32_bf16 v[96:99], v[32:35], v[132:135], v[96:99]
    ds_read_b128 v[168:171], v3 offset:48128
    s_waitcnt lgkmcnt(6)
    v_mfma_f32_16x16x32_bf16 v[100:103], v[32:35], v[136:139], v[100:103]
    ds_read_b128 v[172:175], v3 offset:49152
    v_mfma_f32_16x16x32_bf16 v[104:107], v[32:35], v[140:143], v[104:107]
    ds_read_b128 v[176:179], v3 offset:50176
    v_mfma_f32_16x16x32_bf16 v[108:111], v[32:35], v[144:147], v[108:111]
    ds_read_b128 v[180:183], v3 offset:51200
    s_waitcnt lgkmcnt(6)
    v_mfma_f32_16x16x32_bf16 v[112:115], v[32:35], v[148:151], v[112:115]
    ds_read_b128 v[184:187], v3 offset:52224
    v_mfma_f32_16x16x32_bf16 v[116:119], v[32:35], v[152:155], v[116:119]
    ds_read_b128 v[188:191], v3 offset:53248
    v_mfma_f32_16x16x32_bf16 v[120:123], v[32:35], v[156:159], v[120:123]
    ds_read_b128 v[192:195], v3 offset:54272
    s_waitcnt lgkmcnt(6)
    v_mfma_f32_16x16x32_bf16 v[88:91], v[36:39], v[160:163], v[88:91]
    v_mfma_f32_16x16x32_bf16 v[92:95], v[36:39], v[164:167], v[92:95]
    v_mfma_f32_16x16x32_bf16 v[96:99], v[36:39], v[168:171], v[96:99]
    s_waitcnt lgkmcnt(3)
    v_mfma_f32_16x16x32_bf16 v[100:103], v[36:39], v[172:175], v[100:103]
    v_mfma_f32_16x16x32_bf16 v[104:107], v[36:39], v[176:179], v[104:107]
    v_mfma_f32_16x16x32_bf16 v[108:111], v[36:39], v[180:183], v[108:111]
    s_waitcnt lgkmcnt(0)
    v_mfma_f32_16x16x32_bf16 v[112:115], v[36:39], v[184:187], v[112:115]
    v_mfma_f32_16x16x32_bf16 v[116:119], v[36:39], v[188:191], v[116:119]
    v_mfma_f32_16x16x32_bf16 v[120:123], v[36:39], v[192:195], v[120:123]
    ds_read_b128 v[196:199], v7 offset:768
    ds_read_b128 v[200:203], v7 offset:784
    ds_read_b128 v[204:207], v7 offset:3072
    ds_read_b128 v[208:211], v7 offset:3088
    ds_read_b128 v[212:215], v7 offset:896
    ds_read_b128 v[216:219], v7 offset:912
    ds_read_b128 v[220:223], v7 offset:3200
    ds_read_b128 v[224:227], v7 offset:3216
    s_waitcnt vmcnt(18) lgkmcnt(4)
    v_lshlrev_b32 v228, 16, v40
    v_and_b32 v229, 0xffff0000, v40
    v_lshlrev_b32 v230, 16, v41
    v_and_b32 v231, 0xffff0000, v41
    v_lshlrev_b32 v232, 16, v42
    v_and_b32 v233, 0xffff0000, v42
    v_lshlrev_b32 v234, 16, v43
    v_and_b32 v235, 0xffff0000, v43
    v_pk_fma_f32 v[228:229], v[228:229], v[204:205], v[196:197]
    v_pk_fma_f32 v[230:231], v[230:231], v[206:207], v[198:199]
    v_pk_fma_f32 v[232:233], v[232:233], v[208:209], v[200:201]
    v_pk_fma_f32 v[234:235], v[234:235], v[210:211], v[202:203]
    v_cvt_pk_bf16_f32 v40, v228, v229
    v_cvt_pk_bf16_f32 v41, v230, v231
    v_cvt_pk_bf16_f32 v42, v232, v233
    v_cvt_pk_bf16_f32 v43, v234, v235
    ds_read_b128 v[196:199], v7 offset:1024
    ds_read_b128 v[200:203], v7 offset:1040
    ds_read_b128 v[204:207], v7 offset:3328
    ds_read_b128 v[208:211], v7 offset:3344
    s_waitcnt vmcnt(16) lgkmcnt(4)
    v_lshlrev_b32 v228, 16, v44
    v_and_b32 v229, 0xffff0000, v44
    v_lshlrev_b32 v230, 16, v45
    v_and_b32 v231, 0xffff0000, v45
    v_lshlrev_b32 v232, 16, v46
    v_and_b32 v233, 0xffff0000, v46
    v_lshlrev_b32 v234, 16, v47
    v_and_b32 v235, 0xffff0000, v47
    v_pk_fma_f32 v[228:229], v[228:229], v[220:221], v[212:213]
    v_pk_fma_f32 v[230:231], v[230:231], v[222:223], v[214:215]
    v_pk_fma_f32 v[232:233], v[232:233], v[224:225], v[216:217]
    v_pk_fma_f32 v[234:235], v[234:235], v[226:227], v[218:219]
    v_cvt_pk_bf16_f32 v44, v228, v229
    v_cvt_pk_bf16_f32 v45, v230, v231
    v_cvt_pk_bf16_f32 v46, v232, v233
    v_cvt_pk_bf16_f32 v47, v234, v235
    ds_read_b128 v[212:215], v7 offset:1152
    ds_read_b128 v[216:219], v7 offset:1168
    ds_read_b128 v[220:223], v7 offset:3456
    ds_read_b128 v[224:227], v7 offset:3472
    s_waitcnt vmcnt(14) lgkmcnt(4)
    v_lshlrev_b32 v228, 16, v48
    v_and_b32 v229, 0xffff0000, v48
    v_lshlrev_b32 v230, 16, v49
    v_and_b32 v231, 0xffff0000, v49
    v_lshlrev_b32 v232, 16, v50
    v_and_b32 v233, 0xffff0000, v50
    v_lshlrev_b32 v234, 16, v51
    v_and_b32 v235, 0xffff0000, v51
    v_pk_fma_f32 v[228:229], v[228:229], v[204:205], v[196:197]
    v_pk_fma_f32 v[230:231], v[230:231], v[206:207], v[198:199]
    v_pk_fma_f32 v[232:233], v[232:233], v[208:209], v[200:201]
    v_pk_fma_f32 v[234:235], v[234:235], v[210:211], v[202:203]
    v_cvt_pk_bf16_f32 v48, v228, v229
    v_cvt_pk_bf16_f32 v49, v230, v231
    v_cvt_pk_bf16_f32 v50, v232, v233
    v_cvt_pk_bf16_f32 v51, v234, v235
    ds_read_b128 v[196:199], v7 offset:1280
    ds_read_b128 v[200:203], v7 offset:1296
    ds_read_b128 v[204:207], v7 offset:3584
    ds_read_b128 v[208:211], v7 offset:3600
    s_waitcnt vmcnt(12) lgkmcnt(4)
    v_lshlrev_b32 v228, 16, v52
    v_and_b32 v229, 0xffff0000, v52
    v_lshlrev_b32 v230, 16, v53
    v_and_b32 v231, 0xffff0000, v53
    v_lshlrev_b32 v232, 16, v54
    v_and_b32 v233, 0xffff0000, v54
    v_lshlrev_b32 v234, 16, v55
    v_and_b32 v235, 0xffff0000, v55
    v_pk_fma_f32 v[228:229], v[228:229], v[220:221], v[212:213]
    v_pk_fma_f32 v[230:231], v[230:231], v[222:223], v[214:215]
    v_pk_fma_f32 v[232:233], v[232:233], v[224:225], v[216:217]
    v_pk_fma_f32 v[234:235], v[234:235], v[226:227], v[218:219]
    v_cvt_pk_bf16_f32 v52, v228, v229
    v_cvt_pk_bf16_f32 v53, v230, v231
    v_cvt_pk_bf16_f32 v54, v232, v233
    v_cvt_pk_bf16_f32 v55, v234, v235
    ds_read_b128 v[212:215], v7 offset:1408
    ds_read_b128 v[216:219], v7 offset:1424
    ds_read_b128 v[220:223], v7 offset:3712
    ds_read_b128 v[224:227], v7 offset:3728
    s_waitcnt vmcnt(10) lgkmcnt(4)
    v_lshlrev_b32 v228, 16, v56
    v_and_b32 v229, 0xffff0000, v56
    v_lshlrev_b32 v230, 16, v57
    v_and_b32 v231, 0xffff0000, v57
    v_lshlrev_b32 v232, 16, v58
    v_and_b32 v233, 0xffff0000, v58
    v_lshlrev_b32 v234, 16, v59
    v_and_b32 v235, 0xffff0000, v59
    v_pk_fma_f32 v[228:229], v[228:229], v[204:205], v[196:197]
    v_pk_fma_f32 v[230:231], v[230:231], v[206:207], v[198:199]
    v_pk_fma_f32 v[232:233], v[232:233], v[208:209], v[200:201]
    v_pk_fma_f32 v[234:235], v[234:235], v[210:211], v[202:203]
    v_cvt_pk_bf16_f32 v56, v228, v229
    v_cvt_pk_bf16_f32 v57, v230, v231
    v_cvt_pk_bf16_f32 v58, v232, v233
    v_cvt_pk_bf16_f32 v59, v234, v235
    s_waitcnt vmcnt(8) lgkmcnt(0)
    v_lshlrev_b32 v228, 16, v60
    v_and_b32 v229, 0xffff0000, v60
    v_lshlrev_b32 v230, 16, v61
    v_and_b32 v231, 0xffff0000, v61
    v_lshlrev_b32 v232, 16, v62
    v_and_b32 v233, 0xffff0000, v62
    v_lshlrev_b32 v234, 16, v63
    v_and_b32 v235, 0xffff0000, v63
    v_pk_fma_f32 v[228:229], v[228:229], v[220:221], v[212:213]
    v_pk_fma_f32 v[230:231], v[230:231], v[222:223], v[214:215]
    v_pk_fma_f32 v[232:233], v[232:233], v[224:225], v[216:217]
    v_pk_fma_f32 v[234:235], v[234:235], v[226:227], v[218:219]
    v_cvt_pk_bf16_f32 v60, v228, v229
    v_cvt_pk_bf16_f32 v61, v230, v231
    v_cvt_pk_bf16_f32 v62, v232, v233
    v_cvt_pk_bf16_f32 v63, v234, v235
    s_waitcnt vmcnt(6)
    s_barrier
    s_add_u32 m0, s23, 0
    s_add_u32 s24, s22, 110592
    buffer_load_dwordx4 v3, s[16:19], s24 offen offset:0 lds
    buffer_load_dwordx4 v3, s[16:19], s24 offen offset:1024 lds
    buffer_load_dwordx4 v3, s[16:19], s24 offen offset:2048 lds
    buffer_load_dwordx4 v3, s[16:19], s24 offen offset:3072 lds
    s_add_u32 m0, s23, 4096
    s_add_u32 s24, s22, 114688
    buffer_load_dwordx4 v3, s[16:19], s24 offen offset:0 lds
    buffer_load_dwordx4 v3, s[16:19], s24 offen offset:1024 lds
    buffer_load_dwordx4 v3, s[16:19], s24 offen offset:2048 lds
    ds_read_b128 v[124:127], v8 offset:0
    ds_read_b128 v[128:131], v8 offset:1024
    ds_read_b128 v[132:135], v8 offset:2048
    ds_read_b128 v[136:139], v8 offset:3072
    ds_read_b128 v[140:143], v8 offset:4096
    ds_read_b128 v[144:147], v8 offset:5120
    ds_read_b128 v[148:151], v8 offset:6144
    ds_read_b128 v[152:155], v8 offset:7168
    ds_read_b128 v[156:159], v8 offset:8192
    s_waitcnt lgkmcnt(6)
    v_mfma_f32_16x16x32_bf16 v[88:91], v[40:43], v[124:127], v[88:91]
    ds_read_b128 v[160:163], v8 offset:9216
    v_mfma_f32_16x16x32_bf16 v[92:95], v[40:43], v[128:131], v[92:95]
    ds_read_b128 v[164:167], v8 offset:10240
    v_mfma_f32_16x16x32_bf16 v[96:99], v[40:43], v[132:135], v[96:99]
    ds_read_b128 v[168:171], v8 offset:11264
    s_waitcnt lgkmcnt(6)
    v_mfma_f32_16x16x32_bf16 v[100:103], v[40:43], v[136:139], v[100:103]
    ds_read_b128 v[172:175], v8 offset:12288
    v_mfma_f32_16x16x32_bf16 v[104:107], v[40:43], v[140:143], v[104:107]
    ds_read_b128 v[176:179], v8 offset:13312
    v_mfma_f32_16x16x32_bf16 v[108:111], v[40:43], v[144:147], v[108:111]
    ds_read_b128 v[180:183], v8 offset:14336
    s_waitcnt lgkmcnt(6)
    v_mfma_f32_16x16x32_bf16 v[112:115], v[40:43], v[148:151], v[112:115]
    ds_read_b128 v[184:187], v8 offset:15360
    v_mfma_f32_16x16x32_bf16 v[116:119], v[40:43], v[152:155], v[116:119]
    ds_read_b128 v[188:191], v8 offset:16384
    v_mfma_f32_16x16x32_bf16 v[120:123], v[40:43], v[156:159], v[120:123]
    ds_read_b128 v[192:195], v8 offset:17408
    s_waitcnt lgkmcnt(6)
    v_mfma_f32_16x16x32_bf16 v[88:91], v[44:47], v[160:163], v[88:91]
    ds_read_b128 v[124:127], v8 offset:18432
    v_mfma_f32_16x16x32_bf16 v[92:95], v[44:47], v[164:167], v[92:95]
    ds_read_b128 v[128:131], v8 offset:19456
    v_mfma_f32_16x16x32_bf16 v[96:99], v[44:47], v[168:171], v[96:99]
    ds_read_b128 v[132:135], v8 offset:20480
    s_waitcnt lgkmcnt(6)
    v_mfma_f32_16x16x32_bf16 v[100:103], v[44:47], v[172:175], v[100:103]
    ds_read_b128 v[136:139], v8 offset:21504
    v_mfma_f32_16x16x32_bf16 v[104:107], v[44:47], v[176:179], v[104:107]
    ds_read_b128 v[140:143], v8 offset:22528
    v_mfma_f32_16x16x32_bf16 v[108:111], v[44:47], v[180:183], v[108:111]
    ds_read_b128 v[144:147], v8 offset:23552
    s_waitcnt lgkmcnt(6)
    v_mfma_f32_16x16x32_bf16 v[112:115], v[44:47], v[184:187], v[112:115]
    ds_read_b128 v[148:151], v8 offset:24576
    v_mfma_f32_16x16x32_bf16 v[116:119], v[44:47], v[188:191], v[116:119]
    ds_read_b128 v[152:155], v8 offset:25600
    v_mfma_f32_16x16x32_bf16 v[120:123], v[44:47], v[192:195], v[120:123]
    ds_read_b128 v[156:159], v8 offset:26624
    s_waitcnt lgkmcnt(6)
    v_mfma_f32_16x16x32_bf16 v[88:91], v[48:51], v[124:127], v[88:91]
    ds_read_b128 v[160:163], v8 offset:27648
    v_mfma_f32_16x16x32_bf16 v[92:95], v[48:51], v[128:131], v[92:95]
    ds_read_b128 v[164:167], v8 offset:28672
    v_mfma_f32_16x16x32_bf16 v[96:99], v[48:51], v[132:135], v[96:99]
    ds_read_b128 v[168:171], v8 offset:29696
    s_waitcnt lgkmcnt(6)
    v_mfma_f32_16x16x32_bf16 v[100:103], v[48:51], v[136:139], v[100:103]
    ds_read_b128 v[172:175], v8 offset:30720
    v_mfma_f32_16x16x32_bf16 v[104:107], v[48:51], v[140:143], v[104:107]
    ds_read_b128 v[176:179], v8 offset:31744
    v_mfma_f32_16x16x32_bf16 v[108:111], v[48:51], v[144:147], v[108:111]
    ds_read_b128 v[180:183], v8 offset:32768
    s_waitcnt lgkmcnt(6)
    v_mfma_f32_16x16x32_bf16 v[112:115], v[48:51], v[148:151], v[112:115]
    ds_read_b128 v[184:187], v8 offset:33792
    v_mfma_f32_16x16x32_bf16 v[116:119], v[48:51], v[152:155], v[116:119]
    ds_read_b128 v[188:191], v8 offset:34816
    v_mfma_f32_16x16x32_bf16 v[120:123], v[48:51], v[156:159], v[120:123]
    ds_read_b128 v[192:195], v8 offset:35840
    s_waitcnt lgkmcnt(6)
    v_mfma_f32_16x16x32_bf16 v[88:91], v[52:55], v[160:163], v[88:91]
    ds_read_b128 v[124:127], v8 offset:36864
    v_mfma_f32_16x16x32_bf16 v[92:95], v[52:55], v[164:167], v[92:95]
    ds_read_b128 v[128:131], v8 offset:37888
    v_mfma_f32_16x16x32_bf16 v[96:99], v[52:55], v[168:171], v[96:99]
    ds_read_b128 v[132:135], v8 offset:38912
    s_waitcnt lgkmcnt(6)
    v_mfma_f32_16x16x32_bf16 v[100:103], v[52:55], v[172:175], v[100:103]
    ds_read_b128 v[136:139], v8 offset:39936
    v_mfma_f32_16x16x32_bf16 v[104:107], v[52:55], v[176:179], v[104:107]
    ds_read_b128 v[140:143], v8 offset:40960
    v_mfma_f32_16x16x32_bf16 v[108:111], v[52:55], v[180:183], v[108:111]
    ds_read_b128 v[144:147], v8 offset:41984
    s_waitcnt lgkmcnt(6)
    v_mfma_f32_16x16x32_bf16 v[112:115], v[52:55], v[184:187], v[112:115]
    ds_read_b128 v[148:151], v8 offset:43008
    v_mfma_f32_16x16x32_bf16 v[116:119], v[52:55], v[188:191], v[116:119]
    ds_read_b128 v[152:155], v8 offset:44032
    v_mfma_f32_16x16x32_bf16 v[120:123], v[52:55], v[192:195], v[120:123]
    ds_read_b128 v[156:159], v8 offset:45056
    s_waitcnt lgkmcnt(6)
    v_mfma_f32_16x16x32_bf16 v[88:91], v[56:59], v[124:127], v[88:91]
    ds_read_b128 v[160:163], v8 offset:46080
    v_mfma_f32_16x16x32_bf16 v[92:95], v[56:59], v[128:131], v[92:95]
    ds_read_b128 v[164:167], v8 offset:47104
    v_mfma_f32_16x16x32_bf16 v[96:99], v[56:59], v[132:135], v[96:99]
    ds_read_b128 v[168:171], v8 offset:48128
    s_waitcnt lgkmcnt(6)
    v_mfma_f32_16x16x32_bf16 v[100:103], v[56:59], v[136:139], v[100:103]
    ds_read_b128 v[172:175], v8 offset:49152
    v_mfma_f32_16x16x32_bf16 v[104:107], v[56:59], v[140:143], v[104:107]
    ds_read_b128 v[176:179], v8 offset:50176
    v_mfma_f32_16x16x32_bf16 v[108:111], v[56:59], v[144:147], v[108:111]
    ds_read_b128 v[180:183], v8 offset:51200
    s_waitcnt lgkmcnt(6)
    v_mfma_f32_16x16x32_bf16 v[112:115], v[56:59], v[148:151], v[112:115]
    ds_read_b128 v[184:187], v8 offset:52224
    v_mfma_f32_16x16x32_bf16 v[116:119], v[56:59], v[152:155], v[116:119]
    ds_read_b128 v[188:191], v8 offset:53248
    v_mfma_f32_16x16x32_bf16 v[120:123], v[56:59], v[156:159], v[120:123]
    ds_read_b128 v[192:195], v8 offset:54272
    s_waitcnt lgkmcnt(6)
    v_mfma_f32_16x16x32_bf16 v[88:91], v[60:63], v[160:163], v[88:91]
    v_mfma_f32_16x16x32_bf16 v[92:95], v[60:63], v[164:167], v[92:95]
    v_mfma_f32_16x16x32_bf16 v[96:99], v[60:63], v[168:171], v[96:99]
    s_waitcnt lgkmcnt(3)
    v_mfma_f32_16x16x32_bf16 v[100:103], v[60:63], v[172:175], v[100:103]
    v_mfma_f32_16x16x32_bf16 v[104:107], v[60:63], v[176:179], v[104:107]
    v_mfma_f32_16x16x32_bf16 v[108:111], v[60:63], v[180:183], v[108:111]
    s_waitcnt lgkmcnt(0)
    v_mfma_f32_16x16x32_bf16 v[112:115], v[60:63], v[184:187], v[112:115]
    v_mfma_f32_16x16x32_bf16 v[116:119], v[60:63], v[188:191], v[116:119]
    v_mfma_f32_16x16x32_bf16 v[120:123], v[60:63], v[192:195], v[120:123]
    ds_read_b128 v[196:199], v7 offset:1536
    ds_read_b128 v[200:203], v7 offset:1552
    ds_read_b128 v[204:207], v7 offset:3840
    ds_read_b128 v[208:211], v7 offset:3856
    ds_read_b128 v[212:215], v7 offset:1664
    ds_read_b128 v[216:219], v7 offset:1680
    ds_read_b128 v[220:223], v7 offset:3968
    ds_read_b128 v[224:227], v7 offset:3984
    s_waitcnt vmcnt(12) lgkmcnt(4)
    v_lshlrev_b32 v228, 16, v64
    v_and_b32 v229, 0xffff0000, v64
    v_lshlrev_b32 v230, 16, v65
    v_and_b32 v231, 0xffff0000, v65
    v_lshlrev_b32 v232, 16, v66
    v_and_b32 v233, 0xffff0000, v66
    v_lshlrev_b32 v234, 16, v67
    v_and_b32 v235, 0xffff0000, v67
    v_pk_fma_f32 v[228:229], v[228:229], v[204:205], v[196:197]
    v_pk_fma_f32 v[230:231], v[230:231], v[206:207], v[198:199]
    v_pk_fma_f32 v[232:233], v[232:233], v[208:209], v[200:201]
    v_pk_fma_f32 v[234:235], v[234:235], v[210:211], v[202:203]
    v_cvt_pk_bf16_f32 v64, v228, v229
    v_cvt_pk_bf16_f32 v65, v230, v231
    v_cvt_pk_bf16_f32 v66, v232, v233
    v_cvt_pk_bf16_f32 v67, v234, v235
    ds_read_b128 v[196:199], v7 offset:1792
    ds_read_b128 v[200:203], v7 offset:1808
    ds_read_b128 v[204:207], v7 offset:4096
    ds_read_b128 v[208:211], v7 offset:4112
    s_waitcnt vmcnt(11) lgkmcnt(4)
    v_lshlrev_b32 v228, 16, v68
    v_and_b32 v229, 0xffff0000, v68
    v_lshlrev_b32 v230, 16, v69
    v_and_b32 v231, 0xffff0000, v69
    v_lshlrev_b32 v232, 16, v70
    v_and_b32 v233, 0xffff0000, v70
    v_lshlrev_b32 v234, 16, v71
    v_and_b32 v235, 0xffff0000, v71
    v_pk_fma_f32 v[228:229], v[228:229], v[220:221], v[212:213]
    v_pk_fma_f32 v[230:231], v[230:231], v[222:223], v[214:215]
    v_pk_fma_f32 v[232:233], v[232:233], v[224:225], v[216:217]
    v_pk_fma_f32 v[234:235], v[234:235], v[226:227], v[218:219]
    v_cvt_pk_bf16_f32 v68, v228, v229
    v_cvt_pk_bf16_f32 v69, v230, v231
    v_cvt_pk_bf16_f32 v70, v232, v233
    v_cvt_pk_bf16_f32 v71, v234, v235
    ds_read_b128 v[212:215], v7 offset:1920
    ds_read_b128 v[216:219], v7 offset:1936
    ds_read_b128 v[220:223], v7 offset:4224
    ds_read_b128 v[224:227], v7 offset:4240
    s_waitcnt vmcnt(10) lgkmcnt(4)
    v_lshlrev_b32 v228, 16, v72
    v_and_b32 v229, 0xffff0000, v72
    v_lshlrev_b32 v230, 16, v73
    v_and_b32 v231, 0xffff0000, v73
    v_lshlrev_b32 v232, 16, v74
    v_and_b32 v233, 0xffff0000, v74
    v_lshlrev_b32 v234, 16, v75
    v_and_b32 v235, 0xffff0000, v75
    v_pk_fma_f32 v[228:229], v[228:229], v[204:205], v[196:197]
    v_pk_fma_f32 v[230:231], v[230:231], v[206:207], v[198:199]
    v_pk_fma_f32 v[232:233], v[232:233], v[208:209], v[200:201]
    v_pk_fma_f32 v[234:235], v[234:235], v[210:211], v[202:203]
    v_cvt_pk_bf16_f32 v72, v228, v229
    v_cvt_pk_bf16_f32 v73, v230, v231
    v_cvt_pk_bf16_f32 v74, v232, v233
    v_cvt_pk_bf16_f32 v75, v234, v235
    ds_read_b128 v[196:199], v7 offset:2048
    ds_read_b128 v[200:203], v7 offset:2064
    ds_read_b128 v[204:207], v7 offset:4352
    ds_read_b128 v[208:211], v7 offset:4368
    s_waitcnt vmcnt(9) lgkmcnt(4)
    v_lshlrev_b32 v228, 16, v76
    v_and_b32 v229, 0xffff0000, v76
    v_lshlrev_b32 v230, 16, v77
    v_and_b32 v231, 0xffff0000, v77
    v_lshlrev_b32 v232, 16, v78
    v_and_b32 v233, 0xffff0000, v78
    v_lshlrev_b32 v234, 16, v79
    v_and_b32 v235, 0xffff0000, v79
    v_pk_fma_f32 v[228:229], v[228:229], v[220:221], v[212:213]
    v_pk_fma_f32 v[230:231], v[230:231], v[222:223], v[214:215]
    v_pk_fma_f32 v[232:233], v[232:233], v[224:225], v[216:217]
    v_pk_fma_f32 v[234:235], v[234:235], v[226:227], v[218:219]
    v_cvt_pk_bf16_f32 v76, v228, v229
    v_cvt_pk_bf16_f32 v77, v230, v231
    v_cvt_pk_bf16_f32 v78, v232, v233
    v_cvt_pk_bf16_f32 v79, v234, v235
    ds_read_b128 v[212:215], v7 offset:2176
    ds_read_b128 v[216:219], v7 offset:2192
    ds_read_b128 v[220:223], v7 offset:4480
    ds_read_b128 v[224:227], v7 offset:4496
    s_waitcnt vmcnt(8) lgkmcnt(4)
    v_lshlrev_b32 v228, 16, v80
    v_and_b32 v229, 0xffff0000, v80
    v_lshlrev_b32 v230, 16, v81
    v_and_b32 v231, 0xffff0000, v81
    v_lshlrev_b32 v232, 16, v82
    v_and_b32 v233, 0xffff0000, v82
    v_lshlrev_b32 v234, 16, v83
    v_and_b32 v235, 0xffff0000, v83
    v_pk_fma_f32 v[228:229], v[228:229], v[204:205], v[196:197]
    v_pk_fma_f32 v[230:231], v[230:231], v[206:207], v[198:199]
    v_pk_fma_f32 v[232:233], v[232:233], v[208:209], v[200:201]
    v_pk_fma_f32 v[234:235], v[234:235], v[210:211], v[202:203]
    v_cvt_pk_bf16_f32 v80, v228, v229
    v_cvt_pk_bf16_f32 v81, v230, v231
    v_cvt_pk_bf16_f32 v82, v232, v233
    v_cvt_pk_bf16_f32 v83, v234, v235
    s_waitcnt vmcnt(7) lgkmcnt(0)
    v_lshlrev_b32 v228, 16, v84
    v_and_b32 v229, 0xffff0000, v84
    v_lshlrev_b32 v230, 16, v85
    v_and_b32 v231, 0xffff0000, v85
    v_lshlrev_b32 v232, 16, v86
    v_and_b32 v233, 0xffff0000, v86
    v_lshlrev_b32 v234, 16, v87
    v_and_b32 v235, 0xffff0000, v87
    v_pk_fma_f32 v[228:229], v[228:229], v[220:221], v[212:213]
    v_pk_fma_f32 v[230:231], v[230:231], v[222:223], v[214:215]
    v_pk_fma_f32 v[232:233], v[232:233], v[224:225], v[216:217]
    v_pk_fma_f32 v[234:235], v[234:235], v[226:227], v[218:219]
    v_cvt_pk_bf16_f32 v84, v228, v229
    v_cvt_pk_bf16_f32 v85, v230, v231
    v_cvt_pk_bf16_f32 v86, v232, v233
    v_cvt_pk_bf16_f32 v87, v234, v235
    s_waitcnt vmcnt(0)
    s_barrier
    ds_read_b128 v[124:127], v3 offset:0
    ds_read_b128 v[128:131], v3 offset:1024
    ds_read_b128 v[132:135], v3 offset:2048
    ds_read_b128 v[136:139], v3 offset:3072
    ds_read_b128 v[140:143], v3 offset:4096
    ds_read_b128 v[144:147], v3 offset:5120
    ds_read_b128 v[148:151], v3 offset:6144
    ds_read_b128 v[152:155], v3 offset:7168
    ds_read_b128 v[156:159], v3 offset:8192
    s_waitcnt lgkmcnt(6)
    v_mfma_f32_16x16x32_bf16 v[88:91], v[64:67], v[124:127], v[88:91]
    ds_read_b128 v[160:163], v3 offset:9216
    v_mfma_f32_16x16x32_bf16 v[92:95], v[64:67], v[128:131], v[92:95]
    ds_read_b128 v[164:167], v3 offset:10240
    v_mfma_f32_16x16x32_bf16 v[96:99], v[64:67], v[132:135], v[96:99]
    ds_read_b128 v[168:171], v3 offset:11264
    s_waitcnt lgkmcnt(6)
    v_mfma_f32_16x16x32_bf16 v[100:103], v[64:67], v[136:139], v[100:103]
    ds_read_b128 v[172:175], v3 offset:12288
    v_mfma_f32_16x16x32_bf16 v[104:107], v[64:67], v[140:143], v[104:107]
    ds_read_b128 v[176:179], v3 offset:13312
    v_mfma_f32_16x16x32_bf16 v[108:111], v[64:67], v[144:147], v[108:111]
    ds_read_b128 v[180:183], v3 offset:14336
    s_waitcnt lgkmcnt(6)
    v_mfma_f32_16x16x32_bf16 v[112:115], v[64:67], v[148:151], v[112:115]
    ds_read_b128 v[184:187], v3 offset:15360
    v_mfma_f32_16x16x32_bf16 v[116:119], v[64:67], v[152:155], v[116:119]
    ds_read_b128 v[188:191], v3 offset:16384
    v_mfma_f32_16x16x32_bf16 v[120:123], v[64:67], v[156:159], v[120:123]
    ds_read_b128 v[192:195], v3 offset:17408
    s_waitcnt lgkmcnt(6)
    v_mfma_f32_16x16x32_bf16 v[88:91], v[68:71], v[160:163], v[88:91]
    ds_read_b128 v[124:127], v3 offset:18432
    v_mfma_f32_16x16x32_bf16 v[92:95], v[68:71], v[164:167], v[92:95]
    ds_read_b128 v[128:131], v3 offset:19456
    v_mfma_f32_16x16x32_bf16 v[96:99], v[68:71], v[168:171], v[96:99]
    ds_read_b128 v[132:135], v3 offset:20480
    s_waitcnt lgkmcnt(6)
    v_mfma_f32_16x16x32_bf16 v[100:103], v[68:71], v[172:175], v[100:103]
    ds_read_b128 v[136:139], v3 offset:21504
    v_mfma_f32_16x16x32_bf16 v[104:107], v[68:71], v[176:179], v[104:107]
    ds_read_b128 v[140:143], v3 offset:22528
    v_mfma_f32_16x16x32_bf16 v[108:111], v[68:71], v[180:183], v[108:111]
    ds_read_b128 v[144:147], v3 offset:23552
    s_waitcnt lgkmcnt(6)
    v_mfma_f32_16x16x32_bf16 v[112:115], v[68:71], v[184:187], v[112:115]
    ds_read_b128 v[148:151], v3 offset:24576
    v_mfma_f32_16x16x32_bf16 v[116:119], v[68:71], v[188:191], v[116:119]
    ds_read_b128 v[152:155], v3 offset:25600
    v_mfma_f32_16x16x32_bf16 v[120:123], v[68:71], v[192:195], v[120:123]
    ds_read_b128 v[156:159], v3 offset:26624
    s_waitcnt lgkmcnt(6)
    v_mfma_f32_16x16x32_bf16 v[88:91], v[72:75], v[124:127], v[88:91]
    ds_read_b128 v[160:163], v3 offset:27648
    v_mfma_f32_16x16x32_bf16 v[92:95], v[72:75], v[128:131], v[92:95]
    ds_read_b128 v[164:167], v3 offset:28672
    v_mfma_f32_16x16x32_bf16 v[96:99], v[72:75], v[132:135], v[96:99]
    ds_read_b128 v[168:171], v3 offset:29696
    s_waitcnt lgkmcnt(6)
    v_mfma_f32_16x16x32_bf16 v[100:103], v[72:75], v[136:139], v[100:103]
    ds_read_b128 v[172:175], v3 offset:30720
    v_mfma_f32_16x16x32_bf16 v[104:107], v[72:75], v[140:143], v[104:107]
    ds_read_b128 v[176:179], v3 offset:31744
    v_mfma_f32_16x16x32_bf16 v[108:111], v[72:75], v[144:147], v[108:111]
    ds_read_b128 v[180:183], v3 offset:32768
    s_waitcnt lgkmcnt(6)
    v_mfma_f32_16x16x32_bf16 v[112:115], v[72:75], v[148:151], v[112:115]
    ds_read_b128 v[184:187], v3 offset:33792
    v_mfma_f32_16x16x32_bf16 v[116:119], v[72:75], v[152:155], v[116:119]
    ds_read_b128 v[188:191], v3 offset:34816
    v_mfma_f32_16x16x32_bf16 v[120:123], v[72:75], v[156:159], v[120:123]
    ds_read_b128 v[192:195], v3 offset:35840
    s_waitcnt lgkmcnt(6)
    v_mfma_f32_16x16x32_bf16 v[88:91], v[76:79], v[160:163], v[88:91]
    ds_read_b128 v[124:127], v3 offset:36864
    v_mfma_f32_16x16x32_bf16 v[92:95], v[76:79], v[164:167], v[92:95]
    ds_read_b128 v[128:131], v3 offset:37888
    v_mfma_f32_16x16x32_bf16 v[96:99], v[76:79], v[168:171], v[96:99]
    ds_read_b128 v[132:135], v3 offset:38912
    s_waitcnt lgkmcnt(6)
    v_mfma_f32_16x16x32_bf16 v[100:103], v[76:79], v[172:175], v[100:103]
    ds_read_b128 v[136:139], v3 offset:39936
    v_mfma_f32_16x16x32_bf16 v[104:107], v[76:79], v[176:179], v[104:107]
    ds_read_b128 v[140:143], v3 offset:40960
    v_mfma_f32_16x16x32_bf16 v[108:111], v[76:79], v[180:183], v[108:111]
    ds_read_b128 v[144:147], v3 offset:41984
    s_waitcnt lgkmcnt(6)
    v_mfma_f32_16x16x32_bf16 v[112:115], v[76:79], v[184:187], v[112:115]
    ds_read_b128 v[148:151], v3 offset:43008
    v_mfma_f32_16x16x32_bf16 v[116:119], v[76:79], v[188:191], v[116:119]
    ds_read_b128 v[152:155], v3 offset:44032
    v_mfma_f32_16x16x32_bf16 v[120:123], v[76:79], v[192:195], v[120:123]
    ds_read_b128 v[156:159], v3 offset:45056
    s_waitcnt lgkmcnt(6)
    v_mfma_f32_16x16x32_bf16 v[88:91], v[80:83], v[124:127], v[88:91]
    ds_read_b128 v[160:163], v3 offset:46080
    v_mfma_f32_16x16x32_bf16 v[92:95], v[80:83], v[128:131], v[92:95]
    ds_read_b128 v[164:167], v3 offset:47104
    v_mfma_f32_16x16x32_bf16 v[96:99], v[80:83], v[132:135], v[96:99]
    ds_read_b128 v[168:171], v3 offset:48128
    s_waitcnt lgkmcnt(6)
    v_mfma_f32_16x16x32_bf16 v[100:103], v[80:83], v[136:139], v[100:103]
    ds_read_b128 v[172:175], v3 offset:49152
    v_mfma_f32_16x16x32_bf16 v[104:107], v[80:83], v[140:143], v[104:107]
    ds_read_b128 v[176:179], v3 offset:50176
    v_mfma_f32_16x16x32_bf16 v[108:111], v[80:83], v[144:147], v[108:111]
    ds_read_b128 v[180:183], v3 offset:51200
    s_waitcnt lgkmcnt(6)
    v_mfma_f32_16x16x32_bf16 v[112:115], v[80:83], v[148:151], v[112:115]
    ds_read_b128 v[184:187], v3 offset:52224
    v_mfma_f32_16x16x32_bf16 v[116:119], v[80:83], v[152:155], v[116:119]
    ds_read_b128 v[188:191], v3 offset:53248
    v_mfma_f32_16x16x32_bf16 v[120:123], v[80:83], v[156:159], v[120:123]
    ds_read_b128 v[192:195], v3 offset:54272
    s_waitcnt lgkmcnt(6)
    v_mfma_f32_16x16x32_bf16 v[88:91], v[84:87], v[160:163], v[88:91]
    v_mfma_f32_16x16x32_bf16 v[92:95], v[84:87], v[164:167], v[92:95]
    v_mfma_f32_16x16x32_bf16 v[96:99], v[84:87], v[168:171], v[96:99]
    s_waitcnt lgkmcnt(3)
    v_mfma_f32_16x16x32_bf16 v[100:103], v[84:87], v[172:175], v[100:103]
    v_mfma_f32_16x16x32_bf16 v[104:107], v[84:87], v[176:179], v[104:107]
    v_mfma_f32_16x16x32_bf16 v[108:111], v[84:87], v[180:183], v[108:111]
    s_waitcnt lgkmcnt(0)
    v_mfma_f32_16x16x32_bf16 v[112:115], v[84:87], v[184:187], v[112:115]
    v_mfma_f32_16x16x32_bf16 v[116:119], v[84:87], v[188:191], v[116:119]
    v_mfma_f32_16x16x32_bf16 v[120:123], v[84:87], v[192:195], v[120:123]
    s_branch L_grpJ_17
L_grpB_16:
    s_waitcnt vmcnt(13)
    s_barrier
    s_add_u32 s25, s21, 12288
    buffer_load_dwordx4 v[64:67], v3, s[12:15], s25 offen offset:0
    s_add_u32 s25, s21, 12288
    buffer_load_dwordx4 v[68:71], v3, s[12:15], s25 offen offset:1024
    s_add_u32 s25, s21, 12288
    buffer_load_dwordx4 v[72:75], v3, s[12:15], s25 offen offset:2048
    s_add_u32 s25, s21, 12288
    buffer_load_dwordx4 v[76:79], v3, s[12:15], s25 offen offset:3072
    s_add_u32 s25, s21, 16384
    buffer_load_dwordx4 v[80:83], v3, s[12:15], s25 offen offset:0
    s_add_u32 s25, s21, 16384
    buffer_load_dwordx4 v[84:87], v3, s[12:15], s25 offen offset:1024
    ds_read_b128 v[196:199], v7 offset:768
    ds_read_b128 v[200:203], v7 offset:784
    ds_read_b128 v[204:207], v7 offset:3072
    ds_read_b128 v[208:211], v7 offset:3088
    ds_read_b128 v[212:215], v7 offset:896
    ds_read_b128 v[216:219], v7 offset:912
    ds_read_b128 v[220:223], v7 offset:3200
    ds_read_b128 v[224:227], v7 offset:3216
    s_waitcnt vmcnt(18) lgkmcnt(4)
    v_lshlrev_b32 v228, 16, v40
    v_and_b32 v229, 0xffff0000, v40
    v_lshlrev_b32 v230, 16, v41
    v_and_b32 v231, 0xffff0000, v41
    v_lshlrev_b32 v232, 16, v42
    v_and_b32 v233, 0xffff0000, v42
    v_lshlrev_b32 v234, 16, v43
    v_and_b32 v235, 0xffff0000, v43
    v_pk_fma_f32 v[228:229], v[228:229], v[204:205], v[196:197]
    v_pk_fma_f32 v[230:231], v[230:231], v[206:207], v[198:199]
    v_pk_fma_f32 v[232:233], v[232:233], v[208:209], v[200:201]
    v_pk_fma_f32 v[234:235], v[234:235], v[210:211], v[202:203]
    v_cvt_pk_bf16_f32 v40, v228, v229
    v_cvt_pk_bf16_f32 v41, v230, v231
    v_cvt_pk_bf16_f32 v42, v232, v233
    v_cvt_pk_bf16_f32 v43, v234, v235
    ds_read_b128 v[196:199], v7 offset:1024
    ds_read_b128 v[200:203], v7 offset:1040
    ds_read_b128 v[204:207], v7 offset:3328
    ds_read_b128 v[208:211], v7 offset:3344
    s_waitcnt vmcnt(16) lgkmcnt(4)
    v_lshlrev_b32 v228, 16, v44
    v_and_b32 v229, 0xffff0000, v44
    v_lshlrev_b32 v230, 16, v45
    v_and_b32 v231, 0xffff0000, v45
    v_lshlrev_b32 v232, 16, v46
    v_and_b32 v233, 0xffff0000, v46
    v_lshlrev_b32 v234, 16, v47
    v_and_b32 v235, 0xffff0000, v47
    v_pk_fma_f32 v[228:229], v[228:229], v[220:221], v[212:213]
    v_pk_fma_f32 v[230:231], v[230:231], v[222:223], v[214:215]
    v_pk_fma_f32 v[232:233], v[232:233], v[224:225], v[216:217]
    v_pk_fma_f32 v[234:235], v[234:235], v[226:227], v[218:219]
    v_cvt_pk_bf16_f32 v44, v228, v229
    v_cvt_pk_bf16_f32 v45, v230, v231
    v_cvt_pk_bf16_f32 v46, v232, v233
    v_cvt_pk_bf16_f32 v47, v234, v235
    ds_read_b128 v[212:215], v7 offset:1152
    ds_read_b128 v[216:219], v7 offset:1168
    ds_read_b128 v[220:223], v7 offset:3456
    ds_read_b128 v[224:227], v7 offset:3472
    s_waitcnt vmcnt(14) lgkmcnt(4)
    v_lshlrev_b32 v228, 16, v48
    v_and_b32 v229, 0xffff0000, v48
    v_lshlrev_b32 v230, 16, v49
    v_and_b32 v231, 0xffff0000, v49
    v_lshlrev_b32 v232, 16, v50
    v_and_b32 v233, 0xffff0000, v50
    v_lshlrev_b32 v234, 16, v51
    v_and_b32 v235, 0xffff0000, v51
    v_pk_fma_f32 v[228:229], v[228:229], v[204:205], v[196:197]
    v_pk_fma_f32 v[230:231], v[230:231], v[206:207], v[198:199]
    v_pk_fma_f32 v[232:233], v[232:233], v[208:209], v[200:201]
    v_pk_fma_f32 v[234:235], v[234:235], v[210:211], v[202:203]
    v_cvt_pk_bf16_f32 v48, v228, v229
    v_cvt_pk_bf16_f32 v49, v230, v231
    v_cvt_pk_bf16_f32 v50, v232, v233
    v_cvt_pk_bf16_f32 v51, v234, v235
    ds_read_b128 v[196:199], v7 offset:1280
    ds_read_b128 v[200:203], v7 offset:1296
    ds_read_b128 v[204:207], v7 offset:3584
    ds_read_b128 v[208:211], v7 offset:3600
    s_waitcnt vmcnt(12) lgkmcnt(4)
    v_lshlrev_b32 v228, 16, v52
    v_and_b32 v229, 0xffff0000, v52
    v_lshlrev_b32 v230, 16, v53
    v_and_b32 v231, 0xffff0000, v53
    v_lshlrev_b32 v232, 16, v54
    v_and_b32 v233, 0xffff0000, v54
    v_lshlrev_b32 v234, 16, v55
    v_and_b32 v235, 0xffff0000, v55
    v_pk_fma_f32 v[228:229], v[228:229], v[220:221], v[212:213]
    v_pk_fma_f32 v[230:231], v[230:231], v[222:223], v[214:215]
    v_pk_fma_f32 v[232:233], v[232:233], v[224:225], v[216:217]
    v_pk_fma_f32 v[234:235], v[234:235], v[226:227], v[218:219]
    v_cvt_pk_bf16_f32 v52, v228, v229
    v_cvt_pk_bf16_f32 v53, v230, v231
    v_cvt_pk_bf16_f32 v54, v232, v233
    v_cvt_pk_bf16_f32 v55, v234, v235
    ds_read_b128 v[212:215], v7 offset:1408
    ds_read_b128 v[216:219], v7 offset:1424
    ds_read_b128 v[220:223], v7 offset:3712
    ds_read_b128 v[224:227], v7 offset:3728
    s_waitcnt vmcnt(10) lgkmcnt(4)
    v_lshlrev_b32 v228, 16, v56
    v_and_b32 v229, 0xffff0000, v56
    v_lshlrev_b32 v230, 16, v57
    v_and_b32 v231, 0xffff0000, v57
    v_lshlrev_b32 v232, 16, v58
    v_and_b32 v233, 0xffff0000, v58
    v_lshlrev_b32 v234, 16, v59
    v_and_b32 v235, 0xffff0000, v59
    v_pk_fma_f32 v[228:229], v[228:229], v[204:205], v[196:197]
    v_pk_fma_f32 v[230:231], v[230:231], v[206:207], v[198:199]
    v_pk_fma_f32 v[232:233], v[232:233], v[208:209], v[200:201]
    v_pk_fma_f32 v[234:235], v[234:235], v[210:211], v[202:203]
    v_cvt_pk_bf16_f32 v56, v228, v229
    v_cvt_pk_bf16_f32 v57, v230, v231
    v_cvt_pk_bf16_f32 v58, v232, v233
    v_cvt_pk_bf16_f32 v59, v234, v235
    s_waitcnt vmcnt(8) lgkmcnt(0)
    v_lshlrev_b32 v228, 16, v60
    v_and_b32 v229, 0xffff0000, v60
    v_lshlrev_b32 v230, 16, v61
    v_and_b32 v231, 0xffff0000, v61
    v_lshlrev_b32 v232, 16, v62
    v_and_b32 v233, 0xffff0000, v62
    v_lshlrev_b32 v234, 16, v63
    v_and_b32 v235, 0xffff0000, v63
    v_pk_fma_f32 v[228:229], v[228:229], v[220:221], v[212:213]
    v_pk_fma_f32 v[230:231], v[230:231], v[222:223], v[214:215]
    v_pk_fma_f32 v[232:233], v[232:233], v[224:225], v[216:217]
    v_pk_fma_f32 v[234:235], v[234:235], v[226:227], v[218:219]
    v_cvt_pk_bf16_f32 v60, v228, v229
    v_cvt_pk_bf16_f32 v61, v230, v231
    v_cvt_pk_bf16_f32 v62, v232, v233
    v_cvt_pk_bf16_f32 v63, v234, v235
    ds_read_b128 v[124:127], v3 offset:0
    ds_read_b128 v[128:131], v3 offset:1024
    ds_read_b128 v[132:135], v3 offset:2048
    ds_read_b128 v[136:139], v3 offset:3072
    ds_read_b128 v[140:143], v3 offset:4096
    ds_read_b128 v[144:147], v3 offset:5120
    ds_read_b128 v[148:151], v3 offset:6144
    ds_read_b128 v[152:155], v3 offset:7168
    ds_read_b128 v[156:159], v3 offset:8192
    s_waitcnt lgkmcnt(6)
    v_mfma_f32_16x16x32_bf16 v[88:91], v[16:19], v[124:127], v[88:91]
    ds_read_b128 v[160:163], v3 offset:9216
    v_mfma_f32_16x16x32_bf16 v[92:95], v[16:19], v[128:131], v[92:95]
    ds_read_b128 v[164:167], v3 offset:10240
    v_mfma_f32_16x16x32_bf16 v[96:99], v[16:19], v[132:135], v[96:99]
    ds_read_b128 v[168:171], v3 offset:11264
    s_waitcnt lgkmcnt(6)
    v_mfma_f32_16x16x32_bf16 v[100:103], v[16:19], v[136:139], v[100:103]
    ds_read_b128 v[172:175], v3 offset:12288
    v_mfma_f32_16x16x32_bf16 v[104:107], v[16:19], v[140:143], v[104:107]
    ds_read_b128 v[176:179], v3 offset:13312
    v_mfma_f32_16x16x32_bf16 v[108:111], v[16:19], v[144:147], v[108:111]
    ds_read_b128 v[180:183], v3 offset:14336
    s_waitcnt lgkmcnt(6)
    v_mfma_f32_16x16x32_bf16 v[112:115], v[16:19], v[148:151], v[112:115]
    ds_read_b128 v[184:187], v3 offset:15360
    v_mfma_f32_16x16x32_bf16 v[116:119], v[16:19], v[152:155], v[116:119]
    ds_read_b128 v[188:191], v3 offset:16384
    v_mfma_f32_16x16x32_bf16 v[120:123], v[16:19], v[156:159], v[120:123]
    ds_read_b128 v[192:195], v3 offset:17408
    s_waitcnt lgkmcnt(6)
    v_mfma_f32_16x16x32_bf16 v[88:91], v[20:23], v[160:163], v[88:91]
    ds_read_b128 v[124:127], v3 offset:18432
    v_mfma_f32_16x16x32_bf16 v[92:95], v[20:23], v[164:167], v[92:95]
    ds_read_b128 v[128:131], v3 offset:19456
    v_mfma_f32_16x16x32_bf16 v[96:99], v[20:23], v[168:171], v[96:99]
    ds_read_b128 v[132:135], v3 offset:20480
    s_waitcnt lgkmcnt(6)
    v_mfma_f32_16x16x32_bf16 v[100:103], v[20:23], v[172:175], v[100:103]
    ds_read_b128 v[136:139], v3 offset:21504
    v_mfma_f32_16x16x32_bf16 v[104:107], v[20:23], v[176:179], v[104:107]
    ds_read_b128 v[140:143], v3 offset:22528
    v_mfma_f32_16x16x32_bf16 v[108:111], v[20:23], v[180:183], v[108:111]
    ds_read_b128 v[144:147], v3 offset:23552
    s_waitcnt lgkmcnt(6)
    v_mfma_f32_16x16x32_bf16 v[112:115], v[20:23], v[184:187], v[112:115]
    ds_read_b128 v[148:151], v3 offset:24576
    v_mfma_f32_16x16x32_bf16 v[116:119], v[20:23], v[188:191], v[116:119]
    ds_read_b128 v[152:155], v3 offset:25600
    v_mfma_f32_16x16x32_bf16 v[120:123], v[20:23], v[192:195], v[120:123]
    ds_read_b128 v[156:159], v3 offset:26624
    s_waitcnt lgkmcnt(6)
    v_mfma_f32_16x16x32_bf16 v[88:91], v[24:27], v[124:127], v[88:91]
    ds_read_b128 v[160:163], v3 offset:27648
    v_mfma_f32_16x16x32_bf16 v[92:95], v[24:27], v[128:131], v[92:95]
    ds_read_b128 v[164:167], v3 offset:28672
    v_mfma_f32_16x16x32_bf16 v[96:99], v[24:27], v[132:135], v[96:99]
    ds_read_b128 v[168:171], v3 offset:29696
    s_waitcnt lgkmcnt(6)
    v_mfma_f32_16x16x32_bf16 v[100:103], v[24:27], v[136:139], v[100:103]
    ds_read_b128 v[172:175], v3 offset:30720
    v_mfma_f32_16x16x32_bf16 v[104:107], v[24:27], v[140:143], v[104:107]
    ds_read_b128 v[176:179], v3 offset:31744
    v_mfma_f32_16x16x32_bf16 v[108:111], v[24:27], v[144:147], v[108:111]
    ds_read_b128 v[180:183], v3 offset:32768
    s_waitcnt lgkmcnt(6)
    v_mfma_f32_16x16x32_bf16 v[112:115], v[24:27], v[148:151], v[112:115]
    ds_read_b128 v[184:187], v3 offset:33792
    v_mfma_f32_16x16x32_bf16 v[116:119], v[24:27], v[152:155], v[116:119]
    ds_read_b128 v[188:191], v3 offset:34816
    v_mfma_f32_16x16x32_bf16 v[120:123], v[24:27], v[156:159], v[120:123]
    ds_read_b128 v[192:195], v3 offset:35840
    s_waitcnt lgkmcnt(6)
    v_mfma_f32_16x16x32_bf16 v[88:91], v[28:31], v[160:163], v[88:91]
    ds_read_b128 v[124:127], v3 offset:36864
    v_mfma_f32_16x16x32_bf16 v[92:95], v[28:31], v[164:167], v[92:95]
    ds_read_b128 v[128:131], v3 offset:37888
    v_mfma_f32_16x16x32_bf16 v[96:99], v[28:31], v[168:171], v[96:99]
    ds_read_b128 v[132:135], v3 offset:38912
    s_waitcnt lgkmcnt(6)
    v_mfma_f32_16x16x32_bf16 v[100:103], v[28:31], v[172:175], v[100:103]
    ds_read_b128 v[136:139], v3 offset:39936
    v_mfma_f32_16x16x32_bf16 v[104:107], v[28:31], v[176:179], v[104:107]
    ds_read_b128 v[140:143], v3 offset:40960
    v_mfma_f32_16x16x32_bf16 v[108:111], v[28:31], v[180:183], v[108:111]
    ds_read_b128 v[144:147], v3 offset:41984
    s_waitcnt lgkmcnt(6)
    v_mfma_f32_16x16x32_bf16 v[112:115], v[28:31], v[184:187], v[112:115]
    ds_read_b128 v[148:151], v3 offset:43008
    v_mfma_f32_16x16x32_bf16 v[116:119], v[28:31], v[188:191], v[116:119]
    ds_read_b128 v[152:155], v3 offset:44032
    v_mfma_f32_16x16x32_bf16 v[120:123], v[28:31], v[192:195], v[120:123]
    ds_read_b128 v[156:159], v3 offset:45056
    s_waitcnt lgkmcnt(6)
    v_mfma_f32_16x16x32_bf16 v[88:91], v[32:35], v[124:127], v[88:91]
    ds_read_b128 v[160:163], v3 offset:46080
    v_mfma_f32_16x16x32_bf16 v[92:95], v[32:35], v[128:131], v[92:95]
    ds_read_b128 v[164:167], v3 offset:47104
    v_mfma_f32_16x16x32_bf16 v[96:99], v[32:35], v[132:135], v[96:99]
    ds_read_b128 v[168:171], v3 offset:48128
    s_waitcnt lgkmcnt(6)
    v_mfma_f32_16x16x32_bf16 v[100:103], v[32:35], v[136:139], v[100:103]
    ds_read_b128 v[172:175], v3 offset:49152
    v_mfma_f32_16x16x32_bf16 v[104:107], v[32:35], v[140:143], v[104:107]
    ds_read_b128 v[176:179], v3 offset:50176
    v_mfma_f32_16x16x32_bf16 v[108:111], v[32:35], v[144:147], v[108:111]
    ds_read_b128 v[180:183], v3 offset:51200
    s_waitcnt lgkmcnt(6)
    v_mfma_f32_16x16x32_bf16 v[112:115], v[32:35], v[148:151], v[112:115]
    ds_read_b128 v[184:187], v3 offset:52224
    v_mfma_f32_16x16x32_bf16 v[116:119], v[32:35], v[152:155], v[116:119]
    ds_read_b128 v[188:191], v3 offset:53248
    v_mfma_f32_16x16x32_bf16 v[120:123], v[32:35], v[156:159], v[120:123]
    ds_read_b128 v[192:195], v3 offset:54272
    s_waitcnt lgkmcnt(6)
    v_mfma_f32_16x16x32_bf16 v[88:91], v[36:39], v[160:163], v[88:91]
    v_mfma_f32_16x16x32_bf16 v[92:95], v[36:39], v[164:167], v[92:95]
    v_mfma_f32_16x16x32_bf16 v[96:99], v[36:39], v[168:171], v[96:99]
    s_waitcnt lgkmcnt(3)
    v_mfma_f32_16x16x32_bf16 v[100:103], v[36:39], v[172:175], v[100:103]
    v_mfma_f32_16x16x32_bf16 v[104:107], v[36:39], v[176:179], v[104:107]
    v_mfma_f32_16x16x32_bf16 v[108:111], v[36:39], v[180:183], v[108:111]
    s_waitcnt lgkmcnt(0)
    v_mfma_f32_16x16x32_bf16 v[112:115], v[36:39], v[184:187], v[112:115]
    v_mfma_f32_16x16x32_bf16 v[116:119], v[36:39], v[188:191], v[116:119]
    v_mfma_f32_16x16x32_bf16 v[120:123], v[36:39], v[192:195], v[120:123]
    s_waitcnt vmcnt(6)
    s_barrier
    s_add_u32 m0, s23, 0
    s_add_u32 s24, s22, 110592
    buffer_load_dwordx4 v3, s[16:19], s24 offen offset:0 lds
    buffer_load_dwordx4 v3, s[16:19], s24 offen offset:1024 lds
    buffer_load_dwordx4 v3, s[16:19], s24 offen offset:2048 lds
    buffer_load_dwordx4 v3, s[16:19], s24 offen offset:3072 lds
    s_add_u32 m0, s23, 4096
    s_add_u32 s24, s22, 114688
    buffer_load_dwordx4 v3, s[16:19], s24 offen offset:0 lds
    buffer_load_dwordx4 v3, s[16:19], s24 offen offset:1024 lds
    buffer_load_dwordx4 v3, s[16:19], s24 offen offset:2048 lds
    ds_read_b128 v[196:199], v7 offset:1536
    ds_read_b128 v[200:203], v7 offset:1552
    ds_read_b128 v[204:207], v7 offset:3840
    ds_read_b128 v[208:211], v7 offset:3856
    ds_read_b128 v[212:215], v7 offset:1664
    ds_read_b128 v[216:219], v7 offset:1680
    ds_read_b128 v[220:223], v7 offset:3968
    ds_read_b128 v[224:227], v7 offset:3984
    s_waitcnt vmcnt(12) lgkmcnt(4)
    v_lshlrev_b32 v228, 16, v64
    v_and_b32 v229, 0xffff0000, v64
    v_lshlrev_b32 v230, 16, v65
    v_and_b32 v231, 0xffff0000, v65
    v_lshlrev_b32 v232, 16, v66
    v_and_b32 v233, 0xffff0000, v66
    v_lshlrev_b32 v234, 16, v67
    v_and_b32 v235, 0xffff0000, v67
    v_pk_fma_f32 v[228:229], v[228:229], v[204:205], v[196:197]
    v_pk_fma_f32 v[230:231], v[230:231], v[206:207], v[198:199]
    v_pk_fma_f32 v[232:233], v[232:233], v[208:209], v[200:201]
    v_pk_fma_f32 v[234:235], v[234:235], v[210:211], v[202:203]
    v_cvt_pk_bf16_f32 v64, v228, v229
    v_cvt_pk_bf16_f32 v65, v230, v231
    v_cvt_pk_bf16_f32 v66, v232, v233
    v_cvt_pk_bf16_f32 v67, v234, v235
    ds_read_b128 v[196:199], v7 offset:1792
    ds_read_b128 v[200:203], v7 offset:1808
    ds_read_b128 v[204:207], v7 offset:4096
    ds_read_b128 v[208:211], v7 offset:4112
    s_waitcnt vmcnt(11) lgkmcnt(4)
    v_lshlrev_b32 v228, 16, v68
    v_and_b32 v229, 0xffff0000, v68
    v_lshlrev_b32 v230, 16, v69
    v_and_b32 v231, 0xffff0000, v69
    v_lshlrev_b32 v232, 16, v70
    v_and_b32 v233, 0xffff0000, v70
    v_lshlrev_b32 v234, 16, v71
    v_and_b32 v235, 0xffff0000, v71
    v_pk_fma_f32 v[228:229], v[228:229], v[220:221], v[212:213]
    v_pk_fma_f32 v[230:231], v[230:231], v[222:223], v[214:215]
    v_pk_fma_f32 v[232:233], v[232:233], v[224:225], v[216:217]
    v_pk_fma_f32 v[234:235], v[234:235], v[226:227], v[218:219]
    v_cvt_pk_bf16_f32 v68, v228, v229
    v_cvt_pk_bf16_f32 v69, v230, v231
    v_cvt_pk_bf16_f32 v70, v232, v233
    v_cvt_pk_bf16_f32 v71, v234, v235
    ds_read_b128 v[212:215], v7 offset:1920
    ds_read_b128 v[216:219], v7 offset:1936
    ds_read_b128 v[220:223], v7 offset:4224
    ds_read_b128 v[224:227], v7 offset:4240
    s_waitcnt vmcnt(10) lgkmcnt(4)
    v_lshlrev_b32 v228, 16, v72
    v_and_b32 v229, 0xffff0000, v72
    v_lshlrev_b32 v230, 16, v73
    v_and_b32 v231, 0xffff0000, v73
    v_lshlrev_b32 v232, 16, v74
    v_and_b32 v233, 0xffff0000, v74
    v_lshlrev_b32 v234, 16, v75
    v_and_b32 v235, 0xffff0000, v75
    v_pk_fma_f32 v[228:229], v[228:229], v[204:205], v[196:197]
    v_pk_fma_f32 v[230:231], v[230:231], v[206:207], v[198:199]
    v_pk_fma_f32 v[232:233], v[232:233], v[208:209], v[200:201]
    v_pk_fma_f32 v[234:235], v[234:235], v[210:211], v[202:203]
    v_cvt_pk_bf16_f32 v72, v228, v229
    v_cvt_pk_bf16_f32 v73, v230, v231
    v_cvt_pk_bf16_f32 v74, v232, v233
    v_cvt_pk_bf16_f32 v75, v234, v235
    ds_read_b128 v[196:199], v7 offset:2048
    ds_read_b128 v[200:203], v7 offset:2064
    ds_read_b128 v[204:207], v7 offset:4352
    ds_read_b128 v[208:211], v7 offset:4368
    s_waitcnt vmcnt(9) lgkmcnt(4)
    v_lshlrev_b32 v228, 16, v76
    v_and_b32 v229, 0xffff0000, v76
    v_lshlrev_b32 v230, 16, v77
    v_and_b32 v231, 0xffff0000, v77
    v_lshlrev_b32 v232, 16, v78
    v_and_b32 v233, 0xffff0000, v78
    v_lshlrev_b32 v234, 16, v79
    v_and_b32 v235, 0xffff0000, v79
    v_pk_fma_f32 v[228:229], v[228:229], v[220:221], v[212:213]
    v_pk_fma_f32 v[230:231], v[230:231], v[222:223], v[214:215]
    v_pk_fma_f32 v[232:233], v[232:233], v[224:225], v[216:217]
    v_pk_fma_f32 v[234:235], v[234:235], v[226:227], v[218:219]
    v_cvt_pk_bf16_f32 v76, v228, v229
    v_cvt_pk_bf16_f32 v77, v230, v231
    v_cvt_pk_bf16_f32 v78, v232, v233
    v_cvt_pk_bf16_f32 v79, v234, v235
    ds_read_b128 v[212:215], v7 offset:2176
    ds_read_b128 v[216:219], v7 offset:2192
    ds_read_b128 v[220:223], v7 offset:4480
    ds_read_b128 v[224:227], v7 offset:4496
    s_waitcnt vmcnt(8) lgkmcnt(4)
    v_lshlrev_b32 v228, 16, v80
    v_and_b32 v229, 0xffff0000, v80
    v_lshlrev_b32 v230, 16, v81
    v_and_b32 v231, 0xffff0000, v81
    v_lshlrev_b32 v232, 16, v82
    v_and_b32 v233, 0xffff0000, v82
    v_lshlrev_b32 v234, 16, v83
    v_and_b32 v235, 0xffff0000, v83
    v_pk_fma_f32 v[228:229], v[228:229], v[204:205], v[196:197]
    v_pk_fma_f32 v[230:231], v[230:231], v[206:207], v[198:199]
    v_pk_fma_f32 v[232:233], v[232:233], v[208:209], v[200:201]
    v_pk_fma_f32 v[234:235], v[234:235], v[210:211], v[202:203]
    v_cvt_pk_bf16_f32 v80, v228, v229
    v_cvt_pk_bf16_f32 v81, v230, v231
    v_cvt_pk_bf16_f32 v82, v232, v233
    v_cvt_pk_bf16_f32 v83, v234, v235
    s_waitcnt vmcnt(7) lgkmcnt(0)
    v_lshlrev_b32 v228, 16, v84
    v_and_b32 v229, 0xffff0000, v84
    v_lshlrev_b32 v230, 16, v85
    v_and_b32 v231, 0xffff0000, v85
    v_lshlrev_b32 v232, 16, v86
    v_and_b32 v233, 0xffff0000, v86
    v_lshlrev_b32 v234, 16, v87
    v_and_b32 v235, 0xffff0000, v87
    v_pk_fma_f32 v[228:229], v[228:229], v[220:221], v[212:213]
    v_pk_fma_f32 v[230:231], v[230:231], v[222:223], v[214:215]
    v_pk_fma_f32 v[232:233], v[232:233], v[224:225], v[216:217]
    v_pk_fma_f32 v[234:235], v[234:235], v[226:227], v[218:219]
    v_cvt_pk_bf16_f32 v84, v228, v229
    v_cvt_pk_bf16_f32 v85, v230, v231
    v_cvt_pk_bf16_f32 v86, v232, v233
    v_cvt_pk_bf16_f32 v87, v234, v235
    ds_read_b128 v[124:127], v8 offset:0
    ds_read_b128 v[128:131], v8 offset:1024
    ds_read_b128 v[132:135], v8 offset:2048
    ds_read_b128 v[136:139], v8 offset:3072
    ds_read_b128 v[140:143], v8 offset:4096
    ds_read_b128 v[144:147], v8 offset:5120
    ds_read_b128 v[148:151], v8 offset:6144
    ds_read_b128 v[152:155], v8 offset:7168
    ds_read_b128 v[156:159], v8 offset:8192
    s_waitcnt lgkmcnt(6)
    v_mfma_f32_16x16x32_bf16 v[88:91], v[40:43], v[124:127], v[88:91]
    ds_read_b128 v[160:163], v8 offset:9216
    v_mfma_f32_16x16x32_bf16 v[92:95], v[40:43], v[128:131], v[92:95]
    ds_read_b128 v[164:167], v8 offset:10240
    v_mfma_f32_16x16x32_bf16 v[96:99], v[40:43], v[132:135], v[96:99]
    ds_read_b128 v[168:171], v8 offset:11264
    s_waitcnt lgkmcnt(6)
    v_mfma_f32_16x16x32_bf16 v[100:103], v[40:43], v[136:139], v[100:103]
    ds_read_b128 v[172:175], v8 offset:12288
    v_mfma_f32_16x16x32_bf16 v[104:107], v[40:43], v[140:143], v[104:107]
    ds_read_b128 v[176:179], v8 offset:13312
    v_mfma_f32_16x16x32_bf16 v[108:111], v[40:43], v[144:147], v[108:111]
    ds_read_b128 v[180:183], v8 offset:14336
    s_waitcnt lgkmcnt(6)
    v_mfma_f32_16x16x32_bf16 v[112:115], v[40:43], v[148:151], v[112:115]
    ds_read_b128 v[184:187], v8 offset:15360
    v_mfma_f32_16x16x32_bf16 v[116:119], v[40:43], v[152:155], v[116:119]
    ds_read_b128 v[188:191], v8 offset:16384
    v_mfma_f32_16x16x32_bf16 v[120:123], v[40:43], v[156:159], v[120:123]
    ds_read_b128 v[192:195], v8 offset:17408
    s_waitcnt lgkmcnt(6)
    v_mfma_f32_16x16x32_bf16 v[88:91], v[44:47], v[160:163], v[88:91]
    ds_read_b128 v[124:127], v8 offset:18432
    v_mfma_f32_16x16x32_bf16 v[92:95], v[44:47], v[164:167], v[92:95]
    ds_read_b128 v[128:131], v8 offset:19456
    v_mfma_f32_16x16x32_bf16 v[96:99], v[44:47], v[168:171], v[96:99]
    ds_read_b128 v[132:135], v8 offset:20480
    s_waitcnt lgkmcnt(6)
    v_mfma_f32_16x16x32_bf16 v[100:103], v[44:47], v[172:175], v[100:103]
    ds_read_b128 v[136:139], v8 offset:21504
    v_mfma_f32_16x16x32_bf16 v[104:107], v[44:47], v[176:179], v[104:107]
    ds_read_b128 v[140:143], v8 offset:22528
    v_mfma_f32_16x16x32_bf16 v[108:111], v[44:47], v[180:183], v[108:111]
    ds_read_b128 v[144:147], v8 offset:23552
    s_waitcnt lgkmcnt(6)
    v_mfma_f32_16x16x32_bf16 v[112:115], v[44:47], v[184:187], v[112:115]
    ds_read_b128 v[148:151], v8 offset:24576
    v_mfma_f32_16x16x32_bf16 v[116:119], v[44:47], v[188:191], v[116:119]
    ds_read_b128 v[152:155], v8 offset:25600
    v_mfma_f32_16x16x32_bf16 v[120:123], v[44:47], v[192:195], v[120:123]
    ds_read_b128 v[156:159], v8 offset:26624
    s_waitcnt lgkmcnt(6)
    v_mfma_f32_16x16x32_bf16 v[88:91], v[48:51], v[124:127], v[88:91]
    ds_read_b128 v[160:163], v8 offset:27648
    v_mfma_f32_16x16x32_bf16 v[92:95], v[48:51], v[128:131], v[92:95]
    ds_read_b128 v[164:167], v8 offset:28672
    v_mfma_f32_16x16x32_bf16 v[96:99], v[48:51], v[132:135], v[96:99]
    ds_read_b128 v[168:171], v8 offset:29696
    s_waitcnt lgkmcnt(6)
    v_mfma_f32_16x16x32_bf16 v[100:103], v[48:51], v[136:139], v[100:103]
    ds_read_b128 v[172:175], v8 offset:30720
    v_mfma_f32_16x16x32_bf16 v[104:107], v[48:51], v[140:143], v[104:107]
    ds_read_b128 v[176:179], v8 offset:31744
    v_mfma_f32_16x16x32_bf16 v[108:111], v[48:51], v[144:147], v[108:111]
    ds_read_b128 v[180:183], v8 offset:32768
    s_waitcnt lgkmcnt(6)
    v_mfma_f32_16x16x32_bf16 v[112:115], v[48:51], v[148:151], v[112:115]
    ds_read_b128 v[184:187], v8 offset:33792
    v_mfma_f32_16x16x32_bf16 v[116:119], v[48:51], v[152:155], v[116:119]
    ds_read_b128 v[188:191], v8 offset:34816
    v_mfma_f32_16x16x32_bf16 v[120:123], v[48:51], v[156:159], v[120:123]
    ds_read_b128 v[192:195], v8 offset:35840
    s_waitcnt lgkmcnt(6)
    v_mfma_f32_16x16x32_bf16 v[88:91], v[52:55], v[160:163], v[88:91]
    ds_read_b128 v[124:127], v8 offset:36864
    v_mfma_f32_16x16x32_bf16 v[92:95], v[52:55], v[164:167], v[92:95]
    ds_read_b128 v[128:131], v8 offset:37888
    v_mfma_f32_16x16x32_bf16 v[96:99], v[52:55], v[168:171], v[96:99]
    ds_read_b128 v[132:135], v8 offset:38912
    s_waitcnt lgkmcnt(6)
    v_mfma_f32_16x16x32_bf16 v[100:103], v[52:55], v[172:175], v[100:103]
    ds_read_b128 v[136:139], v8 offset:39936
    v_mfma_f32_16x16x32_bf16 v[104:107], v[52:55], v[176:179], v[104:107]
    ds_read_b128 v[140:143], v8 offset:40960
    v_mfma_f32_16x16x32_bf16 v[108:111], v[52:55], v[180:183], v[108:111]
    ds_read_b128 v[144:147], v8 offset:41984
    s_waitcnt lgkmcnt(6)
    v_mfma_f32_16x16x32_bf16 v[112:115], v[52:55], v[184:187], v[112:115]
    ds_read_b128 v[148:151], v8 offset:43008
    v_mfma_f32_16x16x32_bf16 v[116:119], v[52:55], v[188:191], v[116:119]
    ds_read_b128 v[152:155], v8 offset:44032
    v_mfma_f32_16x16x32_bf16 v[120:123], v[52:55], v[192:195], v[120:123]
    ds_read_b128 v[156:159], v8 offset:45056
    s_waitcnt lgkmcnt(6)
    v_mfma_f32_16x16x32_bf16 v[88:91], v[56:59], v[124:127], v[88:91]
    ds_read_b128 v[160:163], v8 offset:46080
    v_mfma_f32_16x16x32_bf16 v[92:95], v[56:59], v[128:131], v[92:95]
    ds_read_b128 v[164:167], v8 offset:47104
    v_mfma_f32_16x16x32_bf16 v[96:99], v[56:59], v[132:135], v[96:99]
    ds_read_b128 v[168:171], v8 offset:48128
    s_waitcnt lgkmcnt(6)
    v_mfma_f32_16x16x32_bf16 v[100:103], v[56:59], v[136:139], v[100:103]
    ds_read_b128 v[172:175], v8 offset:49152
    v_mfma_f32_16x16x32_bf16 v[104:107], v[56:59], v[140:143], v[104:107]
    ds_read_b128 v[176:179], v8 offset:50176
    v_mfma_f32_16x16x32_bf16 v[108:111], v[56:59], v[144:147], v[108:111]
    ds_read_b128 v[180:183], v8 offset:51200
    s_waitcnt lgkmcnt(6)
    v_mfma_f32_16x16x32_bf16 v[112:115], v[56:59], v[148:151], v[112:115]
    ds_read_b128 v[184:187], v8 offset:52224
    v_mfma_f32_16x16x32_bf16 v[116:119], v[56:59], v[152:155], v[116:119]
    ds_read_b128 v[188:191], v8 offset:53248
    v_mfma_f32_16x16x32_bf16 v[120:123], v[56:59], v[156:159], v[120:123]
    ds_read_b128 v[192:195], v8 offset:54272
    s_waitcnt lgkmcnt(6)
    v_mfma_f32_16x16x32_bf16 v[88:91], v[60:63], v[160:163], v[88:91]
    v_mfma_f32_16x16x32_bf16 v[92:95], v[60:63], v[164:167], v[92:95]
    v_mfma_f32_16x16x32_bf16 v[96:99], v[60:63], v[168:171], v[96:99]
    s_waitcnt lgkmcnt(3)
    v_mfma_f32_16x16x32_bf16 v[100:103], v[60:63], v[172:175], v[100:103]
    v_mfma_f32_16x16x32_bf16 v[104:107], v[60:63], v[176:179], v[104:107]
    v_mfma_f32_16x16x32_bf16 v[108:111], v[60:63], v[180:183], v[108:111]
    s_waitcnt lgkmcnt(0)
    v_mfma_f32_16x16x32_bf16 v[112:115], v[60:63], v[184:187], v[112:115]
    v_mfma_f32_16x16x32_bf16 v[116:119], v[60:63], v[188:191], v[116:119]
    v_mfma_f32_16x16x32_bf16 v[120:123], v[60:63], v[192:195], v[120:123]
    s_waitcnt vmcnt(0)
    s_barrier
    ds_read_b128 v[124:127], v3 offset:0
    ds_read_b128 v[128:131], v3 offset:1024
    ds_read_b128 v[132:135], v3 offset:2048
    ds_read_b128 v[136:139], v3 offset:3072
    ds_read_b128 v[140:143], v3 offset:4096
    ds_read_b128 v[144:147], v3 offset:5120
    ds_read_b128 v[148:151], v3 offset:6144
    ds_read_b128 v[152:155], v3 offset:7168
    ds_read_b128 v[156:159], v3 offset:8192
    s_waitcnt lgkmcnt(6)
    v_mfma_f32_16x16x32_bf16 v[88:91], v[64:67], v[124:127], v[88:91]
    ds_read_b128 v[160:163], v3 offset:9216
    v_mfma_f32_16x16x32_bf16 v[92:95], v[64:67], v[128:131], v[92:95]
    ds_read_b128 v[164:167], v3 offset:10240
    v_mfma_f32_16x16x32_bf16 v[96:99], v[64:67], v[132:135], v[96:99]
    ds_read_b128 v[168:171], v3 offset:11264
    s_waitcnt lgkmcnt(6)
    v_mfma_f32_16x16x32_bf16 v[100:103], v[64:67], v[136:139], v[100:103]
    ds_read_b128 v[172:175], v3 offset:12288
    v_mfma_f32_16x16x32_bf16 v[104:107], v[64:67], v[140:143], v[104:107]
    ds_read_b128 v[176:179], v3 offset:13312
    v_mfma_f32_16x16x32_bf16 v[108:111], v[64:67], v[144:147], v[108:111]
    ds_read_b128 v[180:183], v3 offset:14336
    s_waitcnt lgkmcnt(6)
    v_mfma_f32_16x16x32_bf16 v[112:115], v[64:67], v[148:151], v[112:115]
    ds_read_b128 v[184:187], v3 offset:15360
    v_mfma_f32_16x16x32_bf16 v[116:119], v[64:67], v[152:155], v[116:119]
    ds_read_b128 v[188:191], v3 offset:16384
    v_mfma_f32_16x16x32_bf16 v[120:123], v[64:67], v[156:159], v[120:123]
    ds_read_b128 v[192:195], v3 offset:17408
    s_waitcnt lgkmcnt(6)
    v_mfma_f32_16x16x32_bf16 v[88:91], v[68:71], v[160:163], v[88:91]
    ds_read_b128 v[124:127], v3 offset:18432
    v_mfma_f32_16x16x32_bf16 v[92:95], v[68:71], v[164:167], v[92:95]
    ds_read_b128 v[128:131], v3 offset:19456
    v_mfma_f32_16x16x32_bf16 v[96:99], v[68:71], v[168:171], v[96:99]
    ds_read_b128 v[132:135], v3 offset:20480
    s_waitcnt lgkmcnt(6)
    v_mfma_f32_16x16x32_bf16 v[100:103], v[68:71], v[172:175], v[100:103]
    ds_read_b128 v[136:139], v3 offset:21504
    v_mfma_f32_16x16x32_bf16 v[104:107], v[68:71], v[176:179], v[104:107]
    ds_read_b128 v[140:143], v3 offset:22528
    v_mfma_f32_16x16x32_bf16 v[108:111], v[68:71], v[180:183], v[108:111]
    ds_read_b128 v[144:147], v3 offset:23552
    s_waitcnt lgkmcnt(6)
    v_mfma_f32_16x16x32_bf16 v[112:115], v[68:71], v[184:187], v[112:115]
    ds_read_b128 v[148:151], v3 offset:24576
    v_mfma_f32_16x16x32_bf16 v[116:119], v[68:71], v[188:191], v[116:119]
    ds_read_b128 v[152:155], v3 offset:25600
    v_mfma_f32_16x16x32_bf16 v[120:123], v[68:71], v[192:195], v[120:123]
    ds_read_b128 v[156:159], v3 offset:26624
    s_waitcnt lgkmcnt(6)
    v_mfma_f32_16x16x32_bf16 v[88:91], v[72:75], v[124:127], v[88:91]
    ds_read_b128 v[160:163], v3 offset:27648
    v_mfma_f32_16x16x32_bf16 v[92:95], v[72:75], v[128:131], v[92:95]
    ds_read_b128 v[164:167], v3 offset:28672
    v_mfma_f32_16x16x32_bf16 v[96:99], v[72:75], v[132:135], v[96:99]
    ds_read_b128 v[168:171], v3 offset:29696
    s_waitcnt lgkmcnt(6)
    v_mfma_f32_16x16x32_bf16 v[100:103], v[72:75], v[136:139], v[100:103]
    ds_read_b128 v[172:175], v3 offset:30720
    v_mfma_f32_16x16x32_bf16 v[104:107], v[72:75], v[140:143], v[104:107]
    ds_read_b128 v[176:179], v3 offset:31744
    v_mfma_f32_16x16x32_bf16 v[108:111], v[72:75], v[144:147], v[108:111]
    ds_read_b128 v[180:183], v3 offset:32768
    s_waitcnt lgkmcnt(6)
    v_mfma_f32_16x16x32_bf16 v[112:115], v[72:75], v[148:151], v[112:115]
    ds_read_b128 v[184:187], v3 offset:33792
    v_mfma_f32_16x16x32_bf16 v[116:119], v[72:75], v[152:155], v[116:119]
    ds_read_b128 v[188:191], v3 offset:34816
    v_mfma_f32_16x16x32_bf16 v[120:123], v[72:75], v[156:159], v[120:123]
    ds_read_b128 v[192:195], v3 offset:35840
    s_waitcnt lgkmcnt(6)
    v_mfma_f32_16x16x32_bf16 v[88:91], v[76:79], v[160:163], v[88:91]
    ds_read_b128 v[124:127], v3 offset:36864
    v_mfma_f32_16x16x32_bf16 v[92:95], v[76:79], v[164:167], v[92:95]
    ds_read_b128 v[128:131], v3 offset:37888
    v_mfma_f32_16x16x32_bf16 v[96:99], v[76:79], v[168:171], v[96:99]
    ds_read_b128 v[132:135], v3 offset:38912
    s_waitcnt lgkmcnt(6)
    v_mfma_f32_16x16x32_bf16 v[100:103], v[76:79], v[172:175], v[100:103]
    ds_read_b128 v[136:139], v3 offset:39936
    v_mfma_f32_16x16x32_bf16 v[104:107], v[76:79], v[176:179], v[104:107]
    ds_read_b128 v[140:143], v3 offset:40960
    v_mfma_f32_16x16x32_bf16 v[108:111], v[76:79], v[180:183], v[108:111]
    ds_read_b128 v[144:147], v3 offset:41984
    s_waitcnt lgkmcnt(6)
    v_mfma_f32_16x16x32_bf16 v[112:115], v[76:79], v[184:187], v[112:115]
    ds_read_b128 v[148:151], v3 offset:43008
    v_mfma_f32_16x16x32_bf16 v[116:119], v[76:79], v[188:191], v[116:119]
    ds_read_b128 v[152:155], v3 offset:44032
    v_mfma_f32_16x16x32_bf16 v[120:123], v[76:79], v[192:195], v[120:123]
    ds_read_b128 v[156:159], v3 offset:45056
    s_waitcnt lgkmcnt(6)
    v_mfma_f32_16x16x32_bf16 v[88:91], v[80:83], v[124:127], v[88:91]
    ds_read_b128 v[160:163], v3 offset:46080
    v_mfma_f32_16x16x32_bf16 v[92:95], v[80:83], v[128:131], v[92:95]
    ds_read_b128 v[164:167], v3 offset:47104
    v_mfma_f32_16x16x32_bf16 v[96:99], v[80:83], v[132:135], v[96:99]
    ds_read_b128 v[168:171], v3 offset:48128
    s_waitcnt lgkmcnt(6)
    v_mfma_f32_16x16x32_bf16 v[100:103], v[80:83], v[136:139], v[100:103]
    ds_read_b128 v[172:175], v3 offset:49152
    v_mfma_f32_16x16x32_bf16 v[104:107], v[80:83], v[140:143], v[104:107]
    ds_read_b128 v[176:179], v3 offset:50176
    v_mfma_f32_16x16x32_bf16 v[108:111], v[80:83], v[144:147], v[108:111]
    ds_read_b128 v[180:183], v3 offset:51200
    s_waitcnt lgkmcnt(6)
    v_mfma_f32_16x16x32_bf16 v[112:115], v[80:83], v[148:151], v[112:115]
    ds_read_b128 v[184:187], v3 offset:52224
    v_mfma_f32_16x16x32_bf16 v[116:119], v[80:83], v[152:155], v[116:119]
    ds_read_b128 v[188:191], v3 offset:53248
    v_mfma_f32_16x16x32_bf16 v[120:123], v[80:83], v[156:159], v[120:123]
    ds_read_b128 v[192:195], v3 offset:54272
    s_waitcnt lgkmcnt(6)
    v_mfma_f32_16x16x32_bf16 v[88:91], v[84:87], v[160:163], v[88:91]
    v_mfma_f32_16x16x32_bf16 v[92:95], v[84:87], v[164:167], v[92:95]
    v_mfma_f32_16x16x32_bf16 v[96:99], v[84:87], v[168:171], v[96:99]
    s_waitcnt lgkmcnt(3)
    v_mfma_f32_16x16x32_bf16 v[100:103], v[84:87], v[172:175], v[100:103]
    v_mfma_f32_16x16x32_bf16 v[104:107], v[84:87], v[176:179], v[104:107]
    v_mfma_f32_16x16x32_bf16 v[108:111], v[84:87], v[180:183], v[108:111]
    s_waitcnt lgkmcnt(0)
    v_mfma_f32_16x16x32_bf16 v[112:115], v[84:87], v[184:187], v[112:115]
    v_mfma_f32_16x16x32_bf16 v[116:119], v[84:87], v[188:191], v[116:119]
    v_mfma_f32_16x16x32_bf16 v[120:123], v[84:87], v[192:195], v[120:123]
L_grpJ_17:
    s_nop 7
    s_add_u32 s8, s4, 18046976
    s_addc_u32 s9, s5, 0
    s_and_b32 s9, s9, 0xffff
    s_mov_b32 s10, 4849664
    s_mov_b32 s11, 0x20000
    v_and_b32 v9, 15, v2
    v_lshrrev_b32 v10, 1, v6
    v_and_b32 v11, 1, v6
    v_mul_u32_u24 v12, 304, v11
    v_lshl_add_u32 v12, v10, 3, v12
    v_lshrrev_b32 v13, 1, v9
    v_mul_u32_u24 v13, 151552, v13
    v_and_b32 v14, 1, v9
    v_lshl_add_u32 v13, v14, 4, v13
    v_add_u32 v13, 256, v13
    v_add_u32 v13, v13, v12
    v_lshl_add_u32 v12, v9, 4, v12
    v_cvt_pk_bf16_f32 v124, v88, v89
    v_cvt_pk_bf16_f32 v125, v90, v91
    v_cvt_pk_bf16_f32 v126, v92, v93
    v_cvt_pk_bf16_f32 v127, v94, v95
    v_cvt_pk_bf16_f32 v128, v96, v97
    v_cvt_pk_bf16_f32 v129, v98, v99
    v_cvt_pk_bf16_f32 v130, v100, v101
    v_cvt_pk_bf16_f32 v131, v102, v103
    v_cvt_pk_bf16_f32 v132, v104, v105
    v_cvt_pk_bf16_f32 v133, v106, v107
    v_cvt_pk_bf16_f32 v134, v108, v109
    v_cvt_pk_bf16_f32 v135, v110, v111
    v_cvt_pk_bf16_f32 v136, v112, v113
    v_cvt_pk_bf16_f32 v137, v114, v115
    v_cvt_pk_bf16_f32 v138, v116, v117
    v_cvt_pk_bf16_f32 v139, v118, v119
    v_cvt_pk_bf16_f32 v140, v120, v121
    v_cvt_pk_bf16_f32 v141, v122, v123
    s_lshr_b32 s25, s6, 1
    s_and_b32 s26, s6, 1
    s_sub_u32 s28, s7, 8
    s_lshl_b32 s28, s28, 9
    s_add_u32 s28, s28, s25
    s_mul_i32 s28, s28, 2368
    s_mul_i32 s30, s26, 608
    s_add_u32 s28, s28, s30
    s_add_u32 s28, s28, 1152
    s_mov_b32 s29, s28
    buffer_store_dwordx2 v[124:125], v12, s[8:11], s29 offen
    s_add_u32 s29, s29, 151552
    buffer_store_dwordx2 v[126:127], v12, s[8:11], s29 offen
    s_add_u32 s29, s29, 151552
    buffer_store_dwordx2 v[128:129], v12, s[8:11], s29 offen
    s_add_u32 s29, s29, 151552
    buffer_store_dwordx2 v[130:131], v12, s[8:11], s29 offen
    s_add_u32 s29, s29, 151552
    buffer_store_dwordx2 v[132:133], v12, s[8:11], s29 offen
    s_add_u32 s29, s29, 151552
    buffer_store_dwordx2 v[134:135], v12, s[8:11], s29 offen
    s_add_u32 s29, s29, 151552
    buffer_store_dwordx2 v[136:137], v12, s[8:11], s29 offen
    s_add_u32 s29, s29, 151552
    buffer_store_dwordx2 v[138:139], v12, s[8:11], s29 offen
    buffer_store_dwordx2 v[140:141], v13, s[8:11], s28 offen
    v_lshrrev_b32 v14, 1, v2
    v_mul_u32_u24 v14, 151552, v14
    v_and_b32 v15, 1, v2
    v_mul_u32_u24 v15, 304, v15
    v_add_u32 v14, v14, v15
    v_add_u32 v14, 288, v14
    v_mov_b32 v144, 0x3f803f80
    v_mov_b32 v145, v144
    v_mov_b32 v146, v144
    v_mov_b32 v147, v144
    v_cmp_gt_u32 vcc, 16, v2
    s_and_saveexec_b64 s[32:33], vcc
    buffer_store_dwordx4 v[144:147], v14, s[8:11], s28 offen
    s_branch L_end_8
L_modr_9:
    s_cmp_ge_u32 s2, 228
    s_cbranch_scc1 L_wo_10
    v_lshrrev_b32 v1, 6, v0
    v_and_b32 v2, 63, v0
    v_readfirstlane_b32 s3, v1
    s_sub_u32 s33, s2, 192 - 18
    s_load_dwordx2 s[8:9], s[0:1], 56
    s_load_dwordx2 s[12:13], s[0:1], 48
    v_and_b32 v4, 7, v2
    v_lshrrev_b32 v5, 3, v2
    s_mul_i32 s20, s3, 72
    v_add_u32 v6, s20, v5
    v_lshlrev_b32 v7, 1, v6
    v_mul_u32_u24 v8, 6912, v6
    v_lshl_add_u32 v8, v4, 4, v8
    s_lshl_b32 s21, s33, 7
    s_waitcnt lgkmcnt(0)
    s_and_b32 s9, s9, 0xffff
    s_mov_b32 s10, 3981312
    s_mov_b32 s11, 0x20000
    s_and_b32 s13, s13, 0xffff
    s_mov_b32 s14, 1152
    s_mov_b32 s15, 0x20000
    s_add_u32 s36, s4, 28205056
    s_addc_u32 s37, s5, 0
    s_and_b32 s37, s37, 0xffff
    s_mov_b32 s38, 13824
    s_mov_b32 s39, 0x20000
    buffer_load_ushort v10, v7, s[12:15], 0 offen offset:0
    buffer_load_ushort v11, v7, s[12:15], 0 offen offset:16
    buffer_load_ushort v12, v7, s[12:15], 0 offen offset:32
    buffer_load_ushort v13, v7, s[12:15], 0 offen offset:48
    buffer_load_ushort v14, v7, s[12:15], 0 offen offset:64
    buffer_load_ushort v15, v7, s[12:15], 0 offen offset:80
    buffer_load_ushort v16, v7, s[12:15], 0 offen offset:96
    buffer_load_ushort v17, v7, s[12:15], 0 offen offset:112
    buffer_load_ushort v18, v7, s[12:15], 0 offen offset:128
    buffer_load_dwordx4 v[20:23], v8, s[8:11], s21 offen
    s_add_u32 s21, s21, 55296
    buffer_load_dwordx4 v[24:27], v8, s[8:11], s21 offen
    s_add_u32 s21, s21, 55296
    buffer_load_dwordx4 v[28:31], v8, s[8:11], s21 offen
    s_add_u32 s21, s21, 55296
    buffer_load_dwordx4 v[32:35], v8, s[8:11], s21 offen
    s_add_u32 s21, s21, 55296
    buffer_load_dwordx4 v[36:39], v8, s[8:11], s21 offen
    s_add_u32 s21, s21, 55296
    buffer_load_dwordx4 v[40:43], v8, s[8:11], s21 offen
    s_add_u32 s21, s21, 55296
    buffer_load_dwordx4 v[44:47], v8, s[8:11], s21 offen
    s_add_u32 s21, s21, 55296
    buffer_load_dwordx4 v[48:51], v8, s[8:11], s21 offen
    s_add_u32 s21, s21, 55296
    buffer_load_dwordx4 v[52:55], v8, s[8:11], s21 offen
    s_waitcnt vmcnt(9)
    s_mov_b32 s29, 0xbfb8aa3b
    v_lshlrev_b32 v10, 16, v10
    v_mul_f32 v60, s29, v10
    v_exp_f32 v60, v60
    s_nop 0
    v_add_f32 v60, 1.0, v60
    v_rcp_f32 v60, v60
    s_nop 0
    v_mul_f32 v10, v10, v60
    v_cvt_pk_bf16_f32 v10, v10, v10
    v_and_b32 v10, 0xffff0000, v10
    v_lshlrev_b32 v11, 16, v11
    v_mul_f32 v60, s29, v11
    v_exp_f32 v60, v60
    s_nop 0
    v_add_f32 v60, 1.0, v60
    v_rcp_f32 v60, v60
    s_nop 0
    v_mul_f32 v11, v11, v60
    v_cvt_pk_bf16_f32 v11, v11, v11
    v_and_b32 v11, 0xffff0000, v11
    v_lshlrev_b32 v12, 16, v12
    v_mul_f32 v60, s29, v12
    v_exp_f32 v60, v60
    s_nop 0
    v_add_f32 v60, 1.0, v60
    v_rcp_f32 v60, v60
    s_nop 0
    v_mul_f32 v12, v12, v60
    v_cvt_pk_bf16_f32 v12, v12, v12
    v_and_b32 v12, 0xffff0000, v12
    v_lshlrev_b32 v13, 16, v13
    v_mul_f32 v60, s29, v13
    v_exp_f32 v60, v60
    s_nop 0
    v_add_f32 v60, 1.0, v60
    v_rcp_f32 v60, v60
    s_nop 0
    v_mul_f32 v13, v13, v60
    v_cvt_pk_bf16_f32 v13, v13, v13
    v_and_b32 v13, 0xffff0000, v13
    v_lshlrev_b32 v14, 16, v14
    v_mul_f32 v60, s29, v14
    v_exp_f32 v60, v60
    s_nop 0
    v_add_f32 v60, 1.0, v60
    v_rcp_f32 v60, v60
    s_nop 0
    v_mul_f32 v14, v14, v60
    v_cvt_pk_bf16_f32 v14, v14, v14
    v_and_b32 v14, 0xffff0000, v14
    v_lshlrev_b32 v15, 16, v15
    v_mul_f32 v60, s29, v15
    v_exp_f32 v60, v60
    s_nop 0
    v_add_f32 v60, 1.0, v60
    v_rcp_f32 v60, v60
    s_nop 0
    v_mul_f32 v15, v15, v60
    v_cvt_pk_bf16_f32 v15, v15, v15
    v_and_b32 v15, 0xffff0000, v15
    v_lshlrev_b32 v16, 16, v16
    v_mul_f32 v60, s29, v16
    v_exp_f32 v60, v60
    s_nop 0
    v_add_f32 v60, 1.0, v60
    v_rcp_f32 v60, v60
    s_nop 0
    v_mul_f32 v16, v16, v60
    v_cvt_pk_bf16_f32 v16, v16, v16
    v_and_b32 v16, 0xffff0000, v16
    v_lshlrev_b32 v17, 16, v17
    v_mul_f32 v60, s29, v17
    v_exp_f32 v60, v60
    s_nop 0
    v_add_f32 v60, 1.0, v60
    v_rcp_f32 v60, v60
    s_nop 0
    v_mul_f32 v17, v17, v60
    v_cvt_pk_bf16_f32 v17, v17, v17
    v_and_b32 v17, 0xffff0000, v17
    v_lshlrev_b32 v18, 16, v18
    v_mul_f32 v60, s29, v18
    v_exp_f32 v60, v60
    s_nop 0
    v_add_f32 v60, 1.0, v60
    v_rcp_f32 v60, v60
    s_nop 0
    v_mul_f32 v18, v18, v60
    v_cvt_pk_bf16_f32 v18, v18, v18
    v_and_b32 v18, 0xffff0000, v18
    v_mov_b32 v64, 0
    v_mov_b32 v65, 0
    v_mov_b32 v66, 0
    v_mov_b32 v67, 0
    v_mov_b32 v68, 0
    v_mov_b32 v69, 0
    v_mov_b32 v70, 0
    v_mov_b32 v71, 0
    s_waitcnt vmcnt(8)
    v_lshlrev_b32 v60, 16, v20
    v_and_b32 v61, 0xffff0000, v20
    v_fmac_f32 v64, v10, v60
    v_fmac_f32 v65, v10, v61
    v_lshlrev_b32 v60, 16, v21
    v_and_b32 v61, 0xffff0000, v21
    v_fmac_f32 v66, v10, v60
    v_fmac_f32 v67, v10, v61
    v_lshlrev_b32 v60, 16, v22
    v_and_b32 v61, 0xffff0000, v22
    v_fmac_f32 v68, v10, v60
    v_fmac_f32 v69, v10, v61
    v_lshlrev_b32 v60, 16, v23
    v_and_b32 v61, 0xffff0000, v23
    v_fmac_f32 v70, v10, v60
    v_fmac_f32 v71, v10, v61
    s_waitcnt vmcnt(7)
    v_lshlrev_b32 v60, 16, v24
    v_and_b32 v61, 0xffff0000, v24
    v_fmac_f32 v64, v11, v60
    v_fmac_f32 v65, v11, v61
    v_lshlrev_b32 v60, 16, v25
    v_and_b32 v61, 0xffff0000, v25
    v_fmac_f32 v66, v11, v60
    v_fmac_f32 v67, v11, v61
    v_lshlrev_b32 v60, 16, v26
    v_and_b32 v61, 0xffff0000, v26
    v_fmac_f32 v68, v11, v60
    v_fmac_f32 v69, v11, v61
    v_lshlrev_b32 v60, 16, v27
    v_and_b32 v61, 0xffff0000, v27
    v_fmac_f32 v70, v11, v60
    v_fmac_f32 v71, v11, v61
    s_waitcnt vmcnt(6)
    v_lshlrev_b32 v60, 16, v28
    v_and_b32 v61, 0xffff0000, v28
    v_fmac_f32 v64, v12, v60
    v_fmac_f32 v65, v12, v61
    v_lshlrev_b32 v60, 16, v29
    v_and_b32 v61, 0xffff0000, v29
    v_fmac_f32 v66, v12, v60
    v_fmac_f32 v67, v12, v61
    v_lshlrev_b32 v60, 16, v30
    v_and_b32 v61, 0xffff0000, v30
    v_fmac_f32 v68, v12, v60
    v_fmac_f32 v69, v12, v61
    v_lshlrev_b32 v60, 16, v31
    v_and_b32 v61, 0xffff0000, v31
    v_fmac_f32 v70, v12, v60
    v_fmac_f32 v71, v12, v61
    s_waitcnt vmcnt(5)
    v_lshlrev_b32 v60, 16, v32
    v_and_b32 v61, 0xffff0000, v32
    v_fmac_f32 v64, v13, v60
    v_fmac_f32 v65, v13, v61
    v_lshlrev_b32 v60, 16, v33
    v_and_b32 v61, 0xffff0000, v33
    v_fmac_f32 v66, v13, v60
    v_fmac_f32 v67, v13, v61
    v_lshlrev_b32 v60, 16, v34
    v_and_b32 v61, 0xffff0000, v34
    v_fmac_f32 v68, v13, v60
    v_fmac_f32 v69, v13, v61
    v_lshlrev_b32 v60, 16, v35
    v_and_b32 v61, 0xffff0000, v35
    v_fmac_f32 v70, v13, v60
    v_fmac_f32 v71, v13, v61
    s_waitcnt vmcnt(4)
    v_lshlrev_b32 v60, 16, v36
    v_and_b32 v61, 0xffff0000, v36
    v_fmac_f32 v64, v14, v60
    v_fmac_f32 v65, v14, v61
    v_lshlrev_b32 v60, 16, v37
    v_and_b32 v61, 0xffff0000, v37
    v_fmac_f32 v66, v14, v60
    v_fmac_f32 v67, v14, v61
    v_lshlrev_b32 v60, 16, v38
    v_and_b32 v61, 0xffff0000, v38
    v_fmac_f32 v68, v14, v60
    v_fmac_f32 v69, v14, v61
    v_lshlrev_b32 v60, 16, v39
    v_and_b32 v61, 0xffff0000, v39
    v_fmac_f32 v70, v14, v60
    v_fmac_f32 v71, v14, v61
    s_waitcnt vmcnt(3)
    v_lshlrev_b32 v60, 16, v40
    v_and_b32 v61, 0xffff0000, v40
    v_fmac_f32 v64, v15, v60
    v_fmac_f32 v65, v15, v61
    v_lshlrev_b32 v60, 16, v41
    v_and_b32 v61, 0xffff0000, v41
    v_fmac_f32 v66, v15, v60
    v_fmac_f32 v67, v15, v61
    v_lshlrev_b32 v60, 16, v42
    v_and_b32 v61, 0xffff0000, v42
    v_fmac_f32 v68, v15, v60
    v_fmac_f32 v69, v15, v61
    v_lshlrev_b32 v60, 16, v43
    v_and_b32 v61, 0xffff0000, v43
    v_fmac_f32 v70, v15, v60
    v_fmac_f32 v71, v15, v61
    s_waitcnt vmcnt(2)
    v_lshlrev_b32 v60, 16, v44
    v_and_b32 v61, 0xffff0000, v44
    v_fmac_f32 v64, v16, v60
    v_fmac_f32 v65, v16, v61
    v_lshlrev_b32 v60, 16, v45
    v_and_b32 v61, 0xffff0000, v45
    v_fmac_f32 v66, v16, v60
    v_fmac_f32 v67, v16, v61
    v_lshlrev_b32 v60, 16, v46
    v_and_b32 v61, 0xffff0000, v46
    v_fmac_f32 v68, v16, v60
    v_fmac_f32 v69, v16, v61
    v_lshlrev_b32 v60, 16, v47
    v_and_b32 v61, 0xffff0000, v47
    v_fmac_f32 v70, v16, v60
    v_fmac_f32 v71, v16, v61
    s_waitcnt vmcnt(1)
    v_lshlrev_b32 v60, 16, v48
    v_and_b32 v61, 0xffff0000, v48
    v_fmac_f32 v64, v17, v60
    v_fmac_f32 v65, v17, v61
    v_lshlrev_b32 v60, 16, v49
    v_and_b32 v61, 0xffff0000, v49
    v_fmac_f32 v66, v17, v60
    v_fmac_f32 v67, v17, v61
    v_lshlrev_b32 v60, 16, v50
    v_and_b32 v61, 0xffff0000, v50
    v_fmac_f32 v68, v17, v60
    v_fmac_f32 v69, v17, v61
    v_lshlrev_b32 v60, 16, v51
    v_and_b32 v61, 0xffff0000, v51
    v_fmac_f32 v70, v17, v60
    v_fmac_f32 v71, v17, v61
    s_waitcnt vmcnt(0)
    v_lshlrev_b32 v60, 16, v52
    v_and_b32 v61, 0xffff0000, v52
    v_fmac_f32 v64, v18, v60
    v_fmac_f32 v65, v18, v61
    v_lshlrev_b32 v60, 16, v53
    v_and_b32 v61, 0xffff0000, v53
    v_fmac_f32 v66, v18, v60
    v_fmac_f32 v67, v18, v61
    v_lshlrev_b32 v60, 16, v54
    v_and_b32 v61, 0xffff0000, v54
    v_fmac_f32 v68, v18, v60
    v_fmac_f32 v69, v18, v61
    v_lshlrev_b32 v60, 16, v55
    v_and_b32 v61, 0xffff0000, v55
    v_fmac_f32 v70, v18, v60
    v_fmac_f32 v71, v18, v61
    s_nop 1
    v_add_f32_dpp v64, v64, v64 row_ror:8 row_mask:0xf bank_mask:0xf
    v_mov_b32 v72, v64
    s_nop 1
    v_permlane16_swap_b32 v64, v72
    s_nop 1
    v_add_f32 v64, v64, v72
    v_mov_b32 v72, v64
    s_nop 1
    v_permlane32_swap_b32 v64, v72
    s_nop 1
    v_add_f32 v64, v64, v72
    s_nop 1
    v_add_f32_dpp v65, v65, v65 row_ror:8 row_mask:0xf bank_mask:0xf
    v_mov_b32 v72, v65
    s_nop 1
    v_permlane16_swap_b32 v65, v72
    s_nop 1
    v_add_f32 v65, v65, v72
    v_mov_b32 v72, v65
    s_nop 1
    v_permlane32_swap_b32 v65, v72
    s_nop 1
    v_add_f32 v65, v65, v72
    s_nop 1
    v_add_f32_dpp v66, v66, v66 row_ror:8 row_mask:0xf bank_mask:0xf
    v_mov_b32 v72, v66
    s_nop 1
    v_permlane16_swap_b32 v66, v72
    s_nop 1
    v_add_f32 v66, v66, v72
    v_mov_b32 v72, v66
    s_nop 1
    v_permlane32_swap_b32 v66, v72
    s_nop 1
    v_add_f32 v66, v66, v72
    s_nop 1
    v_add_f32_dpp v67, v67, v67 row_ror:8 row_mask:0xf bank_mask:0xf
    v_mov_b32 v72, v67
    s_nop 1
    v_permlane16_swap_b32 v67, v72
    s_nop 1
    v_add_f32 v67, v67, v72
    v_mov_b32 v72, v67
    s_nop 1
    v_permlane32_swap_b32 v67, v72
    s_nop 1
    v_add_f32 v67, v67, v72
    s_nop 1
    v_add_f32_dpp v68, v68, v68 row_ror:8 row_mask:0xf bank_mask:0xf
    v_mov_b32 v72, v68
    s_nop 1
    v_permlane16_swap_b32 v68, v72
    s_nop 1
    v_add_f32 v68, v68, v72
    v_mov_b32 v72, v68
    s_nop 1
    v_permlane32_swap_b32 v68, v72
    s_nop 1
    v_add_f32 v68, v68, v72
    s_nop 1
    v_add_f32_dpp v69, v69, v69 row_ror:8 row_mask:0xf bank_mask:0xf
    v_mov_b32 v72, v69
    s_nop 1
    v_permlane16_swap_b32 v69, v72
    s_nop 1
    v_add_f32 v69, v69, v72
    v_mov_b32 v72, v69
    s_nop 1
    v_permlane32_swap_b32 v69, v72
    s_nop 1
    v_add_f32 v69, v69, v72
    s_nop 1
    v_add_f32_dpp v70, v70, v70 row_ror:8 row_mask:0xf bank_mask:0xf
    v_mov_b32 v72, v70
    s_nop 1
    v_permlane16_swap_b32 v70, v72
    s_nop 1
    v_add_f32 v70, v70, v72
    v_mov_b32 v72, v70
    s_nop 1
    v_permlane32_swap_b32 v70, v72
    s_nop 1
    v_add_f32 v70, v70, v72
    s_nop 1
    v_add_f32_dpp v71, v71, v71 row_ror:8 row_mask:0xf bank_mask:0xf
    v_mov_b32 v72, v71
    s_nop 1
    v_permlane16_swap_b32 v71, v72
    s_nop 1
    v_add_f32 v71, v71, v72
    v_mov_b32 v72, v71
    s_nop 1
    v_permlane32_swap_b32 v71, v72
    s_nop 1
    v_add_f32 v71, v71, v72
    s_lshl_b32 s20, s3, 8
    v_lshlrev_b32 v9, 5, v4
    v_add_u32 v9, s20, v9
    v_cmp_gt_u32 vcc, 8, v2
    s_and_saveexec_b64 s[26:27], vcc
    ds_write_b128 v9, v[64:67]
    ds_write_b128 v9, v[68:71] offset:16
    s_mov_b64 exec, s[26:27]
    s_waitcnt lgkmcnt(0)
    s_barrier
    s_cmp_lg_u32 s3, 0
    s_cbranch_scc1 L_end_8
    v_lshlrev_b32 v9, 2, v2
    ds_read_b32 v20, v9 offset:0
    ds_read_b32 v21, v9 offset:256
    ds_read_b32 v22, v9 offset:512
    ds_read_b32 v23, v9 offset:768
    ds_read_b32 v24, v9 offset:1024
    ds_read_b32 v25, v9 offset:1280
    ds_read_b32 v26, v9 offset:1536
    ds_read_b32 v27, v9 offset:1792
    s_waitcnt lgkmcnt(0)
    v_add_f32 v20, v20, v21
    v_add_f32 v20, v20, v22
    v_add_f32 v20, v20, v23
    v_add_f32 v20, v20, v24
    v_add_f32 v20, v20, v25
    v_add_f32 v20, v20, v26
    v_add_f32 v20, v20, v27
    s_lshl_b32 s21, s33, 8
    buffer_store_dword v20, v9, s[36:39], s21 offen
    s_branch L_end_8
L_wo_10:
    s_cmp_eq_u32 s2, 255
    s_cbranch_scc1 L_zero_11
    v_lshrrev_b32 v1, 6, v0
    s_nop 0
    v_readfirstlane_b32 s3, v1
    s_sub_u32 s18, s2, 228
    s_lshl_b32 s18, s18, 3
    s_add_u32 s18, s18, s3
    s_mul_i32 s19, s3, 3072
    s_waitcnt lgkmcnt(0)
    v_and_b32 v11, 63, v0
    v_add_u32 v12, 0, v11
    v_mul_u32_u24 v13, 10923, v12
    v_lshrrev_b32 v4, 16, v13
    v_mul_u32_u24 v13, 6, v4
    v_sub_u32 v13, v12, v13
    v_lshlrev_b32 v7, 4, v13
    v_add_u32 v12, 64, v11
    v_mul_u32_u24 v13, 10923, v12
    v_lshrrev_b32 v5, 16, v13
    v_mul_u32_u24 v13, 6, v5
    v_sub_u32 v13, v12, v13
    v_lshlrev_b32 v8, 4, v13
    v_add_u32 v12, 128, v11
    v_mul_u32_u24 v13, 10923, v12
    v_lshrrev_b32 v6, 16, v13
    v_mul_u32_u24 v13, 6, v6
    v_sub_u32 v13, v12, v13
    v_lshlrev_b32 v9, 4, v13
    v_lshrrev_b32 v12, 4, v11
    v_lshlrev_b32 v12, 3, v12
    v_bfe_u32 v13, v11, 2, 2
    v_add_u32 v12, v12, v13
    v_mul_u32_u24 v12, 96, v12
    v_and_b32 v13, 3, v11
    v_lshl_add_u32 v10, v13, 3, v12
    v_lshlrev_b32 v11, 4, v11
    v_add_u32 v10, s19, v10
    s_cmp_ge_u32 s18, 216
    s_cbranch_scc1 L_swt_next_18
    s_sub_u32 s20, s18, 0
    s_load_dwordx2 s[6:7], s[0:1], 16
    s_mul_i32 s22, s20, 3072
    s_mul_hi_u32 s32, s20, 1431655766
    s_mul_i32 s34, s32, 3
    s_sub_u32 s33, s20, s34
    s_mul_hi_u32 s35, s32, 238609295
    s_mul_i32 s34, s35, 18
    s_sub_u32 s36, s32, s34
    s_mul_i32 s21, s35, 288
    s_mul_i32 s34, s33, 96
    s_add_u32 s21, s21, s34
    s_mul_i32 s34, s36, 41472
    s_sub_u32 s32, s36, 16
    s_mul_i32 s32, s32, 331776
    s_add_u32 s32, s32, 18432
    s_cmp_ge_u32 s36, 16
    s_cselect_b32 s34, s32, s34
    s_cselect_b32 s37, 1, 0
    s_add_u32 s21, s21, s34
    s_cmp_eq_u32 s37, 1
    s_cbranch_scc1 L_wob_19
    v_lshrrev_b32 v12, 3, v4
    v_and_b32 v13, 7, v4
    v_lshrrev_b32 v14, 1, v12
    v_mul_u32_u24 v14, 18, v14
    v_and_b32 v12, 1, v12
    v_lshl_add_u32 v14, v12, 2, v14
    v_lshrrev_b32 v12, 2, v13
    v_lshl_add_u32 v14, v12, 3, v14
    v_and_b32 v13, 3, v13
    v_add_u32 v14, v14, v13
    v_mul_u32_u24 v16, 1152, v14
    v_add_u32 v16, v16, v7
    v_lshrrev_b32 v12, 3, v5
    v_and_b32 v13, 7, v5
    v_lshrrev_b32 v14, 1, v12
    v_mul_u32_u24 v14, 18, v14
    v_and_b32 v12, 1, v12
    v_lshl_add_u32 v14, v12, 2, v14
    v_lshrrev_b32 v12, 2, v13
    v_lshl_add_u32 v14, v12, 3, v14
    v_and_b32 v13, 3, v13
    v_add_u32 v14, v14, v13
    v_mul_u32_u24 v17, 1152, v14
    v_add_u32 v17, v17, v8
    v_lshrrev_b32 v12, 3, v6
    v_and_b32 v13, 7, v6
    v_lshrrev_b32 v14, 1, v12
    v_mul_u32_u24 v14, 18, v14
    v_and_b32 v12, 1, v12
    v_lshl_add_u32 v14, v12, 2, v14
    v_lshrrev_b32 v12, 2, v13
    v_lshl_add_u32 v14, v12, 3, v14
    v_and_b32 v13, 3, v13
    v_add_u32 v14, v14, v13
    v_mul_u32_u24 v18, 1152, v14
    v_add_u32 v18, v18, v9
    s_branch L_woj_20
L_wob_19:
    v_lshrrev_b32 v12, 3, v4
    v_and_b32 v13, 7, v4
    v_mul_u32_u24 v14, 72, v12
    v_lshrrev_b32 v12, 1, v13
    v_mul_u32_u24 v12, 18, v12
    v_add_u32 v14, v14, v12
    v_and_b32 v13, 1, v13
    v_add_u32 v14, v14, v13
    v_mul_u32_u24 v16, 1152, v14
    v_add_u32 v16, v16, v7
    v_lshrrev_b32 v12, 3, v5
    v_and_b32 v13, 7, v5
    v_mul_u32_u24 v14, 72, v12
    v_lshrrev_b32 v12, 1, v13
    v_mul_u32_u24 v12, 18, v12
    v_add_u32 v14, v14, v12
    v_and_b32 v13, 1, v13
    v_add_u32 v14, v14, v13
    v_mul_u32_u24 v17, 1152, v14
    v_add_u32 v17, v17, v8
    v_lshrrev_b32 v12, 3, v6
    v_and_b32 v13, 7, v6
    v_mul_u32_u24 v14, 72, v12
    v_lshrrev_b32 v12, 1, v13
    v_mul_u32_u24 v12, 18, v12
    v_add_u32 v14, v14, v12
    v_and_b32 v13, 1, v13
    v_add_u32 v14, v14, v13
    v_mul_u32_u24 v18, 1152, v14
    v_add_u32 v18, v18, v9
L_woj_20:
    s_waitcnt lgkmcnt(0)
    s_mov_b32 s8, s6
    s_and_b32 s9, s7, 0xffff
    s_mov_b32 s10, 663552
    s_mov_b32 s11, 0x20000
    s_add_u32 s12, s4, 4407296
    s_addc_u32 s13, s5, 0
    s_and_b32 s13, s13, 0xffff
    s_mov_b32 s14, 663552
    s_mov_b32 s15, 0x20000
    s_add_u32 m0, s19, 0
    s_nop 0
    buffer_load_dwordx4 v16, s[8:11], s21 offen lds
    s_add_u32 m0, s19, 1024
    s_nop 0
    buffer_load_dwordx4 v17, s[8:11], s21 offen lds
    s_add_u32 m0, s19, 2048
    s_nop 0
    buffer_load_dwordx4 v18, s[8:11], s21 offen lds
    s_waitcnt vmcnt(0)
    ds_read_b64_tr_b16 v[24:25], v10 offset:0
    ds_read_b64_tr_b16 v[26:27], v10 offset:384
    ds_read_b64_tr_b16 v[28:29], v10 offset:32
    ds_read_b64_tr_b16 v[30:31], v10 offset:416
    ds_read_b64_tr_b16 v[32:33], v10 offset:64
    ds_read_b64_tr_b16 v[34:35], v10 offset:448
    s_waitcnt lgkmcnt(4)
    buffer_store_dwordx4 v[24:27], v11, s[12:15], s22 offen offset:0
    s_waitcnt lgkmcnt(2)
    buffer_store_dwordx4 v[28:31], v11, s[12:15], s22 offen offset:1024
    s_waitcnt lgkmcnt(0)
    buffer_store_dwordx4 v[32:35], v11, s[12:15], s22 offen offset:2048
    s_branch L_end_8
L_swt_next_18:
    s_branch L_end_8
L_zero_11:
    s_waitcnt lgkmcnt(0)
    s_add_u32 s28, s4, 47095808
    s_addc_u32 s29, s5, 0
    s_and_b32 s29, s29, 0xffff
    s_mov_b32 s30, 32768
    s_mov_b32 s31, 0x20000
    v_lshlrev_b32 v5, 6, v0
    v_mov_b32 v20, 0
    v_mov_b32 v21, 0
    v_mov_b32 v22, 0
    v_mov_b32 v23, 0
    buffer_store_dwordx4 v[20:23], v5, s[28:31], 0 offen offset:0
    buffer_store_dwordx4 v[20:23], v5, s[28:31], 0 offen offset:16
    buffer_store_dwordx4 v[20:23], v5, s[28:31], 0 offen offset:32
    buffer_store_dwordx4 v[20:23], v5, s[28:31], 0 offen offset:48
L_end_8:
    s_endpgm
.section .rodata,"a"
.p2align 6
.amdhsa_kernel k2_kernel
.amdhsa_next_free_vgpr 240
.amdhsa_next_free_sgpr 102
.amdhsa_accum_offset 240
.amdhsa_group_segment_fixed_size 0
.amdhsa_kernarg_size 88
.amdhsa_user_sgpr_count 2
.amdhsa_user_sgpr_kernarg_segment_ptr 1
.amdhsa_system_sgpr_workgroup_id_x 1
.end_amdhsa_kernel
.text
.globl k3_kernel
.p2align 8
.type k3_kernel,@function
k3_kernel:
    s_cmp_ge_u32 s2, 256
    s_cbranch_scc1 L_end_21
    s_load_dwordx2 s[4:5], s[0:1], 80
    s_load_dwordx2 s[44:45], s[0:1], 32
    s_load_dwordx2 s[48:49], s[0:1], 40
    s_load_dwordx2 s[52:53], s[0:1], 16
    v_lshrrev_b32 v1, 6, v0
    v_and_b32 v2, 63, v0
    v_readfirstlane_b32 s3, v1
    v_mov_b32 v1, v2
    v_lshlrev_b32 v5, 4, v1
    s_and_b32 s6, s2, 7
    s_lshl_b32 s6, s6, 2
    s_bfe_u32 s7, s2, 0x20003
    s_add_u32 s6, s6, s7
    s_lshr_b32 s7, s2, 5
    s_and_b32 s20, s3, 3
    s_lshr_b32 s21, s3, 2
    s_waitcnt lgkmcnt(0)
    s_add_u32 s8, s4, 18046976
    s_addc_u32 s9, s5, 0
    s_and_b32 s9, s9, 0xffff
    s_mov_b32 s10, 4849664
    s_mov_b32 s11, 0x20000
    s_add_u32 s12, s4, 15687680
    s_addc_u32 s13, s5, 0
    s_and_b32 s13, s13, 0xffff
    s_mov_b32 s14, 2097152
    s_mov_b32 s15, 0x20000
    s_add_u32 s16, s4, 17784832
    s_addc_u32 s17, s5, 0
    s_and_b32 s17, s17, 0xffff
    s_mov_b32 s18, 262144
    s_mov_b32 s19, 0x20000
    s_lshl_b32 s22, s7, 3
    s_lshl_b32 s23, s20, 1
    s_add_u32 s22, s22, s23
    s_lshl_b32 s23, s6, 6
    s_add_u32 s23, s23, s22
    s_lshl_b32 s23, s23, 10
    buffer_load_dwordx4 v[8:11], v5, s[12:15], s23 offen
    buffer_load_dwordx4 v[12:15], v5, s[12:15], s23 offen offset:1024
    v_and_b32 v6, 31, v1
    v_lshlrev_b32 v7, 2, v6
    s_lshl_b32 s23, s6, 11
    s_lshl_b32 s24, s22, 5
    s_add_u32 s23, s23, s24
    s_lshl_b32 s23, s23, 2
    buffer_load_dword v16, v7, s[16:19], s23 offen
    buffer_load_dword v18, v7, s[16:19], s23 offen offset:128
    s_mul_i32 s24, s21, 74
    s_add_u32 s24, s24, s20
    s_lshl_b32 s24, s24, 10
    s_mul_i32 s25, s6, 151552
    s_add_u32 s25, s25, s24
    s_add_u32 m0, s24, 0
    s_add_u32 s26, s25, 0
    buffer_load_dwordx4 v5, s[8:11], s26 offen lds
    s_add_u32 m0, s24, 4096
    s_add_u32 s26, s25, 4096
    buffer_load_dwordx4 v5, s[8:11], s26 offen lds
    s_add_u32 m0, s24, 8192
    s_add_u32 s26, s25, 8192
    buffer_load_dwordx4 v5, s[8:11], s26 offen lds
    s_add_u32 m0, s24, 12288
    s_add_u32 s26, s25, 12288
    buffer_load_dwordx4 v5, s[8:11], s26 offen lds
    s_add_u32 s24, s24, 16384
    s_add_u32 s25, s25, 16384
    s_mul_i32 s27, s21, 75776
    v_add_u32 v2, s27, v5
    v_add_u32 v3, s27, v7
    v_add_u32 v3, 1024, v3
    v_lshrrev_b32 v4, 5, v1
    v_min_u32 v6, 18, v6
    v_mul_u32_u24 v192, 304, v4
    v_lshl_add_u32 v6, v6, 4, v192
    v_add_u32 v6, s27, v6
    v_add_u32 v4, 1152, v6
    s_add_u32 s56, s4, 4407296
    s_addc_u32 s57, s5, 0
    s_and_b32 s57, s57, 0xffff
    s_mov_b32 s58, 11280384
    s_mov_b32 s59, 0x20000
    s_lshl_b32 s60, s2, 3
    s_add_u32 s60, s60, s3
    v_lshrrev_b32 v192, 1, v1
    v_and_b32 v193, 1, v1
    v_lshlrev_b32 v193, 4, v193
    v_lshrrev_b32 v194, 3, v192
    v_and_b32 v195, 7, v192
    v_lshrrev_b32 v196, 2, v195
    v_and_b32 v197, 3, v195
    s_mov_b32 s47, 0x20000
    s_cmp_ge_u32 s60, 864
    s_cbranch_scc1 L_w2_22
    s_and_b32 s45, s45, 0xffff
    s_mov_b32 s46, 5308416
    s_lshl_b32 s40, s60, 1
    s_add_u32 s40, s40, 0
    s_mul_hi_u32 s41, s40, 238609295
    s_mul_i32 s43, s41, 18
    s_sub_u32 s42, s40, s43
    s_mul_i32 s41, s41, 96
    s_mul_i32 s42, s42, 294912
    s_add_u32 s41, s41, s42
    s_add_u32 s62, s41, 0
    s_add_u32 s63, s41, 32
    s_add_u32 s64, s41, 64
    s_lshl_b32 s40, s60, 1
    s_add_u32 s40, s40, 1
    s_mul_hi_u32 s41, s40, 238609295
    s_mul_i32 s43, s41, 18
    s_sub_u32 s42, s40, s43
    s_mul_i32 s41, s41, 96
    s_mul_i32 s42, s42, 294912
    s_add_u32 s41, s41, s42
    s_add_u32 s65, s41, 0
    s_add_u32 s66, s41, 32
    s_add_u32 s67, s41, 64
    s_mul_i32 s69, s60, 6144
    s_add_u32 s69, s69, 663552
    v_mul_u32_u24 v200, 9216, v192
    s_branch L_dn_25
L_w2_22:
    s_cmp_ge_u32 s60, 1728
    s_cbranch_scc1 L_no_24
    s_mov_b32 s44, s48
    s_and_b32 s45, s49, 0xffff
    s_mov_b32 s46, 5308416
    s_sub_u32 s60, s60, 864
    s_lshl_b32 s40, s60, 1
    s_add_u32 s40, s40, 0
    s_mul_hi_u32 s41, s40, 238609295
    s_mul_i32 s43, s41, 18
    s_sub_u32 s42, s40, s43
    s_mul_i32 s42, s42, 36864
    s_mul_hi_u32 s40, s41, 357913942
    s_mul_i32 s43, s40, 12
    s_sub_u32 s61, s41, s43
    s_mul_i32 s40, s40, 663552
    s_mul_i32 s61, s61, 96
    s_add_u32 s41, s40, s61
    s_add_u32 s41, s41, s42
    s_add_u32 s62, s41, 0
    s_add_u32 s63, s41, 32
    s_add_u32 s64, s41, 64
    s_lshl_b32 s40, s60, 1
    s_add_u32 s40, s40, 1
    s_mul_hi_u32 s41, s40, 238609295
    s_mul_i32 s43, s41, 18
    s_sub_u32 s42, s40, s43
    s_mul_i32 s42, s42, 36864
    s_mul_hi_u32 s40, s41, 357913942
    s_mul_i32 s43, s40, 12
    s_sub_u32 s61, s41, s43
    s_mul_i32 s40, s40, 663552
    s_mul_i32 s61, s61, 96
    s_add_u32 s41, s40, s61
    s_add_u32 s41, s41, s42
    s_add_u32 s65, s41, 0
    s_add_u32 s66, s41, 32
    s_add_u32 s67, s41, 64
    s_mul_i32 s69, s60, 6144
    s_add_u32 s69, s69, 5971968
    v_lshlrev_b32 v198, 4, v196
    v_lshl_add_u32 v198, v194, 2, v198
    v_add_u32 v198, v198, v197
    v_mul_u32_u24 v200, 1152, v198
    s_branch L_dn_25
L_wo_23:
    s_cmp_ge_u32 s60, 1836
    s_cbranch_scc1 L_no_24
    s_mov_b32 s44, s52
    s_and_b32 s45, s53, 0xffff
    s_mov_b32 s46, 663552
    s_sub_u32 s60, s60, 1728
    s_mul_i32 s69, s60, 6144
    s_mul_hi_u32 s40, s60, 159072863
    s_mul_i32 s43, s40, 27
    s_sub_u32 s41, s60, s43
    s_mul_i32 s42, s41, 6
    s_add_u32 s42, s42, 0
    s_mul_hi_u32 s61, s42, 477218589
    s_mul_i32 s60, s61, 9
    s_sub_u32 s43, s42, s60
    s_lshl_b32 s43, s43, 5
    s_mul_i32 s42, s40, 288
    s_add_u32 s43, s43, s42
    s_mul_i32 s42, s61, 41472
    s_sub_u32 s60, s61, 16
    s_mul_i32 s60, s60, 331776
    s_add_u32 s60, s60, 18432
    s_cmp_ge_u32 s61, 16
    s_cselect_b32 s42, s60, s42
    s_add_u32 s62, s43, s42
    s_mul_i32 s42, s41, 6
    s_add_u32 s42, s42, 1
    s_mul_hi_u32 s61, s42, 477218589
    s_mul_i32 s60, s61, 9
    s_sub_u32 s43, s42, s60
    s_lshl_b32 s43, s43, 5
    s_mul_i32 s42, s40, 288
    s_add_u32 s43, s43, s42
    s_mul_i32 s42, s61, 41472
    s_sub_u32 s60, s61, 16
    s_mul_i32 s60, s60, 331776
    s_add_u32 s60, s60, 18432
    s_cmp_ge_u32 s61, 16
    s_cselect_b32 s42, s60, s42
    s_add_u32 s63, s43, s42
    s_mul_i32 s42, s41, 6
    s_add_u32 s42, s42, 2
    s_mul_hi_u32 s61, s42, 477218589
    s_mul_i32 s60, s61, 9
    s_sub_u32 s43, s42, s60
    s_lshl_b32 s43, s43, 5
    s_mul_i32 s42, s40, 288
    s_add_u32 s43, s43, s42
    s_mul_i32 s42, s61, 41472
    s_sub_u32 s60, s61, 16
    s_mul_i32 s60, s60, 331776
    s_add_u32 s60, s60, 18432
    s_cmp_ge_u32 s61, 16
    s_cselect_b32 s42, s60, s42
    s_add_u32 s64, s43, s42
    s_mul_i32 s42, s41, 6
    s_add_u32 s42, s42, 3
    s_mul_hi_u32 s61, s42, 477218589
    s_mul_i32 s60, s61, 9
    s_sub_u32 s43, s42, s60
    s_lshl_b32 s43, s43, 5
    s_mul_i32 s42, s40, 288
    s_add_u32 s43, s43, s42
    s_mul_i32 s42, s61, 41472
    s_sub_u32 s60, s61, 16
    s_mul_i32 s60, s60, 331776
    s_add_u32 s60, s60, 18432
    s_cmp_ge_u32 s61, 16
    s_cselect_b32 s42, s60, s42
    s_add_u32 s65, s43, s42
    s_mul_i32 s42, s41, 6
    s_add_u32 s42, s42, 4
    s_mul_hi_u32 s61, s42, 477218589
    s_mul_i32 s60, s61, 9
    s_sub_u32 s43, s42, s60
    s_lshl_b32 s43, s43, 5
    s_mul_i32 s42, s40, 288
    s_add_u32 s43, s43, s42
    s_mul_i32 s42, s61, 41472
    s_sub_u32 s60, s61, 16
    s_mul_i32 s60, s60, 331776
    s_add_u32 s60, s60, 18432
    s_cmp_ge_u32 s61, 16
    s_cselect_b32 s42, s60, s42
    s_add_u32 s66, s43, s42
    s_mul_i32 s42, s41, 6
    s_add_u32 s42, s42, 5
    s_mul_hi_u32 s61, s42, 477218589
    s_mul_i32 s60, s61, 9
    s_sub_u32 s43, s42, s60
    s_lshl_b32 s43, s43, 5
    s_mul_i32 s42, s40, 288
    s_add_u32 s43, s43, s42
    s_mul_i32 s42, s61, 41472
    s_sub_u32 s60, s61, 16
    s_mul_i32 s60, s60, 331776
    s_add_u32 s60, s60, 18432
    s_cmp_ge_u32 s61, 16
    s_cselect_b32 s42, s60, s42
    s_add_u32 s67, s43, s42
    s_cmp_ge_u32 s41, 24
    s_cbranch_scc1 L_wob_26
    v_lshrrev_b32 v198, 1, v194
    v_mul_u32_u24 v198, 18, v198
    v_and_b32 v199, 1, v194
    v_lshl_add_u32 v198, v199, 2, v198
    v_lshl_add_u32 v198, v196, 3, v198
    v_add_u32 v198, v198, v197
    v_mul_u32_u24 v200, 1152, v198
    s_branch L_dn_25
L_wob_26:
    v_mul_u32_u24 v198, 72, v194
    v_lshrrev_b32 v199, 1, v195
    v_mul_u32_u24 v199, 18, v199
    v_add_u32 v198, v198, v199
    v_and_b32 v199, 1, v195
    v_add_u32 v198, v198, v199
    v_mul_u32_u24 v200, 1152, v198
    s_branch L_dn_25
L_no_24:
    s_mov_b32 s46, 0
    s_mov_b32 s58, 0
    s_mov_b32 s62, 0
    s_mov_b32 s63, 0
    s_mov_b32 s64, 0
    s_mov_b32 s65, 0
    s_mov_b32 s66, 0
    s_mov_b32 s67, 0
    s_mov_b32 s69, 0
    v_mov_b32 v200, 0
L_dn_25:
    v_add_u32 v200, v200, v193
    s_mov_b32 s68, 0x7ff00000
    v_lshrrev_b32 v198, 4, v1
    v_lshlrev_b32 v198, 3, v198
    v_bfe_u32 v199, v1, 2, 2
    v_add_u32 v198, v198, v199
    v_lshlrev_b32 v198, 5, v198
    v_and_b32 v199, 3, v1
    v_lshl_add_u32 v198, v199, 3, v198
    s_lshl_b32 s61, s3, 10
    s_add_u32 s61, s61, 155648
    v_add_u32 v204, s61, v198
    v_mov_b32 v17, 0
    v_mov_b32 v19, 0
    v_mov_b32 v29, 0
    v_mov_b32 v31, 0
    v_mov_b32 v128, 0
    v_mov_b32 v144, 0
    v_mov_b32 v32, 0
    v_mov_b32 v129, 0
    v_mov_b32 v145, 0
    v_mov_b32 v33, 0
    v_mov_b32 v130, 0
    v_mov_b32 v146, 0
    v_mov_b32 v34, 0
    v_mov_b32 v131, 0
    v_mov_b32 v147, 0
    v_mov_b32 v35, 0
    v_mov_b32 v132, 0
    v_mov_b32 v148, 0
    v_mov_b32 v36, 0
    v_mov_b32 v133, 0
    v_mov_b32 v149, 0
    v_mov_b32 v37, 0
    v_mov_b32 v134, 0
    v_mov_b32 v150, 0
    v_mov_b32 v38, 0
    v_mov_b32 v135, 0
    v_mov_b32 v151, 0
    v_mov_b32 v39, 0
    v_mov_b32 v136, 0
    v_mov_b32 v152, 0
    v_mov_b32 v40, 0
    v_mov_b32 v137, 0
    v_mov_b32 v153, 0
    v_mov_b32 v41, 0
    v_mov_b32 v138, 0
    v_mov_b32 v154, 0
    v_mov_b32 v42, 0
    v_mov_b32 v139, 0
    v_mov_b32 v155, 0
    v_mov_b32 v43, 0
    v_mov_b32 v140, 0
    v_mov_b32 v156, 0
    v_mov_b32 v44, 0
    v_mov_b32 v141, 0
    v_mov_b32 v157, 0
    v_mov_b32 v45, 0
    v_mov_b32 v142, 0
    v_mov_b32 v158, 0
    v_mov_b32 v46, 0
    v_mov_b32 v143, 0
    v_mov_b32 v159, 0
    v_mov_b32 v47, 0
    v_mov_b32 v28, 0
    v_mov_b32 v30, 0
    s_mov_b32 s38, -1
    s_mov_b32 s39, 0
    s_mov_b32 s42, 0x7ffff
    s_mov_b32 s43, 0x7ffff
    s_waitcnt vmcnt(4)
    v_cmp_gt_u32 vcc, 32, v1
    s_nop 1
    v_cndmask_b32 v16, 0, v16, vcc
    v_cndmask_b32 v18, 0, v18, vcc
    s_waitcnt vmcnt(0)
    s_barrier
    ds_read_b128 v[20:23], v2
    ds_read_b32 v28, v3
    s_waitcnt lgkmcnt(0)
    v_mfma_f32_32x32x16_bf16 v[64:79], v[20:23], v[8:11], 0
    v_mfma_f32_32x32x8_bf16 v[64:79], v[28:29], v[16:17], v[64:79]
    v_mfma_f32_32x32x16_bf16 v[96:111], v[20:23], v[12:15], 0
    v_mfma_f32_32x32x8_bf16 v[96:111], v[28:29], v[18:19], v[96:111]
    s_nop 7
    s_nop 7
    v_max_f32 v192, v64, v65
    v_max3_f32 v192, v66, v67, v192
    v_max3_f32 v192, v68, v69, v192
    v_max3_f32 v192, v70, v71, v192
    v_max3_f32 v192, v72, v73, v192
    v_max3_f32 v192, v74, v75, v192
    v_max3_f32 v192, v76, v77, v192
    v_max3_f32 v192, v78, v79, v192
    v_max_f32 v193, v96, v97
    v_max3_f32 v193, v98, v99, v193
    v_max3_f32 v193, v100, v101, v193
    v_max3_f32 v193, v102, v103, v193
    v_max3_f32 v193, v104, v105, v193
    v_max3_f32 v193, v106, v107, v193
    v_max3_f32 v193, v108, v109, v193
    v_max3_f32 v193, v110, v111, v193
    v_mov_b32 v194, v192
    s_nop 1
    v_permlane32_swap_b32 v192, v194
    s_nop 1
    v_max_f32 v192, v192, v194
    v_sub_f32 v160, 0, v192
    v_sub_f32 v161, 0, v192
    v_sub_f32 v162, 0, v192
    v_sub_f32 v163, 0, v192
    v_sub_f32 v164, 0, v192
    v_sub_f32 v165, 0, v192
    v_sub_f32 v166, 0, v192
    v_sub_f32 v167, 0, v192
    v_sub_f32 v168, 0, v192
    v_sub_f32 v169, 0, v192
    v_sub_f32 v170, 0, v192
    v_sub_f32 v171, 0, v192
    v_sub_f32 v172, 0, v192
    v_sub_f32 v173, 0, v192
    v_sub_f32 v174, 0, v192
    v_sub_f32 v175, 0, v192
    v_mov_b32 v194, v193
    s_nop 1
    v_permlane32_swap_b32 v193, v194
    s_nop 1
    v_max_f32 v193, v193, v194
    v_sub_f32 v176, 0, v193
    v_sub_f32 v177, 0, v193
    v_sub_f32 v178, 0, v193
    v_sub_f32 v179, 0, v193
    v_sub_f32 v180, 0, v193
    v_sub_f32 v181, 0, v193
    v_sub_f32 v182, 0, v193
    v_sub_f32 v183, 0, v193
    v_sub_f32 v184, 0, v193
    v_sub_f32 v185, 0, v193
    v_sub_f32 v186, 0, v193
    v_sub_f32 v187, 0, v193
    v_sub_f32 v188, 0, v193
    v_sub_f32 v189, 0, v193
    v_sub_f32 v190, 0, v193
    v_sub_f32 v191, 0, v193
    s_mov_b32 s30, 0
L_main_27:
    ds_read_b128 v[20:23], v2
    ds_read_b32 v28, v3
    ds_read_b128 v[24:27], v2 offset:2368
    ds_read_b32 v30, v3 offset:2368
    ds_read_b128 v[32:35], v4
    ds_read_b128 v[36:39], v4 offset:608
    v_mov_b32 v60, 0
    v_mov_b32 v44, 0
    v_mov_b32 v61, 0
    v_mov_b32 v45, 0
    v_mov_b32 v62, 0
    v_mov_b32 v46, 0
    v_mov_b32 v63, 0
    v_mov_b32 v47, 0
    s_waitcnt lgkmcnt(4)
    v_mfma_f32_32x32x16_bf16 v[64:79], v[20:23], v[8:11], v[160:175]
    v_mfma_f32_32x32x8_bf16 v[64:79], v[28:29], v[16:17], v[64:79]
    v_mfma_f32_32x32x16_bf16 v[96:111], v[20:23], v[12:15], v[176:191]
    v_mfma_f32_32x32x8_bf16 v[96:111], v[28:29], v[18:19], v[96:111]
    s_nop 7
    s_nop 3
    v_mov_b32 v196, v2
    v_mov_b32 v197, v3
    v_mov_b32 v198, v4
    s_cmp_lg_u32 s30, 0
    s_cselect_b32 s31, 8, 5
    s_cbranch_scc1 L_loop_28
    s_waitcnt lgkmcnt(0)
    v_exp_f32 v64, v64
    v_exp_f32 v65, v65
    v_mfma_f32_32x32x16_bf16 v[144:159], v[44:47], v[60:63], v[144:159]
    ds_read_b128 v[20:23], v196 offset:4736
    ds_read_b32 v28, v197 offset:4736
    ds_read_b128 v[40:43], v198 offset:2368
    ds_read_b128 v[44:47], v198 offset:2976
    v_exp_f32 v66, v66
    v_exp_f32 v67, v67
    v_exp_f32 v68, v68
    v_exp_f32 v69, v69
    v_exp_f32 v70, v70
    v_mfma_f32_32x32x16_bf16 v[80:95], v[24:27], v[8:11], v[160:175]
    v_exp_f32 v71, v71
    v_exp_f32 v72, v72
    s_mov_b32 m0, s24
    s_add_u32 s24, s24, 4096
    buffer_load_dwordx4 v5, s[8:11], s25 offen lds
    s_add_u32 s25, s25, 4096
    v_cvt_pk_bf16_f32 v48, v64, v65
    v_cvt_pk_bf16_f32 v49, v66, v67
    v_cvt_pk_bf16_f32 v50, v68, v69
    v_cvt_pk_bf16_f32 v51, v70, v71
    v_mfma_f32_32x32x8_bf16 v[80:95], v[30:31], v[16:17], v[80:95]
    v_exp_f32 v73, v73
    v_exp_f32 v74, v74
    v_exp_f32 v75, v75
    v_exp_f32 v76, v76
    v_mfma_f32_32x32x16_bf16 v[128:143], v[32:35], v[48:51], v[128:143]
    v_exp_f32 v77, v77
    v_exp_f32 v78, v78
    v_exp_f32 v79, v79
    v_exp_f32 v96, v96
    v_mfma_f32_32x32x16_bf16 v[112:127], v[24:27], v[12:15], v[176:191]
    v_cvt_pk_bf16_f32 v52, v72, v73
    v_cvt_pk_bf16_f32 v53, v74, v75
    v_cvt_pk_bf16_f32 v54, v76, v77
    v_cvt_pk_bf16_f32 v55, v78, v79
    s_mov_b32 m0, s24
    s_add_u32 s24, s24, 4096
    buffer_load_dwordx4 v5, s[8:11], s25 offen lds
    s_add_u32 s25, s25, 4096
    v_exp_f32 v97, v97
    v_exp_f32 v98, v98
    v_exp_f32 v99, v99
    v_mfma_f32_32x32x16_bf16 v[128:143], v[36:39], v[52:55], v[128:143]
    v_exp_f32 v100, v100
    v_exp_f32 v101, v101
    v_exp_f32 v102, v102
    v_exp_f32 v103, v103
    v_exp_f32 v104, v104
    v_mfma_f32_32x32x8_bf16 v[112:127], v[30:31], v[18:19], v[112:127]
    v_cvt_pk_bf16_f32 v56, v96, v97
    v_cvt_pk_bf16_f32 v57, v98, v99
    v_cvt_pk_bf16_f32 v58, v100, v101
    v_cvt_pk_bf16_f32 v59, v102, v103
    v_exp_f32 v105, v105
    v_exp_f32 v106, v106
    v_exp_f32 v107, v107
    v_mfma_f32_32x32x16_bf16 v[144:159], v[32:35], v[56:59], v[144:159]
    v_exp_f32 v108, v108
    v_exp_f32 v109, v109
    v_exp_f32 v110, v110
    v_exp_f32 v111, v111
    s_nop 0
    v_cvt_pk_bf16_f32 v60, v104, v105
    v_cvt_pk_bf16_f32 v61, v106, v107
    v_cvt_pk_bf16_f32 v62, v108, v109
    v_cvt_pk_bf16_f32 v63, v110, v111
    s_waitcnt lgkmcnt(0)
    v_exp_f32 v80, v80
    v_exp_f32 v81, v81
    v_mfma_f32_32x32x16_bf16 v[144:159], v[36:39], v[60:63], v[144:159]
    ds_read_b128 v[24:27], v196 offset:7104
    ds_read_b32 v30, v197 offset:7104
    ds_read_b128 v[32:35], v198 offset:4736
    ds_read_b128 v[36:39], v198 offset:5344
    v_exp_f32 v82, v82
    v_exp_f32 v83, v83
    v_exp_f32 v84, v84
    v_exp_f32 v85, v85
    v_exp_f32 v86, v86
    v_mfma_f32_32x32x16_bf16 v[64:79], v[20:23], v[8:11], v[160:175]
    v_exp_f32 v87, v87
    v_exp_f32 v88, v88
    s_mov_b32 m0, s24
    s_add_u32 s24, s24, 4096
    buffer_load_dwordx4 v5, s[8:11], s25 offen lds
    s_add_u32 s25, s25, 4096
    v_cvt_pk_bf16_f32 v48, v80, v81
    v_cvt_pk_bf16_f32 v49, v82, v83
    v_cvt_pk_bf16_f32 v50, v84, v85
    v_cvt_pk_bf16_f32 v51, v86, v87
    v_mfma_f32_32x32x8_bf16 v[64:79], v[28:29], v[16:17], v[64:79]
    v_exp_f32 v89, v89
    v_exp_f32 v90, v90
    v_exp_f32 v91, v91
    v_exp_f32 v92, v92
    v_mfma_f32_32x32x16_bf16 v[128:143], v[40:43], v[48:51], v[128:143]
    v_exp_f32 v93, v93
    v_exp_f32 v94, v94
    v_exp_f32 v95, v95
    v_exp_f32 v112, v112
    v_mfma_f32_32x32x16_bf16 v[96:111], v[20:23], v[12:15], v[176:191]
    v_cvt_pk_bf16_f32 v52, v88, v89
    v_cvt_pk_bf16_f32 v53, v90, v91
    v_cvt_pk_bf16_f32 v54, v92, v93
    v_cvt_pk_bf16_f32 v55, v94, v95
    s_mov_b32 m0, s24
    s_add_u32 s24, s24, 4096
    buffer_load_dwordx4 v5, s[8:11], s25 offen lds
    s_add_u32 s25, s25, 4096
    v_exp_f32 v113, v113
    v_exp_f32 v114, v114
    v_exp_f32 v115, v115
    v_mfma_f32_32x32x16_bf16 v[128:143], v[44:47], v[52:55], v[128:143]
    v_exp_f32 v116, v116
    v_exp_f32 v117, v117
    v_exp_f32 v118, v118
    v_exp_f32 v119, v119
    v_exp_f32 v120, v120
    v_mfma_f32_32x32x8_bf16 v[96:111], v[28:29], v[18:19], v[96:111]
    v_cvt_pk_bf16_f32 v56, v112, v113
    v_cvt_pk_bf16_f32 v57, v114, v115
    v_cvt_pk_bf16_f32 v58, v116, v117
    v_cvt_pk_bf16_f32 v59, v118, v119
    v_exp_f32 v121, v121
    v_exp_f32 v122, v122
    v_exp_f32 v123, v123
    v_mfma_f32_32x32x16_bf16 v[144:159], v[40:43], v[56:59], v[144:159]
    v_exp_f32 v124, v124
    v_exp_f32 v125, v125
    v_exp_f32 v126, v126
    v_exp_f32 v127, v127
    s_nop 0
    v_cvt_pk_bf16_f32 v60, v120, v121
    v_cvt_pk_bf16_f32 v61, v122, v123
    v_cvt_pk_bf16_f32 v62, v124, v125
    v_cvt_pk_bf16_f32 v63, v126, v127
    s_waitcnt lgkmcnt(0)
    v_exp_f32 v64, v64
    v_exp_f32 v65, v65
    v_mfma_f32_32x32x16_bf16 v[144:159], v[44:47], v[60:63], v[144:159]
    ds_read_b128 v[20:23], v196 offset:9472
    ds_read_b32 v28, v197 offset:9472
    ds_read_b128 v[40:43], v198 offset:7104
    ds_read_b128 v[44:47], v198 offset:7712
    v_exp_f32 v66, v66
    v_exp_f32 v67, v67
    v_exp_f32 v68, v68
    v_exp_f32 v69, v69
    v_exp_f32 v70, v70
    v_mfma_f32_32x32x16_bf16 v[80:95], v[24:27], v[8:11], v[160:175]
    v_exp_f32 v71, v71
    v_exp_f32 v72, v72
    s_mov_b32 m0, s24
    s_add_u32 s24, s24, 4096
    buffer_load_dwordx4 v5, s[8:11], s25 offen lds
    s_add_u32 s25, s25, 4096
    v_cvt_pk_bf16_f32 v48, v64, v65
    v_cvt_pk_bf16_f32 v49, v66, v67
    v_cvt_pk_bf16_f32 v50, v68, v69
    v_cvt_pk_bf16_f32 v51, v70, v71
    v_mfma_f32_32x32x8_bf16 v[80:95], v[30:31], v[16:17], v[80:95]
    v_exp_f32 v73, v73
    v_exp_f32 v74, v74
    v_exp_f32 v75, v75
    v_exp_f32 v76, v76
    v_mfma_f32_32x32x16_bf16 v[128:143], v[32:35], v[48:51], v[128:143]
    v_exp_f32 v77, v77
    v_exp_f32 v78, v78
    v_exp_f32 v79, v79
    v_exp_f32 v96, v96
    v_mfma_f32_32x32x16_bf16 v[112:127], v[24:27], v[12:15], v[176:191]
    v_cvt_pk_bf16_f32 v52, v72, v73
    v_cvt_pk_bf16_f32 v53, v74, v75
    v_cvt_pk_bf16_f32 v54, v76, v77
    v_cvt_pk_bf16_f32 v55, v78, v79
    s_mov_b32 m0, s24
    s_add_u32 s24, s24, 4096
    buffer_load_dwordx4 v5, s[8:11], s25 offen lds
    s_add_u32 s25, s25, 4096
    v_exp_f32 v97, v97
    v_exp_f32 v98, v98
    v_exp_f32 v99, v99
    v_mfma_f32_32x32x16_bf16 v[128:143], v[36:39], v[52:55], v[128:143]
    v_exp_f32 v100, v100
    v_exp_f32 v101, v101
    v_exp_f32 v102, v102
    v_exp_f32 v103, v103
    v_exp_f32 v104, v104
    v_mfma_f32_32x32x8_bf16 v[112:127], v[30:31], v[18:19], v[112:127]
    v_cvt_pk_bf16_f32 v56, v96, v97
    v_cvt_pk_bf16_f32 v57, v98, v99
    v_cvt_pk_bf16_f32 v58, v100, v101
    v_cvt_pk_bf16_f32 v59, v102, v103
    v_exp_f32 v105, v105
    v_exp_f32 v106, v106
    v_exp_f32 v107, v107
    v_mfma_f32_32x32x16_bf16 v[144:159], v[32:35], v[56:59], v[144:159]
    v_exp_f32 v108, v108
    v_exp_f32 v109, v109
    v_exp_f32 v110, v110
    v_exp_f32 v111, v111
    s_nop 0
    v_cvt_pk_bf16_f32 v60, v104, v105
    v_cvt_pk_bf16_f32 v61, v106, v107
    v_cvt_pk_bf16_f32 v62, v108, v109
    v_cvt_pk_bf16_f32 v63, v110, v111
    s_waitcnt lgkmcnt(0)
    v_exp_f32 v80, v80
    v_exp_f32 v81, v81
    v_mfma_f32_32x32x16_bf16 v[144:159], v[36:39], v[60:63], v[144:159]
    ds_read_b128 v[24:27], v196 offset:11840
    ds_read_b32 v30, v197 offset:11840
    ds_read_b128 v[32:35], v198 offset:9472
    ds_read_b128 v[36:39], v198 offset:10080
    v_exp_f32 v82, v82
    v_exp_f32 v83, v83
    v_exp_f32 v84, v84
    v_exp_f32 v85, v85
    v_exp_f32 v86, v86
    v_mfma_f32_32x32x16_bf16 v[64:79], v[20:23], v[8:11], v[160:175]
    v_exp_f32 v87, v87
    v_exp_f32 v88, v88
    s_mov_b32 m0, s24
    s_add_u32 s24, s24, 4096
    buffer_load_dwordx4 v5, s[8:11], s25 offen lds
    s_add_u32 s25, s25, 4096
    v_cvt_pk_bf16_f32 v48, v80, v81
    v_cvt_pk_bf16_f32 v49, v82, v83
    v_cvt_pk_bf16_f32 v50, v84, v85
    v_cvt_pk_bf16_f32 v51, v86, v87
    v_mfma_f32_32x32x8_bf16 v[64:79], v[28:29], v[16:17], v[64:79]
    v_exp_f32 v89, v89
    v_exp_f32 v90, v90
    v_exp_f32 v91, v91
    v_exp_f32 v92, v92
    v_mfma_f32_32x32x16_bf16 v[128:143], v[40:43], v[48:51], v[128:143]
    v_exp_f32 v93, v93
    v_exp_f32 v94, v94
    v_exp_f32 v95, v95
    v_exp_f32 v112, v112
    v_mfma_f32_32x32x16_bf16 v[96:111], v[20:23], v[12:15], v[176:191]
    v_cvt_pk_bf16_f32 v52, v88, v89
    v_cvt_pk_bf16_f32 v53, v90, v91
    v_cvt_pk_bf16_f32 v54, v92, v93
    v_cvt_pk_bf16_f32 v55, v94, v95
    s_mov_b32 m0, s24
    s_add_u32 s24, s24, 4096
    buffer_load_dwordx4 v5, s[8:11], s25 offen lds
    s_add_u32 s25, s25, 4096
    v_exp_f32 v113, v113
    v_exp_f32 v114, v114
    v_exp_f32 v115, v115
    v_mfma_f32_32x32x16_bf16 v[128:143], v[44:47], v[52:55], v[128:143]
    v_exp_f32 v116, v116
    v_exp_f32 v117, v117
    v_exp_f32 v118, v118
    v_exp_f32 v119, v119
    v_exp_f32 v120, v120
    v_mfma_f32_32x32x8_bf16 v[96:111], v[28:29], v[18:19], v[96:111]
    v_cvt_pk_bf16_f32 v56, v112, v113
    v_cvt_pk_bf16_f32 v57, v114, v115
    v_cvt_pk_bf16_f32 v58, v116, v117
    v_cvt_pk_bf16_f32 v59, v118, v119
    v_exp_f32 v121, v121
    v_exp_f32 v122, v122
    v_exp_f32 v123, v123
    v_mfma_f32_32x32x16_bf16 v[144:159], v[40:43], v[56:59], v[144:159]
    v_exp_f32 v124, v124
    v_exp_f32 v125, v125
    v_exp_f32 v126, v126
    v_exp_f32 v127, v127
    s_nop 0
    v_cvt_pk_bf16_f32 v60, v120, v121
    v_cvt_pk_bf16_f32 v61, v122, v123
    v_cvt_pk_bf16_f32 v62, v124, v125
    v_cvt_pk_bf16_f32 v63, v126, v127
    v_add_u32 v196, 9472, v196
    v_add_u32 v197, 9472, v197
    v_add_u32 v198, 9472, v198
    s_waitcnt vmcnt(6)
    s_barrier
    s_waitcnt lgkmcnt(0)
    v_exp_f32 v64, v64
    v_exp_f32 v65, v65
    v_mfma_f32_32x32x16_bf16 v[144:159], v[44:47], v[60:63], v[144:159]
    ds_read_b128 v[20:23], v196 offset:4736
    ds_read_b32 v28, v197 offset:4736
    ds_read_b128 v[40:43], v198 offset:2368
    ds_read_b128 v[44:47], v198 offset:2976
    v_exp_f32 v66, v66
    v_exp_f32 v67, v67
    v_exp_f32 v68, v68
    v_exp_f32 v69, v69
    v_exp_f32 v70, v70
    v_mfma_f32_32x32x16_bf16 v[80:95], v[24:27], v[8:11], v[160:175]
    v_exp_f32 v71, v71
    v_exp_f32 v72, v72
    s_mov_b32 m0, s24
    s_add_u32 s24, s24, 4096
    buffer_load_dwordx4 v5, s[8:11], s25 offen lds
    s_add_u32 s25, s25, 4096
    v_cvt_pk_bf16_f32 v48, v64, v65
    v_cvt_pk_bf16_f32 v49, v66, v67
    v_cvt_pk_bf16_f32 v50, v68, v69
    v_cvt_pk_bf16_f32 v51, v70, v71
    v_mfma_f32_32x32x8_bf16 v[80:95], v[30:31], v[16:17], v[80:95]
    v_exp_f32 v73, v73
    v_exp_f32 v74, v74
    v_exp_f32 v75, v75
    v_exp_f32 v76, v76
    v_mfma_f32_32x32x16_bf16 v[128:143], v[32:35], v[48:51], v[128:143]
    v_exp_f32 v77, v77
    v_exp_f32 v78, v78
    v_exp_f32 v79, v79
    v_exp_f32 v96, v96
    v_mfma_f32_32x32x16_bf16 v[112:127], v[24:27], v[12:15], v[176:191]
    v_cvt_pk_bf16_f32 v52, v72, v73
    v_cvt_pk_bf16_f32 v53, v74, v75
    v_cvt_pk_bf16_f32 v54, v76, v77
    v_cvt_pk_bf16_f32 v55, v78, v79
    s_mov_b32 m0, s24
    s_add_u32 s24, s24, 4096
    buffer_load_dwordx4 v5, s[8:11], s25 offen lds
    s_add_u32 s25, s25, 4096
    v_exp_f32 v97, v97
    v_exp_f32 v98, v98
    v_exp_f32 v99, v99
    v_mfma_f32_32x32x16_bf16 v[128:143], v[36:39], v[52:55], v[128:143]
    v_exp_f32 v100, v100
    v_exp_f32 v101, v101
    v_exp_f32 v102, v102
    v_exp_f32 v103, v103
    v_exp_f32 v104, v104
    v_mfma_f32_32x32x8_bf16 v[112:127], v[30:31], v[18:19], v[112:127]
    v_cvt_pk_bf16_f32 v56, v96, v97
    v_cvt_pk_bf16_f32 v57, v98, v99
    v_cvt_pk_bf16_f32 v58, v100, v101
    v_cvt_pk_bf16_f32 v59, v102, v103
    v_exp_f32 v105, v105
    v_exp_f32 v106, v106
    v_exp_f32 v107, v107
    v_mfma_f32_32x32x16_bf16 v[144:159], v[32:35], v[56:59], v[144:159]
    v_exp_f32 v108, v108
    v_exp_f32 v109, v109
    v_exp_f32 v110, v110
    v_exp_f32 v111, v111
    s_nop 0
    v_cvt_pk_bf16_f32 v60, v104, v105
    v_cvt_pk_bf16_f32 v61, v106, v107
    v_cvt_pk_bf16_f32 v62, v108, v109
    v_cvt_pk_bf16_f32 v63, v110, v111
    s_waitcnt lgkmcnt(0)
    v_exp_f32 v80, v80
    v_exp_f32 v81, v81
    v_mfma_f32_32x32x16_bf16 v[144:159], v[36:39], v[60:63], v[144:159]
    ds_read_b128 v[24:27], v196 offset:7104
    ds_read_b32 v30, v197 offset:7104
    ds_read_b128 v[32:35], v198 offset:4736
    ds_read_b128 v[36:39], v198 offset:5344
    v_exp_f32 v82, v82
    v_exp_f32 v83, v83
    v_exp_f32 v84, v84
    v_exp_f32 v85, v85
    v_exp_f32 v86, v86
    v_mfma_f32_32x32x16_bf16 v[64:79], v[20:23], v[8:11], v[160:175]
    v_exp_f32 v87, v87
    v_exp_f32 v88, v88
    s_mov_b32 m0, s24
    s_add_u32 s24, s24, 4096
    buffer_load_dwordx4 v5, s[8:11], s25 offen lds
    s_add_u32 s25, s25, 4096
    v_cvt_pk_bf16_f32 v48, v80, v81
    v_cvt_pk_bf16_f32 v49, v82, v83
    v_cvt_pk_bf16_f32 v50, v84, v85
    v_cvt_pk_bf16_f32 v51, v86, v87
    v_mfma_f32_32x32x8_bf16 v[64:79], v[28:29], v[16:17], v[64:79]
    v_exp_f32 v89, v89
    v_exp_f32 v90, v90
    v_exp_f32 v91, v91
    v_exp_f32 v92, v92
    v_mfma_f32_32x32x16_bf16 v[128:143], v[40:43], v[48:51], v[128:143]
    v_exp_f32 v93, v93
    v_exp_f32 v94, v94
    v_exp_f32 v95, v95
    v_exp_f32 v112, v112
    v_mfma_f32_32x32x16_bf16 v[96:111], v[20:23], v[12:15], v[176:191]
    v_cvt_pk_bf16_f32 v52, v88, v89
    v_cvt_pk_bf16_f32 v53, v90, v91
    v_cvt_pk_bf16_f32 v54, v92, v93
    v_cvt_pk_bf16_f32 v55, v94, v95
    s_mov_b32 m0, s24
    s_add_u32 s24, s24, 4096
    buffer_load_dwordx4 v5, s[8:11], s25 offen lds
    s_add_u32 s25, s25, 4096
    v_exp_f32 v113, v113
    v_exp_f32 v114, v114
    v_exp_f32 v115, v115
    v_mfma_f32_32x32x16_bf16 v[128:143], v[44:47], v[52:55], v[128:143]
    v_exp_f32 v116, v116
    v_exp_f32 v117, v117
    v_exp_f32 v118, v118
    v_exp_f32 v119, v119
    v_exp_f32 v120, v120
    v_mfma_f32_32x32x8_bf16 v[96:111], v[28:29], v[18:19], v[96:111]
    v_cvt_pk_bf16_f32 v56, v112, v113
    v_cvt_pk_bf16_f32 v57, v114, v115
    v_cvt_pk_bf16_f32 v58, v116, v117
    v_cvt_pk_bf16_f32 v59, v118, v119
    v_exp_f32 v121, v121
    v_exp_f32 v122, v122
    v_exp_f32 v123, v123
    v_mfma_f32_32x32x16_bf16 v[144:159], v[40:43], v[56:59], v[144:159]
    v_exp_f32 v124, v124
    v_exp_f32 v125, v125
    v_exp_f32 v126, v126
    v_exp_f32 v127, v127
    s_nop 0
    v_cvt_pk_bf16_f32 v60, v120, v121
    v_cvt_pk_bf16_f32 v61, v122, v123
    v_cvt_pk_bf16_f32 v62, v124, v125
    v_cvt_pk_bf16_f32 v63, v126, v127
    s_waitcnt lgkmcnt(0)
    v_exp_f32 v64, v64
    v_exp_f32 v65, v65
    v_mfma_f32_32x32x16_bf16 v[144:159], v[44:47], v[60:63], v[144:159]
    ds_read_b128 v[20:23], v196 offset:9472
    ds_read_b32 v28, v197 offset:9472
    ds_read_b128 v[40:43], v198 offset:7104
    ds_read_b128 v[44:47], v198 offset:7712
    v_exp_f32 v66, v66
    v_exp_f32 v67, v67
    v_exp_f32 v68, v68
    v_exp_f32 v69, v69
    v_exp_f32 v70, v70
    v_mfma_f32_32x32x16_bf16 v[80:95], v[24:27], v[8:11], v[160:175]
    v_exp_f32 v71, v71
    v_exp_f32 v72, v72
    s_mov_b32 m0, s24
    s_add_u32 s24, s24, 4096
    buffer_load_dwordx4 v5, s[8:11], s25 offen lds
    s_add_u32 s25, s25, 4096
    v_cvt_pk_bf16_f32 v48, v64, v65
    v_cvt_pk_bf16_f32 v49, v66, v67
    v_cvt_pk_bf16_f32 v50, v68, v69
    v_cvt_pk_bf16_f32 v51, v70, v71
    v_mfma_f32_32x32x8_bf16 v[80:95], v[30:31], v[16:17], v[80:95]
    v_exp_f32 v73, v73
    v_exp_f32 v74, v74
    v_exp_f32 v75, v75
    v_exp_f32 v76, v76
    v_mfma_f32_32x32x16_bf16 v[128:143], v[32:35], v[48:51], v[128:143]
    v_exp_f32 v77, v77
    v_exp_f32 v78, v78
    v_exp_f32 v79, v79
    v_exp_f32 v96, v96
    v_mfma_f32_32x32x16_bf16 v[112:127], v[24:27], v[12:15], v[176:191]
    v_cvt_pk_bf16_f32 v52, v72, v73
    v_cvt_pk_bf16_f32 v53, v74, v75
    v_cvt_pk_bf16_f32 v54, v76, v77
    v_cvt_pk_bf16_f32 v55, v78, v79
    s_mov_b32 m0, s24
    s_add_u32 s24, s24, 4096
    buffer_load_dwordx4 v5, s[8:11], s25 offen lds
    s_add_u32 s25, s25, 4096
    v_exp_f32 v97, v97
    v_exp_f32 v98, v98
    v_exp_f32 v99, v99
    v_mfma_f32_32x32x16_bf16 v[128:143], v[36:39], v[52:55], v[128:143]
    v_exp_f32 v100, v100
    v_exp_f32 v101, v101
    v_exp_f32 v102, v102
    v_exp_f32 v103, v103
    v_exp_f32 v104, v104
    v_mfma_f32_32x32x8_bf16 v[112:127], v[30:31], v[18:19], v[112:127]
    v_cvt_pk_bf16_f32 v56, v96, v97
    v_cvt_pk_bf16_f32 v57, v98, v99
    v_cvt_pk_bf16_f32 v58, v100, v101
    v_cvt_pk_bf16_f32 v59, v102, v103
    v_exp_f32 v105, v105
    v_exp_f32 v106, v106
    v_exp_f32 v107, v107
    v_mfma_f32_32x32x16_bf16 v[144:159], v[32:35], v[56:59], v[144:159]
    v_exp_f32 v108, v108
    v_exp_f32 v109, v109
    v_exp_f32 v110, v110
    v_exp_f32 v111, v111
    s_nop 0
    v_cvt_pk_bf16_f32 v60, v104, v105
    v_cvt_pk_bf16_f32 v61, v106, v107
    v_cvt_pk_bf16_f32 v62, v108, v109
    v_cvt_pk_bf16_f32 v63, v110, v111
    s_waitcnt lgkmcnt(0)
    v_exp_f32 v80, v80
    v_exp_f32 v81, v81
    v_mfma_f32_32x32x16_bf16 v[144:159], v[36:39], v[60:63], v[144:159]
    ds_read_b128 v[24:27], v196 offset:11840
    ds_read_b32 v30, v197 offset:11840
    ds_read_b128 v[32:35], v198 offset:9472
    ds_read_b128 v[36:39], v198 offset:10080
    v_exp_f32 v82, v82
    v_exp_f32 v83, v83
    v_exp_f32 v84, v84
    v_exp_f32 v85, v85
    v_exp_f32 v86, v86
    v_mfma_f32_32x32x16_bf16 v[64:79], v[20:23], v[8:11], v[160:175]
    v_exp_f32 v87, v87
    v_exp_f32 v88, v88
    s_mov_b32 m0, s24
    s_add_u32 s24, s24, 4096
    buffer_load_dwordx4 v5, s[8:11], s25 offen lds
    s_add_u32 s25, s25, 4096
    v_cvt_pk_bf16_f32 v48, v80, v81
    v_cvt_pk_bf16_f32 v49, v82, v83
    v_cvt_pk_bf16_f32 v50, v84, v85
    v_cvt_pk_bf16_f32 v51, v86, v87
    v_mfma_f32_32x32x8_bf16 v[64:79], v[28:29], v[16:17], v[64:79]
    v_exp_f32 v89, v89
    v_exp_f32 v90, v90
    v_exp_f32 v91, v91
    v_exp_f32 v92, v92
    v_mfma_f32_32x32x16_bf16 v[128:143], v[40:43], v[48:51], v[128:143]
    v_exp_f32 v93, v93
    v_exp_f32 v94, v94
    v_exp_f32 v95, v95
    v_exp_f32 v112, v112
    v_mfma_f32_32x32x16_bf16 v[96:111], v[20:23], v[12:15], v[176:191]
    v_cvt_pk_bf16_f32 v52, v88, v89
    v_cvt_pk_bf16_f32 v53, v90, v91
    v_cvt_pk_bf16_f32 v54, v92, v93
    v_cvt_pk_bf16_f32 v55, v94, v95
    v_exp_f32 v113, v113
    v_exp_f32 v114, v114
    v_exp_f32 v115, v115
    v_mfma_f32_32x32x16_bf16 v[128:143], v[44:47], v[52:55], v[128:143]
    v_exp_f32 v116, v116
    v_exp_f32 v117, v117
    v_exp_f32 v118, v118
    v_exp_f32 v119, v119
    v_exp_f32 v120, v120
    v_mfma_f32_32x32x8_bf16 v[96:111], v[28:29], v[18:19], v[96:111]
    s_mov_b32 m0, s61
    s_nop 0
    buffer_load_dwordx4 v200, s[44:47], s62 offen lds
    s_mov_b32 s62, s63
    s_mov_b32 s63, s64
    s_mov_b32 s64, s65
    s_mov_b32 s65, s66
    s_mov_b32 s66, s67
    s_mov_b32 s67, s68
    v_cvt_pk_bf16_f32 v56, v112, v113
    v_cvt_pk_bf16_f32 v57, v114, v115
    v_cvt_pk_bf16_f32 v58, v116, v117
    v_cvt_pk_bf16_f32 v59, v118, v119
    v_exp_f32 v121, v121
    v_exp_f32 v122, v122
    v_exp_f32 v123, v123
    v_mfma_f32_32x32x16_bf16 v[144:159], v[40:43], v[56:59], v[144:159]
    v_exp_f32 v124, v124
    v_exp_f32 v125, v125
    v_exp_f32 v126, v126
    v_exp_f32 v127, v127
    s_nop 0
    v_cvt_pk_bf16_f32 v60, v120, v121
    v_cvt_pk_bf16_f32 v61, v122, v123
    v_cvt_pk_bf16_f32 v62, v124, v125
    v_cvt_pk_bf16_f32 v63, v126, v127
    v_add_u32 v196, 9472, v196
    v_add_u32 v197, 9472, v197
    v_add_u32 v198, 9472, v198
    s_waitcnt vmcnt(10)
    s_barrier
    s_waitcnt lgkmcnt(0)
    v_exp_f32 v64, v64
    v_exp_f32 v65, v65
    v_mfma_f32_32x32x16_bf16 v[144:159], v[44:47], v[60:63], v[144:159]
    ds_read_b128 v[20:23], v196 offset:4736
    ds_read_b32 v28, v197 offset:4736
    ds_read_b128 v[40:43], v198 offset:2368
    ds_read_b128 v[44:47], v198 offset:2976
    v_exp_f32 v66, v66
    v_exp_f32 v67, v67
    v_exp_f32 v68, v68
    v_exp_f32 v69, v69
    v_exp_f32 v70, v70
    v_mfma_f32_32x32x16_bf16 v[80:95], v[24:27], v[8:11], v[160:175]
    v_exp_f32 v71, v71
    v_exp_f32 v72, v72
    s_waitcnt vmcnt(0)
    ds_read_b64_tr_b16 v[208:209], v204
    ds_read_b64_tr_b16 v[210:211], v204 offset:128
    v_cvt_pk_bf16_f32 v48, v64, v65
    v_cvt_pk_bf16_f32 v49, v66, v67
    v_cvt_pk_bf16_f32 v50, v68, v69
    v_cvt_pk_bf16_f32 v51, v70, v71
    v_mfma_f32_32x32x8_bf16 v[80:95], v[30:31], v[16:17], v[80:95]
    v_exp_f32 v73, v73
    v_exp_f32 v74, v74
    v_exp_f32 v75, v75
    v_exp_f32 v76, v76
    v_mfma_f32_32x32x16_bf16 v[128:143], v[32:35], v[48:51], v[128:143]
    v_exp_f32 v77, v77
    v_exp_f32 v78, v78
    v_exp_f32 v79, v79
    v_exp_f32 v96, v96
    v_mfma_f32_32x32x16_bf16 v[112:127], v[24:27], v[12:15], v[176:191]
    v_cvt_pk_bf16_f32 v52, v72, v73
    v_cvt_pk_bf16_f32 v53, v74, v75
    v_cvt_pk_bf16_f32 v54, v76, v77
    v_cvt_pk_bf16_f32 v55, v78, v79
    v_exp_f32 v97, v97
    v_exp_f32 v98, v98
    v_exp_f32 v99, v99
    v_mfma_f32_32x32x16_bf16 v[128:143], v[36:39], v[52:55], v[128:143]
    v_exp_f32 v100, v100
    v_exp_f32 v101, v101
    v_exp_f32 v102, v102
    v_exp_f32 v103, v103
    v_exp_f32 v104, v104
    v_mfma_f32_32x32x8_bf16 v[112:127], v[30:31], v[18:19], v[112:127]
    v_cvt_pk_bf16_f32 v56, v96, v97
    v_cvt_pk_bf16_f32 v57, v98, v99
    v_cvt_pk_bf16_f32 v58, v100, v101
    v_cvt_pk_bf16_f32 v59, v102, v103
    v_exp_f32 v105, v105
    v_exp_f32 v106, v106
    v_exp_f32 v107, v107
    v_mfma_f32_32x32x16_bf16 v[144:159], v[32:35], v[56:59], v[144:159]
    v_exp_f32 v108, v108
    v_exp_f32 v109, v109
    v_exp_f32 v110, v110
    v_exp_f32 v111, v111
    s_nop 0
    v_cvt_pk_bf16_f32 v60, v104, v105
    v_cvt_pk_bf16_f32 v61, v106, v107
    v_cvt_pk_bf16_f32 v62, v108, v109
    v_cvt_pk_bf16_f32 v63, v110, v111
    s_waitcnt lgkmcnt(0)
    v_exp_f32 v80, v80
    v_exp_f32 v81, v81
    v_mfma_f32_32x32x16_bf16 v[144:159], v[36:39], v[60:63], v[144:159]
    ds_read_b128 v[24:27], v196 offset:7104
    ds_read_b32 v30, v197 offset:7104
    ds_read_b128 v[32:35], v198 offset:4736
    ds_read_b128 v[36:39], v198 offset:5344
    v_exp_f32 v82, v82
    v_exp_f32 v83, v83
    v_exp_f32 v84, v84
    v_exp_f32 v85, v85
    v_exp_f32 v86, v86
    v_mfma_f32_32x32x16_bf16 v[64:79], v[20:23], v[8:11], v[160:175]
    v_exp_f32 v87, v87
    v_exp_f32 v88, v88
    buffer_store_dwordx4 v[208:211], v5, s[56:59], s69 offen sc1
    s_add_u32 s69, s69, 1024
    v_cvt_pk_bf16_f32 v48, v80, v81
    v_cvt_pk_bf16_f32 v49, v82, v83
    v_cvt_pk_bf16_f32 v50, v84, v85
    v_cvt_pk_bf16_f32 v51, v86, v87
    v_mfma_f32_32x32x8_bf16 v[64:79], v[28:29], v[16:17], v[64:79]
    v_exp_f32 v89, v89
    v_exp_f32 v90, v90
    v_exp_f32 v91, v91
    v_exp_f32 v92, v92
    v_mfma_f32_32x32x16_bf16 v[128:143], v[40:43], v[48:51], v[128:143]
    s_mov_b32 m0, s61
    s_nop 0
    buffer_load_dwordx4 v200, s[44:47], s62 offen lds
    s_mov_b32 s62, s63
    s_mov_b32 s63, s64
    s_mov_b32 s64, s65
    s_mov_b32 s65, s66
    s_mov_b32 s66, s67
    s_mov_b32 s67, s68
    v_exp_f32 v93, v93
    v_exp_f32 v94, v94
    v_exp_f32 v95, v95
    v_exp_f32 v112, v112
    v_mfma_f32_32x32x16_bf16 v[96:111], v[20:23], v[12:15], v[176:191]
    v_cvt_pk_bf16_f32 v52, v88, v89
    v_cvt_pk_bf16_f32 v53, v90, v91
    v_cvt_pk_bf16_f32 v54, v92, v93
    v_cvt_pk_bf16_f32 v55, v94, v95
    v_exp_f32 v113, v113
    v_exp_f32 v114, v114
    v_exp_f32 v115, v115
    v_mfma_f32_32x32x16_bf16 v[128:143], v[44:47], v[52:55], v[128:143]
    v_exp_f32 v116, v116
    v_exp_f32 v117, v117
    v_exp_f32 v118, v118
    v_exp_f32 v119, v119
    v_exp_f32 v120, v120
    v_mfma_f32_32x32x8_bf16 v[96:111], v[28:29], v[18:19], v[96:111]
    v_cvt_pk_bf16_f32 v56, v112, v113
    v_cvt_pk_bf16_f32 v57, v114, v115
    v_cvt_pk_bf16_f32 v58, v116, v117
    v_cvt_pk_bf16_f32 v59, v118, v119
    v_exp_f32 v121, v121
    v_exp_f32 v122, v122
    v_exp_f32 v123, v123
    v_mfma_f32_32x32x16_bf16 v[144:159], v[40:43], v[56:59], v[144:159]
    v_exp_f32 v124, v124
    v_exp_f32 v125, v125
    v_exp_f32 v126, v126
    v_exp_f32 v127, v127
    s_nop 0
    v_cvt_pk_bf16_f32 v60, v120, v121
    v_cvt_pk_bf16_f32 v61, v122, v123
    v_cvt_pk_bf16_f32 v62, v124, v125
    v_cvt_pk_bf16_f32 v63, v126, v127
    s_waitcnt lgkmcnt(0)
    v_exp_f32 v64, v64
    v_exp_f32 v65, v65
    v_mfma_f32_32x32x16_bf16 v[144:159], v[44:47], v[60:63], v[144:159]
    ds_read_b128 v[20:23], v196 offset:9472
    ds_read_b32 v28, v197 offset:9472
    ds_read_b128 v[40:43], v198 offset:7104
    ds_read_b128 v[44:47], v198 offset:7712
    v_exp_f32 v66, v66
    v_exp_f32 v67, v67
    v_exp_f32 v68, v68
    v_exp_f32 v69, v69
    v_exp_f32 v70, v70
    v_mfma_f32_32x32x16_bf16 v[80:95], v[24:27], v[8:11], v[160:175]
    v_exp_f32 v71, v71
    v_exp_f32 v72, v72
    v_cvt_pk_bf16_f32 v48, v64, v65
    v_cvt_pk_bf16_f32 v49, v66, v67
    v_cvt_pk_bf16_f32 v50, v68, v69
    v_cvt_pk_bf16_f32 v51, v70, v71
    v_mfma_f32_32x32x8_bf16 v[80:95], v[30:31], v[16:17], v[80:95]
    v_exp_f32 v73, v73
    v_exp_f32 v74, v74
    v_exp_f32 v75, v75
    v_exp_f32 v76, v76
    v_mfma_f32_32x32x16_bf16 v[128:143], v[32:35], v[48:51], v[128:143]
    v_exp_f32 v77, v77
    v_exp_f32 v78, v78
    v_exp_f32 v79, v79
    v_exp_f32 v96, v96
    v_mfma_f32_32x32x16_bf16 v[112:127], v[24:27], v[12:15], v[176:191]
    v_cvt_pk_bf16_f32 v52, v72, v73
    v_cvt_pk_bf16_f32 v53, v74, v75
    v_cvt_pk_bf16_f32 v54, v76, v77
    v_cvt_pk_bf16_f32 v55, v78, v79
    v_exp_f32 v97, v97
    v_exp_f32 v98, v98
    v_exp_f32 v99, v99
    v_mfma_f32_32x32x16_bf16 v[128:143], v[36:39], v[52:55], v[128:143]
    v_exp_f32 v100, v100
    v_exp_f32 v101, v101
    v_exp_f32 v102, v102
    v_exp_f32 v103, v103
    v_exp_f32 v104, v104
    v_mfma_f32_32x32x8_bf16 v[112:127], v[30:31], v[18:19], v[112:127]
    v_cvt_pk_bf16_f32 v56, v96, v97
    v_cvt_pk_bf16_f32 v57, v98, v99
    v_cvt_pk_bf16_f32 v58, v100, v101
    v_cvt_pk_bf16_f32 v59, v102, v103
    v_exp_f32 v105, v105
    v_exp_f32 v106, v106
    v_exp_f32 v107, v107
    v_mfma_f32_32x32x16_bf16 v[144:159], v[32:35], v[56:59], v[144:159]
    v_exp_f32 v108, v108
    v_exp_f32 v109, v109
    v_exp_f32 v110, v110
    v_exp_f32 v111, v111
    s_nop 0
    v_cvt_pk_bf16_f32 v60, v104, v105
    v_cvt_pk_bf16_f32 v61, v106, v107
    v_cvt_pk_bf16_f32 v62, v108, v109
    v_cvt_pk_bf16_f32 v63, v110, v111
    s_waitcnt lgkmcnt(0)
    v_exp_f32 v80, v80
    v_exp_f32 v81, v81
    v_mfma_f32_32x32x16_bf16 v[144:159], v[36:39], v[60:63], v[144:159]
    ds_read_b128 v[24:27], v196 offset:11840
    ds_read_b32 v30, v197 offset:11840
    ds_read_b128 v[32:35], v198 offset:9472
    ds_read_b128 v[36:39], v198 offset:10080
    v_exp_f32 v82, v82
    v_exp_f32 v83, v83
    v_exp_f32 v84, v84
    v_exp_f32 v85, v85
    v_exp_f32 v86, v86
    v_mfma_f32_32x32x16_bf16 v[64:79], v[20:23], v[8:11], v[160:175]
    v_exp_f32 v87, v87
    v_exp_f32 v88, v88
    v_cvt_pk_bf16_f32 v48, v80, v81
    v_cvt_pk_bf16_f32 v49, v82, v83
    v_cvt_pk_bf16_f32 v50, v84, v85
    v_cvt_pk_bf16_f32 v51, v86, v87
    v_mfma_f32_32x32x8_bf16 v[64:79], v[28:29], v[16:17], v[64:79]
    v_exp_f32 v89, v89
    v_exp_f32 v90, v90
    v_exp_f32 v91, v91
    v_exp_f32 v92, v92
    v_mfma_f32_32x32x16_bf16 v[128:143], v[40:43], v[48:51], v[128:143]
    v_exp_f32 v93, v93
    v_exp_f32 v94, v94
    v_exp_f32 v95, v95
    v_exp_f32 v112, v112
    v_mfma_f32_32x32x16_bf16 v[96:111], v[20:23], v[12:15], v[176:191]
    v_cvt_pk_bf16_f32 v52, v88, v89
    v_cvt_pk_bf16_f32 v53, v90, v91
    v_cvt_pk_bf16_f32 v54, v92, v93
    v_cvt_pk_bf16_f32 v55, v94, v95
    v_exp_f32 v113, v113
    v_exp_f32 v114, v114
    v_exp_f32 v115, v115
    v_mfma_f32_32x32x16_bf16 v[128:143], v[44:47], v[52:55], v[128:143]
    v_exp_f32 v116, v116
    v_exp_f32 v117, v117
    v_exp_f32 v118, v118
    v_exp_f32 v119, v119
    v_exp_f32 v120, v120
    v_mfma_f32_32x32x8_bf16 v[96:111], v[28:29], v[18:19], v[96:111]
    v_cvt_pk_bf16_f32 v56, v112, v113
    v_cvt_pk_bf16_f32 v57, v114, v115
    v_cvt_pk_bf16_f32 v58, v116, v117
    v_cvt_pk_bf16_f32 v59, v118, v119
    v_exp_f32 v121, v121
    v_exp_f32 v122, v122
    v_exp_f32 v123, v123
    v_mfma_f32_32x32x16_bf16 v[144:159], v[40:43], v[56:59], v[144:159]
    v_exp_f32 v124, v124
    v_exp_f32 v125, v125
    v_exp_f32 v126, v126
    v_exp_f32 v127, v127
    s_nop 0
    v_cvt_pk_bf16_f32 v60, v120, v121
    v_cvt_pk_bf16_f32 v61, v122, v123
    v_cvt_pk_bf16_f32 v62, v124, v125
    v_cvt_pk_bf16_f32 v63, v126, v127
    v_add_u32 v196, 9472, v196
    v_add_u32 v197, 9472, v197
    v_add_u32 v198, 9472, v198
    s_barrier
.p2align 6
L_loop_28:
    s_waitcnt lgkmcnt(0)
    v_exp_f32 v64, v64
    v_exp_f32 v65, v65
    v_mfma_f32_32x32x16_bf16 v[144:159], v[44:47], v[60:63], v[144:159]
    ds_read_b128 v[20:23], v196 offset:4736
    ds_read_b32 v28, v197 offset:4736
    ds_read_b128 v[40:43], v198 offset:2368
    ds_read_b128 v[44:47], v198 offset:2976
    v_exp_f32 v66, v66
    v_exp_f32 v67, v67
    v_exp_f32 v68, v68
    v_exp_f32 v69, v69
    v_exp_f32 v70, v70
    v_mfma_f32_32x32x16_bf16 v[80:95], v[24:27], v[8:11], v[160:175]
    v_exp_f32 v71, v71
    v_exp_f32 v72, v72
    s_waitcnt vmcnt(0)
    ds_read_b64_tr_b16 v[208:209], v204
    ds_read_b64_tr_b16 v[210:211], v204 offset:128
    v_cvt_pk_bf16_f32 v48, v64, v65
    v_cvt_pk_bf16_f32 v49, v66, v67
    v_cvt_pk_bf16_f32 v50, v68, v69
    v_cvt_pk_bf16_f32 v51, v70, v71
    v_mfma_f32_32x32x8_bf16 v[80:95], v[30:31], v[16:17], v[80:95]
    v_exp_f32 v73, v73
    v_exp_f32 v74, v74
    v_exp_f32 v75, v75
    v_exp_f32 v76, v76
    v_mfma_f32_32x32x16_bf16 v[128:143], v[32:35], v[48:51], v[128:143]
    v_exp_f32 v77, v77
    v_exp_f32 v78, v78
    v_exp_f32 v79, v79
    v_exp_f32 v96, v96
    v_mfma_f32_32x32x16_bf16 v[112:127], v[24:27], v[12:15], v[176:191]
    v_cvt_pk_bf16_f32 v52, v72, v73
    v_cvt_pk_bf16_f32 v53, v74, v75
    v_cvt_pk_bf16_f32 v54, v76, v77
    v_cvt_pk_bf16_f32 v55, v78, v79
    v_exp_f32 v97, v97
    v_exp_f32 v98, v98
    v_exp_f32 v99, v99
    v_mfma_f32_32x32x16_bf16 v[128:143], v[36:39], v[52:55], v[128:143]
    v_exp_f32 v100, v100
    v_exp_f32 v101, v101
    v_exp_f32 v102, v102
    v_exp_f32 v103, v103
    v_exp_f32 v104, v104
    v_mfma_f32_32x32x8_bf16 v[112:127], v[30:31], v[18:19], v[112:127]
    v_cvt_pk_bf16_f32 v56, v96, v97
    v_cvt_pk_bf16_f32 v57, v98, v99
    v_cvt_pk_bf16_f32 v58, v100, v101
    v_cvt_pk_bf16_f32 v59, v102, v103
    v_exp_f32 v105, v105
    v_exp_f32 v106, v106
    v_exp_f32 v107, v107
    v_mfma_f32_32x32x16_bf16 v[144:159], v[32:35], v[56:59], v[144:159]
    v_exp_f32 v108, v108
    v_exp_f32 v109, v109
    v_exp_f32 v110, v110
    v_exp_f32 v111, v111
    s_nop 0
    v_cvt_pk_bf16_f32 v60, v104, v105
    v_cvt_pk_bf16_f32 v61, v106, v107
    v_cvt_pk_bf16_f32 v62, v108, v109
    v_cvt_pk_bf16_f32 v63, v110, v111
    s_waitcnt lgkmcnt(0)
    v_exp_f32 v80, v80
    v_exp_f32 v81, v81
    v_mfma_f32_32x32x16_bf16 v[144:159], v[36:39], v[60:63], v[144:159]
    ds_read_b128 v[24:27], v196 offset:7104
    ds_read_b32 v30, v197 offset:7104
    ds_read_b128 v[32:35], v198 offset:4736
    ds_read_b128 v[36:39], v198 offset:5344
    v_exp_f32 v82, v82
    v_exp_f32 v83, v83
    v_exp_f32 v84, v84
    v_exp_f32 v85, v85
    v_exp_f32 v86, v86
    v_mfma_f32_32x32x16_bf16 v[64:79], v[20:23], v[8:11], v[160:175]
    v_exp_f32 v87, v87
    v_exp_f32 v88, v88
    buffer_store_dwordx4 v[208:211], v5, s[56:59], s69 offen sc1
    s_add_u32 s69, s69, 1024
    v_cvt_pk_bf16_f32 v48, v80, v81
    v_cvt_pk_bf16_f32 v49, v82, v83
    v_cvt_pk_bf16_f32 v50, v84, v85
    v_cvt_pk_bf16_f32 v51, v86, v87
    v_mfma_f32_32x32x8_bf16 v[64:79], v[28:29], v[16:17], v[64:79]
    v_exp_f32 v89, v89
    v_exp_f32 v90, v90
    v_exp_f32 v91, v91
    v_exp_f32 v92, v92
    v_mfma_f32_32x32x16_bf16 v[128:143], v[40:43], v[48:51], v[128:143]
    s_mov_b32 m0, s61
    s_nop 0
    buffer_load_dwordx4 v200, s[44:47], s62 offen lds
    s_mov_b32 s62, s63
    s_mov_b32 s63, s64
    s_mov_b32 s64, s65
    s_mov_b32 s65, s66
    s_mov_b32 s66, s67
    s_mov_b32 s67, s68
    v_exp_f32 v93, v93
    v_exp_f32 v94, v94
    v_exp_f32 v95, v95
    v_exp_f32 v112, v112
    v_mfma_f32_32x32x16_bf16 v[96:111], v[20:23], v[12:15], v[176:191]
    v_cvt_pk_bf16_f32 v52, v88, v89
    v_cvt_pk_bf16_f32 v53, v90, v91
    v_cvt_pk_bf16_f32 v54, v92, v93
    v_cvt_pk_bf16_f32 v55, v94, v95
    v_exp_f32 v113, v113
    v_exp_f32 v114, v114
    v_exp_f32 v115, v115
    v_mfma_f32_32x32x16_bf16 v[128:143], v[44:47], v[52:55], v[128:143]
    v_exp_f32 v116, v116
    v_exp_f32 v117, v117
    v_exp_f32 v118, v118
    v_exp_f32 v119, v119
    v_exp_f32 v120, v120
    v_mfma_f32_32x32x8_bf16 v[96:111], v[28:29], v[18:19], v[96:111]
    v_cvt_pk_bf16_f32 v56, v112, v113
    v_cvt_pk_bf16_f32 v57, v114, v115
    v_cvt_pk_bf16_f32 v58, v116, v117
    v_cvt_pk_bf16_f32 v59, v118, v119
    v_exp_f32 v121, v121
    v_exp_f32 v122, v122
    v_exp_f32 v123, v123
    v_mfma_f32_32x32x16_bf16 v[144:159], v[40:43], v[56:59], v[144:159]
    v_exp_f32 v124, v124
    v_exp_f32 v125, v125
    v_exp_f32 v126, v126
    v_exp_f32 v127, v127
    s_nop 0
    v_cvt_pk_bf16_f32 v60, v120, v121
    v_cvt_pk_bf16_f32 v61, v122, v123
    v_cvt_pk_bf16_f32 v62, v124, v125
    v_cvt_pk_bf16_f32 v63, v126, v127
    s_waitcnt lgkmcnt(0)
    v_exp_f32 v64, v64
    v_exp_f32 v65, v65
    v_mfma_f32_32x32x16_bf16 v[144:159], v[44:47], v[60:63], v[144:159]
    ds_read_b128 v[20:23], v196 offset:9472
    ds_read_b32 v28, v197 offset:9472
    ds_read_b128 v[40:43], v198 offset:7104
    ds_read_b128 v[44:47], v198 offset:7712
    v_exp_f32 v66, v66
    v_exp_f32 v67, v67
    v_exp_f32 v68, v68
    v_exp_f32 v69, v69
    v_exp_f32 v70, v70
    v_mfma_f32_32x32x16_bf16 v[80:95], v[24:27], v[8:11], v[160:175]
    v_exp_f32 v71, v71
    v_exp_f32 v72, v72
    v_cvt_pk_bf16_f32 v48, v64, v65
    v_cvt_pk_bf16_f32 v49, v66, v67
    v_cvt_pk_bf16_f32 v50, v68, v69
    v_cvt_pk_bf16_f32 v51, v70, v71
    v_mfma_f32_32x32x8_bf16 v[80:95], v[30:31], v[16:17], v[80:95]
    v_exp_f32 v73, v73
    v_exp_f32 v74, v74
    v_exp_f32 v75, v75
    v_exp_f32 v76, v76
    v_mfma_f32_32x32x16_bf16 v[128:143], v[32:35], v[48:51], v[128:143]
    v_exp_f32 v77, v77
    v_exp_f32 v78, v78
    v_exp_f32 v79, v79
    v_exp_f32 v96, v96
    v_mfma_f32_32x32x16_bf16 v[112:127], v[24:27], v[12:15], v[176:191]
    v_cvt_pk_bf16_f32 v52, v72, v73
    v_cvt_pk_bf16_f32 v53, v74, v75
    v_cvt_pk_bf16_f32 v54, v76, v77
    v_cvt_pk_bf16_f32 v55, v78, v79
    v_exp_f32 v97, v97
    v_exp_f32 v98, v98
    v_exp_f32 v99, v99
    v_mfma_f32_32x32x16_bf16 v[128:143], v[36:39], v[52:55], v[128:143]
    v_exp_f32 v100, v100
    v_exp_f32 v101, v101
    v_exp_f32 v102, v102
    v_exp_f32 v103, v103
    v_exp_f32 v104, v104
    v_mfma_f32_32x32x8_bf16 v[112:127], v[30:31], v[18:19], v[112:127]
    v_cvt_pk_bf16_f32 v56, v96, v97
    v_cvt_pk_bf16_f32 v57, v98, v99
    v_cvt_pk_bf16_f32 v58, v100, v101
    v_cvt_pk_bf16_f32 v59, v102, v103
    v_exp_f32 v105, v105
    v_exp_f32 v106, v106
    v_exp_f32 v107, v107
    v_mfma_f32_32x32x16_bf16 v[144:159], v[32:35], v[56:59], v[144:159]
    v_exp_f32 v108, v108
    v_exp_f32 v109, v109
    v_exp_f32 v110, v110
    v_exp_f32 v111, v111
    s_nop 0
    v_cvt_pk_bf16_f32 v60, v104, v105
    v_cvt_pk_bf16_f32 v61, v106, v107
    v_cvt_pk_bf16_f32 v62, v108, v109
    v_cvt_pk_bf16_f32 v63, v110, v111
    s_waitcnt lgkmcnt(0)
    v_exp_f32 v80, v80
    v_exp_f32 v81, v81
    v_mfma_f32_32x32x16_bf16 v[144:159], v[36:39], v[60:63], v[144:159]
    ds_read_b128 v[24:27], v196 offset:11840
    ds_read_b32 v30, v197 offset:11840
    ds_read_b128 v[32:35], v198 offset:9472
    ds_read_b128 v[36:39], v198 offset:10080
    v_exp_f32 v82, v82
    v_exp_f32 v83, v83
    v_exp_f32 v84, v84
    v_exp_f32 v85, v85
    v_exp_f32 v86, v86
    v_mfma_f32_32x32x16_bf16 v[64:79], v[20:23], v[8:11], v[160:175]
    v_exp_f32 v87, v87
    v_exp_f32 v88, v88
    v_cvt_pk_bf16_f32 v48, v80, v81
    v_cvt_pk_bf16_f32 v49, v82, v83
    v_cvt_pk_bf16_f32 v50, v84, v85
    v_cvt_pk_bf16_f32 v51, v86, v87
    v_mfma_f32_32x32x8_bf16 v[64:79], v[28:29], v[16:17], v[64:79]
    v_exp_f32 v89, v89
    v_exp_f32 v90, v90
    v_exp_f32 v91, v91
    v_exp_f32 v92, v92
    v_mfma_f32_32x32x16_bf16 v[128:143], v[40:43], v[48:51], v[128:143]
    v_exp_f32 v93, v93
    v_exp_f32 v94, v94
    v_exp_f32 v95, v95
    v_exp_f32 v112, v112
    v_mfma_f32_32x32x16_bf16 v[96:111], v[20:23], v[12:15], v[176:191]
    v_cvt_pk_bf16_f32 v52, v88, v89
    v_cvt_pk_bf16_f32 v53, v90, v91
    v_cvt_pk_bf16_f32 v54, v92, v93
    v_cvt_pk_bf16_f32 v55, v94, v95
    v_exp_f32 v113, v113
    v_exp_f32 v114, v114
    v_exp_f32 v115, v115
    v_mfma_f32_32x32x16_bf16 v[128:143], v[44:47], v[52:55], v[128:143]
    v_exp_f32 v116, v116
    v_exp_f32 v117, v117
    v_exp_f32 v118, v118
    v_exp_f32 v119, v119
    v_exp_f32 v120, v120
    v_mfma_f32_32x32x8_bf16 v[96:111], v[28:29], v[18:19], v[96:111]
    v_cvt_pk_bf16_f32 v56, v112, v113
    v_cvt_pk_bf16_f32 v57, v114, v115
    v_cvt_pk_bf16_f32 v58, v116, v117
    v_cvt_pk_bf16_f32 v59, v118, v119
    v_exp_f32 v121, v121
    v_exp_f32 v122, v122
    v_exp_f32 v123, v123
    v_mfma_f32_32x32x16_bf16 v[144:159], v[40:43], v[56:59], v[144:159]
    v_exp_f32 v124, v124
    v_exp_f32 v125, v125
    v_exp_f32 v126, v126
    v_exp_f32 v127, v127
    s_nop 0
    v_cvt_pk_bf16_f32 v60, v120, v121
    v_cvt_pk_bf16_f32 v61, v122, v123
    v_cvt_pk_bf16_f32 v62, v124, v125
    v_cvt_pk_bf16_f32 v63, v126, v127
    v_add_u32 v196, 9472, v196
    v_add_u32 v197, 9472, v197
    v_add_u32 v198, 9472, v198
    s_sub_u32 s31, s31, 1
    s_cmp_lg_u32 s31, 0
    s_cbranch_scc1 L_loop_28
    v_mfma_f32_32x32x16_bf16 v[144:159], v[44:47], v[60:63], v[144:159]
    s_waitcnt lgkmcnt(0)
    s_nop 7
    s_nop 3
    s_cmp_lg_u32 s30, 0
    s_cbranch_scc1 L_ok_29
    s_mov_b32 s33, 0x4e800000
    v_cmp_nlt_f32 s[34:35], v138, s33
    v_cmp_nlt_f32 s[36:37], v154, s33
    s_or_b64 s[34:35], s[34:35], s[36:37]
    s_movk_i32 s33, 0x207
    v_cmp_class_f32 s[36:37], v128, s33
    s_or_b64 s[34:35], s[34:35], s[36:37]
    v_cmp_class_f32 s[36:37], v129, s33
    s_or_b64 s[34:35], s[34:35], s[36:37]
    v_cmp_class_f32 s[36:37], v130, s33
    s_or_b64 s[34:35], s[34:35], s[36:37]
    v_cmp_class_f32 s[36:37], v131, s33
    s_or_b64 s[34:35], s[34:35], s[36:37]
    v_cmp_class_f32 s[36:37], v132, s33
    s_or_b64 s[34:35], s[34:35], s[36:37]
    v_cmp_class_f32 s[36:37], v133, s33
    s_or_b64 s[34:35], s[34:35], s[36:37]
    v_cmp_class_f32 s[36:37], v134, s33
    s_or_b64 s[34:35], s[34:35], s[36:37]
    v_cmp_class_f32 s[36:37], v135, s33
    s_or_b64 s[34:35], s[34:35], s[36:37]
    v_cmp_class_f32 s[36:37], v136, s33
    s_or_b64 s[34:35], s[34:35], s[36:37]
    v_cmp_class_f32 s[36:37], v137, s33
    s_or_b64 s[34:35], s[34:35], s[36:37]
    v_cmp_class_f32 s[36:37], v144, s33
    s_or_b64 s[34:35], s[34:35], s[36:37]
    v_cmp_class_f32 s[36:37], v145, s33
    s_or_b64 s[34:35], s[34:35], s[36:37]
    v_cmp_class_f32 s[36:37], v146, s33
    s_or_b64 s[34:35], s[34:35], s[36:37]
    v_cmp_class_f32 s[36:37], v147, s33
    s_or_b64 s[34:35], s[34:35], s[36:37]
    v_cmp_class_f32 s[36:37], v148, s33
    s_or_b64 s[34:35], s[34:35], s[36:37]
    v_cmp_class_f32 s[36:37], v149, s33
    s_or_b64 s[34:35], s[34:35], s[36:37]
    v_cmp_class_f32 s[36:37], v150, s33
    s_or_b64 s[34:35], s[34:35], s[36:37]
    v_cmp_class_f32 s[36:37], v151, s33
    s_or_b64 s[34:35], s[34:35], s[36:37]
    v_cmp_class_f32 s[36:37], v152, s33
    s_or_b64 s[34:35], s[34:35], s[36:37]
    v_cmp_class_f32 s[36:37], v153, s33
    s_or_b64 s[34:35], s[34:35], s[36:37]
    s_cmp_eq_u64 s[34:35], 0
    s_cbranch_scc1 L_ok_29
    s_mov_b32 s46, 0
    s_mov_b32 s58, 0
    v_mov_b32 v196, v2
    v_mov_b32 v197, v3
    v_mov_b32 v192, 0xff800000
    v_mov_b32 v193, 0xff800000
    s_mov_b32 s31, 0
L_fb_30:
    ds_read_b128 v[20:23], v196
    ds_read_b32 v28, v197
    s_waitcnt lgkmcnt(0)
    v_mfma_f32_32x32x16_bf16 v[64:79], v[20:23], v[8:11], 0
    v_mfma_f32_32x32x8_bf16 v[64:79], v[28:29], v[16:17], v[64:79]
    v_mfma_f32_32x32x16_bf16 v[96:111], v[20:23], v[12:15], 0
    v_mfma_f32_32x32x8_bf16 v[96:111], v[28:29], v[18:19], v[96:111]
    s_nop 7
    s_nop 7
    v_max3_f32 v192, v64, v65, v192
    v_max3_f32 v192, v66, v67, v192
    v_max3_f32 v192, v68, v69, v192
    v_max3_f32 v192, v70, v71, v192
    v_max3_f32 v192, v72, v73, v192
    v_max3_f32 v192, v74, v75, v192
    v_max3_f32 v192, v76, v77, v192
    v_max3_f32 v192, v78, v79, v192
    v_max3_f32 v193, v96, v97, v193
    v_max3_f32 v193, v98, v99, v193
    v_max3_f32 v193, v100, v101, v193
    v_max3_f32 v193, v102, v103, v193
    v_max3_f32 v193, v104, v105, v193
    v_max3_f32 v193, v106, v107, v193
    v_max3_f32 v193, v108, v109, v193
    v_max3_f32 v193, v110, v111, v193
    v_add_u32 v196, 2368, v196
    v_add_u32 v197, 2368, v197
    s_add_u32 s31, s31, 1
    s_cmp_lt_u32 s31, 32
    s_cbranch_scc1 L_fb_30
    v_mov_b32 v194, v192
    s_nop 1
    v_permlane32_swap_b32 v192, v194
    s_nop 1
    v_max_f32 v192, v192, v194
    v_sub_f32 v160, 0, v192
    v_sub_f32 v161, 0, v192
    v_sub_f32 v162, 0, v192
    v_sub_f32 v163, 0, v192
    v_sub_f32 v164, 0, v192
    v_sub_f32 v165, 0, v192
    v_sub_f32 v166, 0, v192
    v_sub_f32 v167, 0, v192
    v_sub_f32 v168, 0, v192
    v_sub_f32 v169, 0, v192
    v_sub_f32 v170, 0, v192
    v_sub_f32 v171, 0, v192
    v_sub_f32 v172, 0, v192
    v_sub_f32 v173, 0, v192
    v_sub_f32 v174, 0, v192
    v_sub_f32 v175, 0, v192
    v_mov_b32 v194, v193
    s_nop 1
    v_permlane32_swap_b32 v193, v194
    s_nop 1
    v_max_f32 v193, v193, v194
    v_sub_f32 v176, 0, v193
    v_sub_f32 v177, 0, v193
    v_sub_f32 v178, 0, v193
    v_sub_f32 v179, 0, v193
    v_sub_f32 v180, 0, v193
    v_sub_f32 v181, 0, v193
    v_sub_f32 v182, 0, v193
    v_sub_f32 v183, 0, v193
    v_sub_f32 v184, 0, v193
    v_sub_f32 v185, 0, v193
    v_sub_f32 v186, 0, v193
    v_sub_f32 v187, 0, v193
    v_sub_f32 v188, 0, v193
    v_sub_f32 v189, 0, v193
    v_sub_f32 v190, 0, v193
    v_sub_f32 v191, 0, v193
    v_mov_b32 v128, 0
    v_mov_b32 v144, 0
    v_mov_b32 v129, 0
    v_mov_b32 v145, 0
    v_mov_b32 v130, 0
    v_mov_b32 v146, 0
    v_mov_b32 v131, 0
    v_mov_b32 v147, 0
    v_mov_b32 v132, 0
    v_mov_b32 v148, 0
    v_mov_b32 v133, 0
    v_mov_b32 v149, 0
    v_mov_b32 v134, 0
    v_mov_b32 v150, 0
    v_mov_b32 v135, 0
    v_mov_b32 v151, 0
    v_mov_b32 v136, 0
    v_mov_b32 v152, 0
    v_mov_b32 v137, 0
    v_mov_b32 v153, 0
    v_mov_b32 v138, 0
    v_mov_b32 v154, 0
    v_mov_b32 v139, 0
    v_mov_b32 v155, 0
    v_mov_b32 v140, 0
    v_mov_b32 v156, 0
    v_mov_b32 v141, 0
    v_mov_b32 v157, 0
    v_mov_b32 v142, 0
    v_mov_b32 v158, 0
    v_mov_b32 v143, 0
    v_mov_b32 v159, 0
    s_mov_b32 s30, 1
    s_branch L_main_27
L_ok_29:
    s_load_dwordx2 s[48:49], s[0:1], 0
    s_add_u32 s44, s4, 4407296
    s_addc_u32 s45, s5, 0
    s_and_b32 s45, s45, 0xffff
    s_mov_b32 s46, 663552
    s_mov_b32 s47, 0x20000
    s_lshr_b32 s22, s6, 2
    s_lshl_b32 s23, s7, 3
    s_add_u32 s22, s22, s23
    s_and_b32 s23, s6, 3
    s_mul_i32 s26, s23, 165888
    s_cmp_ge_u32 s3, 4
    s_cbranch_scc1 L_late_31
    s_lshl_b32 s27, s3, 10
    s_add_u32 s27, s27, s26
    buffer_load_dwordx4 v[20:23], v5, s[44:47], s27 offen
    s_add_u32 s27, s27, 9216
    buffer_load_dwordx4 v[24:27], v5, s[44:47], s27 offen
    s_add_u32 s27, s27, 9216
    buffer_load_dwordx4 v[28:31], v5, s[44:47], s27 offen
    s_add_u32 s27, s27, 9216
    buffer_load_dwordx4 v[32:35], v5, s[44:47], s27 offen
    s_add_u32 s27, s27, 9216
    buffer_load_dwordx4 v[36:39], v5, s[44:47], s27 offen
    s_add_u32 s27, s27, 9216
    buffer_load_dwordx4 v[40:43], v5, s[44:47], s27 offen
    s_add_u32 s27, s27, 9216
    buffer_load_dwordx4 v[44:47], v5, s[44:47], s27 offen
    s_add_u32 s27, s27, 9216
    buffer_load_dwordx4 v[48:51], v5, s[44:47], s27 offen
    s_add_u32 s27, s27, 9216
    buffer_load_dwordx4 v[52:55], v5, s[44:47], s27 offen
    s_add_u32 s27, s27, 9216
    buffer_load_dwordx4 v[56:59], v5, s[44:47], s27 offen
    s_add_u32 s27, s27, 9216
    buffer_load_dwordx4 v[60:63], v5, s[44:47], s27 offen
    s_add_u32 s27, s27, 9216
    buffer_load_dwordx4 v[64:67], v5, s[44:47], s27 offen
    s_add_u32 s27, s27, 9216
    buffer_load_dwordx4 v[68:71], v5, s[44:47], s27 offen
    s_add_u32 s27, s27, 9216
    buffer_load_dwordx4 v[72:75], v5, s[44:47], s27 offen
    s_add_u32 s27, s27, 9216
    buffer_load_dwordx4 v[76:79], v5, s[44:47], s27 offen
    s_add_u32 s27, s27, 9216
    buffer_load_dwordx4 v[80:83], v5, s[44:47], s27 offen
    s_add_u32 s27, s27, 9216
    buffer_load_dwordx4 v[84:87], v5, s[44:47], s27 offen
    s_add_u32 s27, s27, 9216
    buffer_load_dwordx4 v[88:91], v5, s[44:47], s27 offen
L_late_31:
    s_add_u32 s8, s4, 22896640
    s_addc_u32 s9, s5, 0
    s_and_b32 s9, s9, 0xffff
    s_mov_b32 s10, 2359296
    s_mov_b32 s11, 0x20000
    s_barrier
    s_lshl_b32 s33, s20, 1
    s_add_u32 s34, s33, s21
    s_xor_b32 s35, s34, 1
    s_mul_i32 s34, s34, 3072
    s_mul_i32 s35, s35, 3072
    v_add_u32 v196, s34, v5
    v_add_u32 v197, s35, v5
    s_cmp_lg_u32 s21, 0
    s_cbranch_scc1 L_kh1_32
    v_mov_b32 v155, v176
    ds_write_b128 v196, v[144:147]
    ds_write_b128 v196, v[148:151] offset:1024
    ds_write_b128 v196, v[152:155] offset:2048
    s_waitcnt lgkmcnt(0)
    s_barrier
    ds_read_b128 v[96:99], v197
    ds_read_b128 v[100:103], v197 offset:1024
    ds_read_b128 v[104:107], v197 offset:2048
    s_waitcnt lgkmcnt(0)
    v_min_f32 v112, v160, v107
    v_sub_f32 v113, v112, v160
    v_sub_f32 v114, v112, v107
    v_exp_f32 v113, v113
    v_exp_f32 v114, v114
    s_nop 0
    v_mul_f32 v128, v128, v113
    v_fmac_f32 v128, v96, v114
    v_mul_f32 v129, v129, v113
    v_fmac_f32 v129, v97, v114
    v_mul_f32 v130, v130, v113
    v_fmac_f32 v130, v98, v114
    v_mul_f32 v131, v131, v113
    v_fmac_f32 v131, v99, v114
    v_mul_f32 v132, v132, v113
    v_fmac_f32 v132, v100, v114
    v_mul_f32 v133, v133, v113
    v_fmac_f32 v133, v101, v114
    v_mul_f32 v134, v134, v113
    v_fmac_f32 v134, v102, v114
    v_mul_f32 v135, v135, v113
    v_fmac_f32 v135, v103, v114
    v_mul_f32 v136, v136, v113
    v_fmac_f32 v136, v104, v114
    v_mul_f32 v137, v137, v113
    v_fmac_f32 v137, v105, v114
    v_mul_f32 v138, v138, v113
    v_fmac_f32 v138, v106, v114
    v_mov_b32 v115, v138
    v_mov_b32 v116, v138
    s_nop 1
    v_permlane32_swap_b32 v115, v116
    s_nop 1
    v_rcp_f32 v115, v115
    s_nop 0
    v_mul_f32 v128, v128, v115
    v_mul_f32 v129, v129, v115
    v_mul_f32 v130, v130, v115
    v_mul_f32 v131, v131, v115
    v_mul_f32 v132, v132, v115
    v_mul_f32 v133, v133, v115
    v_mul_f32 v134, v134, v115
    v_mul_f32 v135, v135, v115
    v_mul_f32 v136, v136, v115
    v_mul_f32 v137, v137, v115
    v_cvt_pk_bf16_f32 v120, v128, v129
    v_cvt_pk_bf16_f32 v121, v130, v131
    v_cvt_pk_bf16_f32 v122, v132, v133
    v_cvt_pk_bf16_f32 v123, v134, v135
    v_cvt_pk_bf16_f32 v124, v136, v137
    v_bfe_u32 v117, v1, 4, 1
    v_mul_u32_u24 v117, 18432, v117
    v_and_b32 v118, 15, v1
    v_lshl_add_u32 v117, v118, 4, v117
    v_lshrrev_b32 v118, 5, v1
    v_lshl_add_u32 v119, v118, 8, v117
    s_lshl_b32 s36, s7, 4
    s_lshl_b32 s37, s20, 2
    s_add_u32 s36, s36, s37
    s_add_u32 s36, s36, 0
    s_mul_i32 s36, s36, 18
    s_lshr_b32 s37, s6, 1
    s_add_u32 s37, s37, s36
    s_lshl_b32 s37, s37, 10
    s_and_b32 s38, s6, 1
    s_lshl_b32 s38, s38, 9
    s_add_u32 s37, s37, s38
    buffer_store_dwordx4 v[120:123], v119, s[8:11], s37 offen sc1
    s_lshr_b32 s37, s6, 4
    s_add_u32 s37, s37, 16
    s_add_u32 s37, s37, s36
    s_lshl_b32 s37, s37, 10
    s_bfe_u32 s38, s6, 0x20002
    s_lshl_b32 s38, s38, 8
    s_add_u32 s37, s37, s38
    s_and_b32 s38, s6, 3
    s_lshl_b32 s38, s38, 2
    s_add_u32 s37, s37, s38
    v_cmp_gt_u32 vcc, 32, v1
    s_and_saveexec_b64 s[40:41], vcc
    buffer_store_dword v124, v117, s[8:11], s37 offen sc1
    s_branch L_cmb_33
L_kh1_32:
    v_mov_b32 v139, v160
    ds_write_b128 v196, v[128:131]
    ds_write_b128 v196, v[132:135] offset:1024
    ds_write_b128 v196, v[136:139] offset:2048
    s_waitcnt lgkmcnt(0)
    s_barrier
    ds_read_b128 v[96:99], v197
    ds_read_b128 v[100:103], v197 offset:1024
    ds_read_b128 v[104:107], v197 offset:2048
    s_waitcnt lgkmcnt(0)
    v_min_f32 v112, v176, v107
    v_sub_f32 v113, v112, v176
    v_sub_f32 v114, v112, v107
    v_exp_f32 v113, v113
    v_exp_f32 v114, v114
    s_nop 0
    v_mul_f32 v144, v144, v113
    v_fmac_f32 v144, v96, v114
    v_mul_f32 v145, v145, v113
    v_fmac_f32 v145, v97, v114
    v_mul_f32 v146, v146, v113
    v_fmac_f32 v146, v98, v114
    v_mul_f32 v147, v147, v113
    v_fmac_f32 v147, v99, v114
    v_mul_f32 v148, v148, v113
    v_fmac_f32 v148, v100, v114
    v_mul_f32 v149, v149, v113
    v_fmac_f32 v149, v101, v114
    v_mul_f32 v150, v150, v113
    v_fmac_f32 v150, v102, v114
    v_mul_f32 v151, v151, v113
    v_fmac_f32 v151, v103, v114
    v_mul_f32 v152, v152, v113
    v_fmac_f32 v152, v104, v114
    v_mul_f32 v153, v153, v113
    v_fmac_f32 v153, v105, v114
    v_mul_f32 v154, v154, v113
    v_fmac_f32 v154, v106, v114
    v_mov_b32 v115, v154
    v_mov_b32 v116, v154
    s_nop 1
    v_permlane32_swap_b32 v115, v116
    s_nop 1
    v_rcp_f32 v115, v115
    s_nop 0
    v_mul_f32 v144, v144, v115
    v_mul_f32 v145, v145, v115
    v_mul_f32 v146, v146, v115
    v_mul_f32 v147, v147, v115
    v_mul_f32 v148, v148, v115
    v_mul_f32 v149, v149, v115
    v_mul_f32 v150, v150, v115
    v_mul_f32 v151, v151, v115
    v_mul_f32 v152, v152, v115
    v_mul_f32 v153, v153, v115
    v_cvt_pk_bf16_f32 v120, v144, v145
    v_cvt_pk_bf16_f32 v121, v146, v147
    v_cvt_pk_bf16_f32 v122, v148, v149
    v_cvt_pk_bf16_f32 v123, v150, v151
    v_cvt_pk_bf16_f32 v124, v152, v153
    v_bfe_u32 v117, v1, 4, 1
    v_mul_u32_u24 v117, 18432, v117
    v_and_b32 v118, 15, v1
    v_lshl_add_u32 v117, v118, 4, v117
    v_lshrrev_b32 v118, 5, v1
    v_lshl_add_u32 v119, v118, 8, v117
    s_lshl_b32 s36, s7, 4
    s_lshl_b32 s37, s20, 2
    s_add_u32 s36, s36, s37
    s_add_u32 s36, s36, 2
    s_mul_i32 s36, s36, 18
    s_lshr_b32 s37, s6, 1
    s_add_u32 s37, s37, s36
    s_lshl_b32 s37, s37, 10
    s_and_b32 s38, s6, 1
    s_lshl_b32 s38, s38, 9
    s_add_u32 s37, s37, s38
    buffer_store_dwordx4 v[120:123], v119, s[8:11], s37 offen sc1
    s_lshr_b32 s37, s6, 4
    s_add_u32 s37, s37, 16
    s_add_u32 s37, s37, s36
    s_lshl_b32 s37, s37, 10
    s_bfe_u32 s38, s6, 0x20002
    s_lshl_b32 s38, s38, 8
    s_add_u32 s37, s37, s38
    s_and_b32 s38, s6, 3
    s_lshl_b32 s38, s38, 2
    s_add_u32 s37, s37, s38
    v_cmp_gt_u32 vcc, 32, v1
    s_and_saveexec_b64 s[40:41], vcc
    buffer_store_dword v124, v117, s[8:11], s37 offen sc1
    s_branch L_cmb_33
L_cmb_33:
    s_mov_b64 exec, -1
    s_waitcnt lgkmcnt(0)
    s_and_b32 s49, s49, 0xffff
    s_mov_b32 s50, 2359296
    s_mov_b32 s51, 0x20000
    s_add_u32 s52, s4, 28205056
    s_addc_u32 s53, s5, 0
    s_and_b32 s53, s53, 0xffff
    s_mov_b32 s54, 13824
    s_mov_b32 s55, 0x20000
    s_add_u32 s56, s4, 25255936
    s_addc_u32 s57, s5, 0
    s_and_b32 s57, s57, 0xffff
    s_mov_b32 s58, 2359296
    s_mov_b32 s59, 0x20000
    s_add_u32 s60, s4, 27615232
    s_addc_u32 s61, s5, 0
    s_and_b32 s61, s61, 0xffff
    s_mov_b32 s62, 589824
    s_mov_b32 s63, 0x20000
    s_add_u32 s64, s4, 47095808
    s_addc_u32 s65, s5, 0
    s_and_b32 s65, s65, 0xffff
    s_mov_b32 s66, 32768
    s_mov_b32 s67, 0x20000
    v_and_b32 v6, 15, v1
    v_lshrrev_b32 v7, 4, v1
    s_waitcnt vmcnt(0)
    s_barrier
    s_cmp_lg_u32 s3, 0
    s_cbranch_scc1 L_noatom_34
    s_mov_b64 exec, 1
    s_lshl_b32 s27, s7, 8
    v_mov_b32 v12, 1
    v_mov_b32 v13, 0
    buffer_atomic_add v12, v13, s[64:67], s27 offen sc1
    s_mov_b64 exec, -1
L_noatom_34:
    s_cmp_lt_u32 s3, 4
    s_cbranch_scc1 L_early_35
    s_lshl_b32 s27, s3, 10
    s_add_u32 s27, s27, s26
    buffer_load_dwordx4 v[20:23], v5, s[44:47], s27 offen
    s_add_u32 s27, s27, 9216
    buffer_load_dwordx4 v[24:27], v5, s[44:47], s27 offen
    s_add_u32 s27, s27, 9216
    buffer_load_dwordx4 v[28:31], v5, s[44:47], s27 offen
    s_add_u32 s27, s27, 9216
    buffer_load_dwordx4 v[32:35], v5, s[44:47], s27 offen
    s_add_u32 s27, s27, 9216
    buffer_load_dwordx4 v[36:39], v5, s[44:47], s27 offen
    s_add_u32 s27, s27, 9216
    buffer_load_dwordx4 v[40:43], v5, s[44:47], s27 offen
    s_add_u32 s27, s27, 9216
    buffer_load_dwordx4 v[44:47], v5, s[44:47], s27 offen
    s_add_u32 s27, s27, 9216
    buffer_load_dwordx4 v[48:51], v5, s[44:47], s27 offen
    s_add_u32 s27, s27, 9216
    buffer_load_dwordx4 v[52:55], v5, s[44:47], s27 offen
    s_add_u32 s27, s27, 9216
    buffer_load_dwordx4 v[56:59], v5, s[44:47], s27 offen
    s_add_u32 s27, s27, 9216
    buffer_load_dwordx4 v[60:63], v5, s[44:47], s27 offen
    s_add_u32 s27, s27, 9216
    buffer_load_dwordx4 v[64:67], v5, s[44:47], s27 offen
    s_add_u32 s27, s27, 9216
    buffer_load_dwordx4 v[68:71], v5, s[44:47], s27 offen
    s_add_u32 s27, s27, 9216
    buffer_load_dwordx4 v[72:75], v5, s[44:47], s27 offen
    s_add_u32 s27, s27, 9216
    buffer_load_dwordx4 v[76:79], v5, s[44:47], s27 offen
    s_add_u32 s27, s27, 9216
    buffer_load_dwordx4 v[80:83], v5, s[44:47], s27 offen
    s_add_u32 s27, s27, 9216
    buffer_load_dwordx4 v[84:87], v5, s[44:47], s27 offen
    s_add_u32 s27, s27, 9216
    buffer_load_dwordx4 v[88:91], v5, s[44:47], s27 offen
L_early_35:
    s_lshl_b32 s27, s22, 5
    v_add_u32 v8, s27, v6
    v_mul_u32_u24 v8, 1152, v8
    v_lshl_add_u32 v8, v7, 3, v8
    v_lshlrev_b32 v9, 4, v7
    s_mul_i32 s27, s23, 288
    s_lshl_b32 s28, s3, 5
    s_add_u32 s28, s28, s27
    buffer_load_dwordx2 v[96:97], v8, s[48:51], s28 offen
    s_add_u32 s29, s28, 18432
    buffer_load_dwordx2 v[98:99], v8, s[48:51], s29 offen
    s_lshl_b32 s29, s28, 1
    s_add_u32 s29, s29, 4608
    buffer_load_dwordx4 v[100:103], v9, s[52:55], s29 offen
    s_cmp_ge_u32 s3, 2
    s_cbranch_scc1 L_nosec_36
    s_add_u32 s27, s26, 8192
    buffer_load_dwordx4 v[128:131], v5, s[44:47], s27 offen
    s_add_u32 s27, s27, 9216
    buffer_load_dwordx4 v[132:135], v5, s[44:47], s27 offen
    s_add_u32 s27, s27, 9216
    buffer_load_dwordx4 v[136:139], v5, s[44:47], s27 offen
    s_add_u32 s27, s27, 9216
    buffer_load_dwordx4 v[140:143], v5, s[44:47], s27 offen
    s_add_u32 s27, s27, 9216
    buffer_load_dwordx4 v[144:147], v5, s[44:47], s27 offen
    s_add_u32 s27, s27, 9216
    buffer_load_dwordx4 v[148:151], v5, s[44:47], s27 offen
    s_add_u32 s27, s27, 9216
    buffer_load_dwordx4 v[152:155], v5, s[44:47], s27 offen
    s_add_u32 s27, s27, 9216
    buffer_load_dwordx4 v[156:159], v5, s[44:47], s27 offen
    s_add_u32 s27, s27, 9216
    buffer_load_dwordx4 v[160:163], v5, s[44:47], s27 offen
    s_add_u32 s27, s27, 9216
    buffer_load_dwordx4 v[164:167], v5, s[44:47], s27 offen
    s_add_u32 s27, s27, 9216
    buffer_load_dwordx4 v[168:171], v5, s[44:47], s27 offen
    s_add_u32 s27, s27, 9216
    buffer_load_dwordx4 v[172:175], v5, s[44:47], s27 offen
    s_add_u32 s27, s27, 9216
    buffer_load_dwordx4 v[176:179], v5, s[44:47], s27 offen
    s_add_u32 s27, s27, 9216
    buffer_load_dwordx4 v[180:183], v5, s[44:47], s27 offen
    s_add_u32 s27, s27, 9216
    buffer_load_dwordx4 v[184:187], v5, s[44:47], s27 offen
    s_add_u32 s27, s27, 9216
    buffer_load_dwordx4 v[188:191], v5, s[44:47], s27 offen
    s_add_u32 s27, s27, 9216
    buffer_load_dwordx4 v[192:195], v5, s[44:47], s27 offen
    s_add_u32 s27, s27, 9216
    buffer_load_dwordx4 v[196:199], v5, s[44:47], s27 offen
    s_mul_i32 s27, s23, 288
    s_add_u32 s27, s27, 256
    s_mul_i32 s29, s3, 18432
    s_add_u32 s29, s29, s27
    buffer_load_dwordx2 v[104:105], v8, s[48:51], s29 offen
    s_lshl_b32 s29, s27, 1
    s_add_u32 s29, s29, 4608
    buffer_load_dwordx4 v[108:111], v9, s[52:55], s29 offen
L_nosec_36:
    s_cmp_lg_u32 s3, 0
    s_cbranch_scc1 L_w_37
    s_mov_b64 exec, 1
    s_lshl_b32 s27, s7, 8
    v_mov_b32 v13, 0
    s_mov_b32 s29, 0
L_p_38:
    buffer_load_dword v14, v13, s[64:67], s27 offen sc1
    s_waitcnt vmcnt(0)
    v_readfirstlane_b32 s30, v14
    s_add_u32 s29, s29, 1
    s_cmp_ge_u32 s30, 32
    s_cbranch_scc1 L_d_39
    s_cmp_ge_u32 s29, 1048576
    s_cbranch_scc1 L_d_39
    s_sleep 4
    s_branch L_p_38
L_d_39:
    s_mov_b64 exec, -1
L_w_37:
    s_barrier
    s_mul_i32 s27, s22, 36864
    s_add_u32 s29, s3, 0
    s_min_u32 s29, s29, 35
    s_lshl_b32 s29, s29, 10
    s_add_u32 m0, s29, 32768
    s_add_u32 s29, s29, s27
    buffer_load_dwordx4 v5, s[8:11], s29 offen sc1 lds
    s_add_u32 s29, s3, 8
    s_min_u32 s29, s29, 35
    s_lshl_b32 s29, s29, 10
    s_add_u32 m0, s29, 32768
    s_add_u32 s29, s29, s27
    buffer_load_dwordx4 v5, s[8:11], s29 offen sc1 lds
    s_add_u32 s29, s3, 16
    s_min_u32 s29, s29, 35
    s_lshl_b32 s29, s29, 10
    s_add_u32 m0, s29, 32768
    s_add_u32 s29, s29, s27
    buffer_load_dwordx4 v5, s[8:11], s29 offen sc1 lds
    s_add_u32 s29, s3, 24
    s_min_u32 s29, s29, 35
    s_lshl_b32 s29, s29, 10
    s_add_u32 m0, s29, 32768
    s_add_u32 s29, s29, s27
    buffer_load_dwordx4 v5, s[8:11], s29 offen sc1 lds
    s_add_u32 s29, s3, 32
    s_min_u32 s29, s29, 35
    s_lshl_b32 s29, s29, 10
    s_add_u32 m0, s29, 32768
    s_add_u32 s29, s29, s27
    buffer_load_dwordx4 v5, s[8:11], s29 offen sc1 lds
    v_add_u32 v10, 32768, v5
    v_mov_b32 v200, 0
    v_mov_b32 v201, 0
    v_mov_b32 v202, 0
    v_mov_b32 v203, 0
    v_mov_b32 v204, 0
    v_mov_b32 v205, 0
    v_mov_b32 v206, 0
    v_mov_b32 v207, 0
    v_mov_b32 v208, 0
    v_mov_b32 v209, 0
    v_mov_b32 v210, 0
    v_mov_b32 v211, 0
    s_waitcnt vmcnt(0)
    s_barrier
    v_lshrrev_b32 v11, 1, v7
    v_lshlrev_b32 v11, 8, v11
    v_lshl_add_u32 v11, v6, 4, v11
    v_and_b32 v12, 1, v7
    v_lshl_add_u32 v11, v12, 3, v11
    v_lshlrev_b32 v12, 3, v6
    ds_read_b128 v[112:115], v10 offset:0
    ds_read_b128 v[116:119], v10 offset:18432
    ds_read_b128 v[120:123], v10 offset:1024
    ds_read_b128 v[124:127], v10 offset:19456
    s_waitcnt lgkmcnt(2)
    v_mfma_f32_16x16x32_bf16 v[200:203], v[20:23], v[112:115], v[200:203]
    v_mfma_f32_16x16x32_bf16 v[204:207], v[20:23], v[116:119], v[204:207]
    ds_read_b128 v[112:115], v10 offset:2048
    ds_read_b128 v[116:119], v10 offset:20480
    s_waitcnt lgkmcnt(2)
    v_mfma_f32_16x16x32_bf16 v[200:203], v[24:27], v[120:123], v[200:203]
    v_mfma_f32_16x16x32_bf16 v[204:207], v[24:27], v[124:127], v[204:207]
    ds_read_b128 v[120:123], v10 offset:3072
    ds_read_b128 v[124:127], v10 offset:21504
    s_waitcnt lgkmcnt(2)
    v_mfma_f32_16x16x32_bf16 v[200:203], v[28:31], v[112:115], v[200:203]
    v_mfma_f32_16x16x32_bf16 v[204:207], v[28:31], v[116:119], v[204:207]
    ds_read_b128 v[112:115], v10 offset:4096
    ds_read_b128 v[116:119], v10 offset:22528
    s_waitcnt lgkmcnt(2)
    v_mfma_f32_16x16x32_bf16 v[200:203], v[32:35], v[120:123], v[200:203]
    v_mfma_f32_16x16x32_bf16 v[204:207], v[32:35], v[124:127], v[204:207]
    ds_read_b128 v[120:123], v10 offset:5120
    ds_read_b128 v[124:127], v10 offset:23552
    s_waitcnt lgkmcnt(2)
    v_mfma_f32_16x16x32_bf16 v[200:203], v[36:39], v[112:115], v[200:203]
    v_mfma_f32_16x16x32_bf16 v[204:207], v[36:39], v[116:119], v[204:207]
    ds_read_b128 v[112:115], v10 offset:6144
    ds_read_b128 v[116:119], v10 offset:24576
    s_waitcnt lgkmcnt(2)
    v_mfma_f32_16x16x32_bf16 v[200:203], v[40:43], v[120:123], v[200:203]
    v_mfma_f32_16x16x32_bf16 v[204:207], v[40:43], v[124:127], v[204:207]
    ds_read_b128 v[120:123], v10 offset:7168
    ds_read_b128 v[124:127], v10 offset:25600
    s_waitcnt lgkmcnt(2)
    v_mfma_f32_16x16x32_bf16 v[200:203], v[44:47], v[112:115], v[200:203]
    v_mfma_f32_16x16x32_bf16 v[204:207], v[44:47], v[116:119], v[204:207]
    ds_read_b128 v[112:115], v10 offset:8192
    ds_read_b128 v[116:119], v10 offset:26624
    s_waitcnt lgkmcnt(2)
    v_mfma_f32_16x16x32_bf16 v[200:203], v[48:51], v[120:123], v[200:203]
    v_mfma_f32_16x16x32_bf16 v[204:207], v[48:51], v[124:127], v[204:207]
    ds_read_b128 v[120:123], v10 offset:9216
    ds_read_b128 v[124:127], v10 offset:27648
    s_waitcnt lgkmcnt(2)
    v_mfma_f32_16x16x32_bf16 v[200:203], v[52:55], v[112:115], v[200:203]
    v_mfma_f32_16x16x32_bf16 v[204:207], v[52:55], v[116:119], v[204:207]
    ds_read_b128 v[112:115], v10 offset:10240
    ds_read_b128 v[116:119], v10 offset:28672
    s_waitcnt lgkmcnt(2)
    v_mfma_f32_16x16x32_bf16 v[200:203], v[56:59], v[120:123], v[200:203]
    v_mfma_f32_16x16x32_bf16 v[204:207], v[56:59], v[124:127], v[204:207]
    ds_read_b128 v[120:123], v10 offset:11264
    ds_read_b128 v[124:127], v10 offset:29696
    s_waitcnt lgkmcnt(2)
    v_mfma_f32_16x16x32_bf16 v[200:203], v[60:63], v[112:115], v[200:203]
    v_mfma_f32_16x16x32_bf16 v[204:207], v[60:63], v[116:119], v[204:207]
    ds_read_b128 v[112:115], v10 offset:12288
    ds_read_b128 v[116:119], v10 offset:30720
    s_waitcnt lgkmcnt(2)
    v_mfma_f32_16x16x32_bf16 v[200:203], v[64:67], v[120:123], v[200:203]
    v_mfma_f32_16x16x32_bf16 v[204:207], v[64:67], v[124:127], v[204:207]
    ds_read_b128 v[120:123], v10 offset:13312
    ds_read_b128 v[124:127], v10 offset:31744
    s_waitcnt lgkmcnt(2)
    v_mfma_f32_16x16x32_bf16 v[200:203], v[68:71], v[112:115], v[200:203]
    v_mfma_f32_16x16x32_bf16 v[204:207], v[68:71], v[116:119], v[204:207]
    ds_read_b128 v[112:115], v10 offset:14336
    ds_read_b128 v[116:119], v10 offset:32768
    s_waitcnt lgkmcnt(2)
    v_mfma_f32_16x16x32_bf16 v[200:203], v[72:75], v[120:123], v[200:203]
    v_mfma_f32_16x16x32_bf16 v[204:207], v[72:75], v[124:127], v[204:207]
    ds_read_b128 v[120:123], v10 offset:15360
    ds_read_b128 v[124:127], v10 offset:33792
    s_waitcnt lgkmcnt(2)
    v_mfma_f32_16x16x32_bf16 v[200:203], v[76:79], v[112:115], v[200:203]
    v_mfma_f32_16x16x32_bf16 v[204:207], v[76:79], v[116:119], v[204:207]
    ds_read_b128 v[112:115], v10 offset:16384
    ds_read_b128 v[116:119], v10 offset:34816
    s_waitcnt lgkmcnt(2)
    v_mfma_f32_16x16x32_bf16 v[200:203], v[80:83], v[120:123], v[200:203]
    v_mfma_f32_16x16x32_bf16 v[204:207], v[80:83], v[124:127], v[204:207]
    ds_read_b128 v[120:123], v10 offset:17408
    ds_read_b128 v[124:127], v10 offset:35840
    s_waitcnt lgkmcnt(2)
    v_mfma_f32_16x16x32_bf16 v[200:203], v[84:87], v[112:115], v[200:203]
    v_mfma_f32_16x16x32_bf16 v[204:207], v[84:87], v[116:119], v[204:207]
    s_waitcnt lgkmcnt(0)
    v_mfma_f32_16x16x32_bf16 v[200:203], v[88:91], v[120:123], v[200:203]
    v_mfma_f32_16x16x32_bf16 v[204:207], v[88:91], v[124:127], v[204:207]
    s_cmp_ge_u32 s3, 2
    s_cbranch_scc1 L_p2_40
    s_mul_i32 s27, s3, 18432
    v_add_u32 v13, s27, v10
    ds_read_b128 v[112:115], v13 offset:0
    ds_read_b128 v[116:119], v13 offset:1024
    ds_read_b128 v[120:123], v13 offset:2048
    ds_read_b128 v[124:127], v13 offset:3072
    s_waitcnt lgkmcnt(3)
    v_mfma_f32_16x16x32_bf16 v[208:211], v[128:131], v[112:115], v[208:211]
    ds_read_b128 v[112:115], v13 offset:4096
    s_waitcnt lgkmcnt(3)
    v_mfma_f32_16x16x32_bf16 v[208:211], v[132:135], v[116:119], v[208:211]
    ds_read_b128 v[116:119], v13 offset:5120
    s_waitcnt lgkmcnt(3)
    v_mfma_f32_16x16x32_bf16 v[208:211], v[136:139], v[120:123], v[208:211]
    ds_read_b128 v[120:123], v13 offset:6144
    s_waitcnt lgkmcnt(3)
    v_mfma_f32_16x16x32_bf16 v[208:211], v[140:143], v[124:127], v[208:211]
    ds_read_b128 v[124:127], v13 offset:7168
    s_waitcnt lgkmcnt(3)
    v_mfma_f32_16x16x32_bf16 v[208:211], v[144:147], v[112:115], v[208:211]
    ds_read_b128 v[112:115], v13 offset:8192
    s_waitcnt lgkmcnt(3)
    v_mfma_f32_16x16x32_bf16 v[208:211], v[148:151], v[116:119], v[208:211]
    ds_read_b128 v[116:119], v13 offset:9216
    s_waitcnt lgkmcnt(3)
    v_mfma_f32_16x16x32_bf16 v[208:211], v[152:155], v[120:123], v[208:211]
    ds_read_b128 v[120:123], v13 offset:10240
    s_waitcnt lgkmcnt(3)
    v_mfma_f32_16x16x32_bf16 v[208:211], v[156:159], v[124:127], v[208:211]
    ds_read_b128 v[124:127], v13 offset:11264
    s_waitcnt lgkmcnt(3)
    v_mfma_f32_16x16x32_bf16 v[208:211], v[160:163], v[112:115], v[208:211]
    ds_read_b128 v[112:115], v13 offset:12288
    s_waitcnt lgkmcnt(3)
    v_mfma_f32_16x16x32_bf16 v[208:211], v[164:167], v[116:119], v[208:211]
    ds_read_b128 v[116:119], v13 offset:13312
    s_waitcnt lgkmcnt(3)
    v_mfma_f32_16x16x32_bf16 v[208:211], v[168:171], v[120:123], v[208:211]
    ds_read_b128 v[120:123], v13 offset:14336
    s_waitcnt lgkmcnt(3)
    v_mfma_f32_16x16x32_bf16 v[208:211], v[172:175], v[124:127], v[208:211]
    ds_read_b128 v[124:127], v13 offset:15360
    s_waitcnt lgkmcnt(3)
    v_mfma_f32_16x16x32_bf16 v[208:211], v[176:179], v[112:115], v[208:211]
    ds_read_b128 v[112:115], v13 offset:16384
    s_waitcnt lgkmcnt(3)
    v_mfma_f32_16x16x32_bf16 v[208:211], v[180:183], v[116:119], v[208:211]
    ds_read_b128 v[116:119], v13 offset:17408
    s_waitcnt lgkmcnt(3)
    v_mfma_f32_16x16x32_bf16 v[208:211], v[184:187], v[120:123], v[208:211]
    s_waitcnt lgkmcnt(2)
    v_mfma_f32_16x16x32_bf16 v[208:211], v[188:191], v[124:127], v[208:211]
    s_waitcnt lgkmcnt(1)
    v_mfma_f32_16x16x32_bf16 v[208:211], v[192:195], v[112:115], v[208:211]
    s_waitcnt lgkmcnt(0)
    v_mfma_f32_16x16x32_bf16 v[208:211], v[196:199], v[116:119], v[208:211]
    s_nop 7
    s_mul_i32 s28, s23, 9
    s_add_u32 s28, s28, 8
    v_lshlrev_b32 v40, 16, v104
    v_and_b32 v41, 0xffff0000, v104
    v_lshlrev_b32 v42, 16, v105
    v_and_b32 v43, 0xffff0000, v105
    v_fmac_f32 v40, v208, v108
    v_fmac_f32 v41, v209, v109
    v_fmac_f32 v42, v210, v110
    v_fmac_f32 v43, v211, v111
    v_cvt_pk_bf16_f32 v44, v40, v41
    v_cvt_pk_bf16_f32 v45, v42, v43
    s_lshl_b32 s34, s22, 1
    s_add_u32 s34, s34, s3
    s_mul_i32 s35, s34, 18
    s_lshr_b32 s36, s28, 1
    s_add_u32 s35, s35, s36
    s_lshl_b32 s35, s35, 10
    s_and_b32 s36, s28, 1
    s_lshl_b32 s36, s36, 9
    s_add_u32 s35, s35, s36
    buffer_store_dwordx2 v[44:45], v11, s[56:59], s35 offen
    v_lshlrev_b32 v40, 16, v44
    v_and_b32 v41, 0xffff0000, v44
    v_lshlrev_b32 v42, 16, v45
    v_and_b32 v43, 0xffff0000, v45
    v_add_f32 v46, v40, v41
    v_mul_f32 v47, v40, v40
    v_add_f32 v46, v46, v42
    v_fmac_f32 v47, v41, v41
    v_add_f32 v46, v46, v43
    v_fmac_f32 v47, v42, v42
    v_fmac_f32 v47, v43, v43
    v_mov_b32 v48, v46
    s_nop 1
    v_permlane16_swap_b32 v46, v48
    s_nop 1
    v_add_f32 v46, v46, v48
    v_mov_b32 v48, v46
    s_nop 1
    v_permlane32_swap_b32 v46, v48
    s_nop 1
    v_add_f32 v46, v46, v48
    v_mov_b32 v48, v47
    s_nop 1
    v_permlane16_swap_b32 v47, v48
    s_nop 1
    v_add_f32 v47, v47, v48
    v_mov_b32 v48, v47
    s_nop 1
    v_permlane32_swap_b32 v47, v48
    s_nop 1
    v_add_f32 v47, v47, v48
    s_lshl_b32 s35, s28, 11
    s_lshl_b32 s36, s34, 4
    s_add_u32 s35, s35, s36
    s_lshl_b32 s35, s35, 3
    s_mov_b64 exec, 0xffff
    buffer_store_dwordx2 v[46:47], v12, s[60:63], s35 offen
    s_mov_b64 exec, -1
L_p2_40:
    s_nop 7
    s_mul_i32 s28, s23, 9
    s_add_u32 s28, s28, s3
    s_mov_b32 s29, 0
    v_lshlrev_b32 v20, 16, v96
    v_and_b32 v21, 0xffff0000, v96
    v_lshlrev_b32 v22, 16, v97
    v_and_b32 v23, 0xffff0000, v97
    v_fmac_f32 v20, v200, v100
    v_fmac_f32 v21, v201, v101
    v_fmac_f32 v22, v202, v102
    v_fmac_f32 v23, v203, v103
    v_cvt_pk_bf16_f32 v24, v20, v21
    v_cvt_pk_bf16_f32 v25, v22, v23
    s_lshl_b32 s34, s22, 1
    s_add_u32 s34, s34, s29
    s_mul_i32 s35, s34, 18
    s_lshr_b32 s36, s28, 1
    s_add_u32 s35, s35, s36
    s_lshl_b32 s35, s35, 10
    s_and_b32 s36, s28, 1
    s_lshl_b32 s36, s36, 9
    s_add_u32 s35, s35, s36
    buffer_store_dwordx2 v[24:25], v11, s[56:59], s35 offen
    v_lshlrev_b32 v20, 16, v24
    v_and_b32 v21, 0xffff0000, v24
    v_lshlrev_b32 v22, 16, v25
    v_and_b32 v23, 0xffff0000, v25
    v_add_f32 v26, v20, v21
    v_mul_f32 v27, v20, v20
    v_add_f32 v26, v26, v22
    v_fmac_f32 v27, v21, v21
    v_add_f32 v26, v26, v23
    v_fmac_f32 v27, v22, v22
    v_fmac_f32 v27, v23, v23
    v_mov_b32 v28, v26
    s_nop 1
    v_permlane16_swap_b32 v26, v28
    s_nop 1
    v_add_f32 v26, v26, v28
    v_mov_b32 v28, v26
    s_nop 1
    v_permlane32_swap_b32 v26, v28
    s_nop 1
    v_add_f32 v26, v26, v28
    v_mov_b32 v28, v27
    s_nop 1
    v_permlane16_swap_b32 v27, v28
    s_nop 1
    v_add_f32 v27, v27, v28
    v_mov_b32 v28, v27
    s_nop 1
    v_permlane32_swap_b32 v27, v28
    s_nop 1
    v_add_f32 v27, v27, v28
    s_lshl_b32 s35, s28, 11
    s_lshl_b32 s36, s34, 4
    s_add_u32 s35, s35, s36
    s_lshl_b32 s35, s35, 3
    s_mov_b64 exec, 0xffff
    buffer_store_dwordx2 v[26:27], v12, s[60:63], s35 offen
    s_mov_b64 exec, -1
    s_mov_b32 s29, 1
    v_lshlrev_b32 v30, 16, v98
    v_and_b32 v31, 0xffff0000, v98
    v_lshlrev_b32 v32, 16, v99
    v_and_b32 v33, 0xffff0000, v99
    v_fmac_f32 v30, v204, v100
    v_fmac_f32 v31, v205, v101
    v_fmac_f32 v32, v206, v102
    v_fmac_f32 v33, v207, v103
    v_cvt_pk_bf16_f32 v34, v30, v31
    v_cvt_pk_bf16_f32 v35, v32, v33
    s_lshl_b32 s34, s22, 1
    s_add_u32 s34, s34, s29
    s_mul_i32 s35, s34, 18
    s_lshr_b32 s36, s28, 1
    s_add_u32 s35, s35, s36
    s_lshl_b32 s35, s35, 10
    s_and_b32 s36, s28, 1
    s_lshl_b32 s36, s36, 9
    s_add_u32 s35, s35, s36
    buffer_store_dwordx2 v[34:35], v11, s[56:59], s35 offen
    v_lshlrev_b32 v30, 16, v34
    v_and_b32 v31, 0xffff0000, v34
    v_lshlrev_b32 v32, 16, v35
    v_and_b32 v33, 0xffff0000, v35
    v_add_f32 v36, v30, v31
    v_mul_f32 v37, v30, v30
    v_add_f32 v36, v36, v32
    v_fmac_f32 v37, v31, v31
    v_add_f32 v36, v36, v33
    v_fmac_f32 v37, v32, v32
    v_fmac_f32 v37, v33, v33
    v_mov_b32 v38, v36
    s_nop 1
    v_permlane16_swap_b32 v36, v38
    s_nop 1
    v_add_f32 v36, v36, v38
    v_mov_b32 v38, v36
    s_nop 1
    v_permlane32_swap_b32 v36, v38
    s_nop 1
    v_add_f32 v36, v36, v38
    v_mov_b32 v38, v37
    s_nop 1
    v_permlane16_swap_b32 v37, v38
    s_nop 1
    v_add_f32 v37, v37, v38
    v_mov_b32 v38, v37
    s_nop 1
    v_permlane32_swap_b32 v37, v38
    s_nop 1
    v_add_f32 v37, v37, v38
    s_lshl_b32 s35, s28, 11
    s_lshl_b32 s36, s34, 4
    s_add_u32 s35, s35, s36
    s_lshl_b32 s35, s35, 3
    s_mov_b64 exec, 0xffff
    buffer_store_dwordx2 v[36:37], v12, s[60:63], s35 offen
    s_mov_b64 exec, -1
L_end_21:
    s_endpgm
.section .rodata,"a"
.p2align 6
.amdhsa_kernel k3_kernel
.amdhsa_next_free_vgpr 212
.amdhsa_next_free_sgpr 102
.amdhsa_accum_offset 212
.amdhsa_group_segment_fixed_size 0
.amdhsa_kernarg_size 88
.amdhsa_user_sgpr_count 2
.amdhsa_user_sgpr_kernarg_segment_ptr 1
.amdhsa_system_sgpr_workgroup_id_x 1
.end_amdhsa_kernel
.text
.globl k45_kernel
.p2align 8
.type k45_kernel,@function
k45_kernel:
    s_cmp_ge_u32 s2, 256
    s_cbranch_scc1 L_end_42
    s_load_dwordx2 s[4:5], s[0:1], 80
    s_load_dwordx2 s[6:7], s[0:1], 0
    s_load_dwordx2 s[54:55], s[0:1], 64
    v_lshrrev_b32 v1, 6, v0
    v_and_b32 v2, 63, v0
    v_readfirstlane_b32 s3, v1
    v_lshlrev_b32 v3, 4, v2
    s_and_b32 s22, s2, 7
    s_lshr_b32 s23, s2, 3
    s_and_b32 s20, s22, 1
    s_lshl_b32 s20, s20, 2
    s_and_b32 s21, s23, 3
    s_add_u32 s20, s20, s21
    s_lshr_b32 s21, s22, 1
    s_lshl_b32 s21, s21, 3
    s_lshr_b32 s23, s23, 2
    s_add_u32 s21, s21, s23
    v_and_b32 v4, 15, v2
    v_lshrrev_b32 v5, 4, v2
    s_waitcnt lgkmcnt(0)
    s_add_u32 s8, s4, 22896640
    s_addc_u32 s9, s5, 0
    s_and_b32 s9, s9, 0xffff
    s_mov_b32 s10, 2359296
    s_mov_b32 s11, 0x20000
    s_add_u32 s12, s4, 4407296
    s_addc_u32 s13, s5, 0
    s_and_b32 s13, s13, 0xffff
    s_mov_b32 s14, 663552
    s_mov_b32 s15, 0x20000
    s_mov_b32 s16, s6
    s_and_b32 s17, s7, 0xffff
    s_mov_b32 s18, 2359296
    s_mov_b32 s19, 0x20000
    s_add_u32 s24, s4, 5070848
    s_addc_u32 s25, s5, 0
    s_and_b32 s25, s25, 0xffff
    s_mov_b32 s26, 5308416
    s_mov_b32 s27, 0x20000
    s_add_u32 s28, s4, 10379264
    s_addc_u32 s29, s5, 0
    s_and_b32 s29, s29, 0xffff
    s_mov_b32 s30, 5308416
    s_mov_b32 s31, 0x20000
    s_add_u32 s32, s4, 28205056
    s_addc_u32 s33, s5, 0
    s_and_b32 s33, s33, 0xffff
    s_mov_b32 s34, 13824
    s_mov_b32 s35, 0x20000
    s_add_u32 s36, s4, 25255936
    s_addc_u32 s37, s5, 0
    s_and_b32 s37, s37, 0xffff
    s_mov_b32 s38, 2359296
    s_mov_b32 s39, 0x20000
    s_add_u32 s40, s4, 27615232
    s_addc_u32 s41, s5, 0
    s_and_b32 s41, s41, 0xffff
    s_mov_b32 s42, 589824
    s_mov_b32 s43, 0x20000
    s_add_u32 s44, s4, 47095808
    s_addc_u32 s45, s5, 0
    s_and_b32 s45, s45, 0xffff
    s_mov_b32 s46, 32768
    s_mov_b32 s47, 0x20000
    v_lshlrev_b32 v7, 4, v0
    s_mov_b32 s60, 6912
    buffer_load_dwordx4 v[60:63], v7, s[32:35], s60 offen
    s_mul_i32 s58, s20, 12
    s_add_u32 s58, s58, s3
    s_mul_i32 s58, s58, 55296
    s_mov_b32 s59, s58
    s_and_b32 s60, s20, 3
    s_mul_i32 s60, s60, 3
    s_add_u32 s60, s60, s3
    s_sub_u32 s61, s60, 12
    s_cmp_ge_u32 s60, 12
    s_cselect_b32 s60, s61, s60
    s_and_b32 s22, s60, 3
    s_lshr_b32 s23, s60, 2
    s_lshl_b32 s60, s21, 6
    s_lshl_b32 s61, s22, 4
    s_add_u32 s60, s60, s61
    s_lshl_b32 s60, s60, 3
    v_mul_u32_u24 v6, 147456, v5
    v_lshl_add_u32 v6, v4, 3, v6
    buffer_load_dwordx2 v[40:41], v6, s[40:43], s60 offen
    s_add_u32 s60, s60, 16384
    buffer_load_dwordx2 v[42:43], v6, s[40:43], s60 offen
    s_add_u32 s60, s60, 16384
    buffer_load_dwordx2 v[44:45], v6, s[40:43], s60 offen
    s_add_u32 s60, s60, 16384
    buffer_load_dwordx2 v[46:47], v6, s[40:43], s60 offen
    s_add_u32 s60, s60, 16384
    buffer_load_dwordx2 v[48:49], v6, s[40:43], s60 offen
    s_add_u32 s60, s60, 16384
    buffer_load_dwordx2 v[50:51], v6, s[40:43], s60 offen
    s_add_u32 s60, s60, 16384
    buffer_load_dwordx2 v[52:53], v6, s[40:43], s60 offen
    s_add_u32 s60, s60, 16384
    buffer_load_dwordx2 v[54:55], v6, s[40:43], s60 offen
    s_add_u32 s60, s60, 16384
    buffer_load_dwordx2 v[56:57], v6, s[40:43], s60 offen
    s_lshl_b32 s60, s21, 2
    s_add_u32 s60, s60, s22
    s_mul_i32 s60, s60, 18
    s_mul_i32 s61, s23, 6
    s_add_u32 s60, s60, s61
    s_lshl_b32 s60, s60, 10
    s_add_u32 s61, s60, 4096
    buffer_load_dwordx4 v[16:19], v3, s[36:39], s60 offen offset:0
    buffer_load_dwordx4 v[20:23], v3, s[36:39], s60 offen offset:1024
    buffer_load_dwordx4 v[24:27], v3, s[36:39], s60 offen offset:2048
    buffer_load_dwordx4 v[28:31], v3, s[36:39], s60 offen offset:3072
    buffer_load_dwordx4 v[32:35], v3, s[36:39], s61 offen offset:0
    buffer_load_dwordx4 v[36:39], v3, s[36:39], s61 offen offset:1024
    v_lshlrev_b32 v7, 5, v5
    s_mul_i32 s60, s23, 768
    s_add_u32 s60, s60, 147456
    v_add_u32 v7, s60, v7
    s_mul_i32 s60, s22, 18
    s_mul_i32 s61, s23, 6
    s_add_u32 s60, s60, s61
    s_lshl_b32 s60, s60, 10
    v_add_u32 v8, s60, v3
    s_waitcnt vmcnt(15)
    v_mov_b32 v58, v7
    v_lshlrev_b32 v7, 4, v0
    v_cmp_le_u32 vcc, 144, v0
    v_mov_b32 v15, 0
    v_add_u32 v7, 147456, v7
    v_cndmask_b32 v15, v15, 1.0, vcc
    v_add_f32 v60, v60, v15
    v_add_f32 v61, v61, v15
    v_add_f32 v62, v62, v15
    v_add_f32 v63, v63, v15
    v_cmp_gt_u32 vcc, 288, v0
    s_and_saveexec_b64 s[62:63], vcc
    ds_write_b128 v7, v[60:63]
    s_mov_b64 exec, s[62:63]
    v_mov_b32 v12, 152064
    v_mov_b32 v13, 0
    ds_write_b32 v12, v13
    ds_write_b32 v12, v13 offset:4
    ds_write_b32 v12, v13 offset:8
    v_mov_b32 v7, v58
    s_waitcnt lgkmcnt(0)
    s_barrier
    ds_read_b128 v[136:139], v7 offset:0
    ds_read_b128 v[140:143], v7 offset:16
    ds_read_b128 v[144:147], v7 offset:2304
    ds_read_b128 v[148:151], v7 offset:2320
    s_waitcnt vmcnt(6)
    v_add_f32 v40, v40, v42
    v_add_f32 v41, v41, v43
    v_add_f32 v40, v40, v44
    v_add_f32 v41, v41, v45
    v_add_f32 v40, v40, v46
    v_add_f32 v41, v41, v47
    v_add_f32 v40, v40, v48
    v_add_f32 v41, v41, v49
    v_add_f32 v40, v40, v50
    v_add_f32 v41, v41, v51
    v_add_f32 v40, v40, v52
    v_add_f32 v41, v41, v53
    v_add_f32 v40, v40, v54
    v_add_f32 v41, v41, v55
    v_add_f32 v40, v40, v56
    v_add_f32 v41, v41, v57
    v_mov_b32 v12, v40
    s_nop 1
    v_permlane16_swap_b32 v40, v12
    s_nop 1
    v_add_f32 v40, v40, v12
    v_mov_b32 v12, v40
    s_nop 1
    v_permlane32_swap_b32 v40, v12
    s_nop 1
    v_add_f32 v40, v40, v12
    v_mov_b32 v12, v41
    s_nop 1
    v_permlane16_swap_b32 v41, v12
    s_nop 1
    v_add_f32 v41, v41, v12
    v_mov_b32 v12, v41
    s_nop 1
    v_permlane32_swap_b32 v41, v12
    s_nop 1
    v_add_f32 v41, v41, v12
    s_mov_b32 s60, 0x3ae38e39
    v_mul_f32 v12, s60, v40
    v_mul_f32 v13, s60, v41
    v_fma_f32 v13, -v12, v12, v13
    v_max_f32 v13, 0, v13
    v_add_f32 v13, 0x3727c5ac, v13
    v_rsq_f32 v13, v13
    s_nop 0
    v_mul_f32 v14, v12, v13
    v_sub_f32 v14, 0, v14
    ds_read_b128 v[152:155], v7 offset:128
    ds_read_b128 v[156:159], v7 offset:144
    ds_read_b128 v[160:163], v7 offset:2432
    ds_read_b128 v[164:167], v7 offset:2448
    buffer_load_dwordx4 v[64:67], v3, s[24:27], s58 offen offset:0
    buffer_load_dwordx4 v[68:71], v3, s[24:27], s58 offen offset:1024
    s_waitcnt vmcnt(7)
    v_lshlrev_b32 v40, 16, v16
    v_and_b32 v41, 0xffff0000, v16
    v_lshlrev_b32 v42, 16, v17
    v_and_b32 v43, 0xffff0000, v17
    v_lshlrev_b32 v44, 16, v18
    v_and_b32 v45, 0xffff0000, v18
    v_lshlrev_b32 v46, 16, v19
    v_and_b32 v47, 0xffff0000, v19
    v_fma_f32 v40, v40, v13, v14
    v_fma_f32 v41, v41, v13, v14
    v_fma_f32 v42, v42, v13, v14
    v_fma_f32 v43, v43, v13, v14
    v_fma_f32 v44, v44, v13, v14
    v_fma_f32 v45, v45, v13, v14
    v_fma_f32 v46, v46, v13, v14
    v_fma_f32 v47, v47, v13, v14
    s_waitcnt lgkmcnt(4)
    v_pk_fma_f32 v[40:41], v[40:41], v[144:145], v[136:137]
    v_pk_fma_f32 v[42:43], v[42:43], v[146:147], v[138:139]
    v_pk_fma_f32 v[44:45], v[44:45], v[148:149], v[140:141]
    v_pk_fma_f32 v[46:47], v[46:47], v[150:151], v[142:143]
    v_cvt_pk_bf16_f32 v16, v40, v41
    v_cvt_pk_bf16_f32 v17, v42, v43
    v_cvt_pk_bf16_f32 v18, v44, v45
    v_cvt_pk_bf16_f32 v19, v46, v47
    ds_write_b128 v8, v[16:19] offset:0
    ds_read_b128 v[136:139], v7 offset:256
    ds_read_b128 v[140:143], v7 offset:272
    ds_read_b128 v[144:147], v7 offset:2560
    ds_read_b128 v[148:151], v7 offset:2576
    buffer_load_dwordx4 v[72:75], v3, s[24:27], s58 offen offset:2048
    s_add_u32 s58, s58, 3072
    buffer_load_dwordx4 v[76:79], v3, s[24:27], s58 offen offset:0
    s_waitcnt vmcnt(8)
    v_lshlrev_b32 v40, 16, v20
    v_and_b32 v41, 0xffff0000, v20
    v_lshlrev_b32 v42, 16, v21
    v_and_b32 v43, 0xffff0000, v21
    v_lshlrev_b32 v44, 16, v22
    v_and_b32 v45, 0xffff0000, v22
    v_lshlrev_b32 v46, 16, v23
    v_and_b32 v47, 0xffff0000, v23
    v_fma_f32 v40, v40, v13, v14
    v_fma_f32 v41, v41, v13, v14
    v_fma_f32 v42, v42, v13, v14
    v_fma_f32 v43, v43, v13, v14
    v_fma_f32 v44, v44, v13, v14
    v_fma_f32 v45, v45, v13, v14
    v_fma_f32 v46, v46, v13, v14
    v_fma_f32 v47, v47, v13, v14
    s_waitcnt lgkmcnt(4)
    v_pk_fma_f32 v[40:41], v[40:41], v[160:161], v[152:153]
    v_pk_fma_f32 v[42:43], v[42:43], v[162:163], v[154:155]
    v_pk_fma_f32 v[44:45], v[44:45], v[164:165], v[156:157]
    v_pk_fma_f32 v[46:47], v[46:47], v[166:167], v[158:159]
    v_cvt_pk_bf16_f32 v20, v40, v41
    v_cvt_pk_bf16_f32 v21, v42, v43
    v_cvt_pk_bf16_f32 v22, v44, v45
    v_cvt_pk_bf16_f32 v23, v46, v47
    ds_write_b128 v8, v[20:23] offset:1024
    ds_read_b128 v[152:155], v7 offset:384
    ds_read_b128 v[156:159], v7 offset:400
    ds_read_b128 v[160:163], v7 offset:2688
    ds_read_b128 v[164:167], v7 offset:2704
    buffer_load_dwordx4 v[80:83], v3, s[24:27], s58 offen offset:1024
    buffer_load_dwordx4 v[84:87], v3, s[24:27], s58 offen offset:2048
    s_add_u32 s58, s58, 3072
    s_waitcnt vmcnt(9)
    v_lshlrev_b32 v40, 16, v24
    v_and_b32 v41, 0xffff0000, v24
    v_lshlrev_b32 v42, 16, v25
    v_and_b32 v43, 0xffff0000, v25
    v_lshlrev_b32 v44, 16, v26
    v_and_b32 v45, 0xffff0000, v26
    v_lshlrev_b32 v46, 16, v27
    v_and_b32 v47, 0xffff0000, v27
    v_fma_f32 v40, v40, v13, v14
    v_fma_f32 v41, v41, v13, v14
    v_fma_f32 v42, v42, v13, v14
    v_fma_f32 v43, v43, v13, v14
    v_fma_f32 v44, v44, v13, v14
    v_fma_f32 v45, v45, v13, v14
    v_fma_f32 v46, v46, v13, v14
    v_fma_f32 v47, v47, v13, v14
    s_waitcnt lgkmcnt(4)
    v_pk_fma_f32 v[40:41], v[40:41], v[144:145], v[136:137]
    v_pk_fma_f32 v[42:43], v[42:43], v[146:147], v[138:139]
    v_pk_fma_f32 v[44:45], v[44:45], v[148:149], v[140:141]
    v_pk_fma_f32 v[46:47], v[46:47], v[150:151], v[142:143]
    v_cvt_pk_bf16_f32 v24, v40, v41
    v_cvt_pk_bf16_f32 v25, v42, v43
    v_cvt_pk_bf16_f32 v26, v44, v45
    v_cvt_pk_bf16_f32 v27, v46, v47
    ds_write_b128 v8, v[24:27] offset:2048
    ds_read_b128 v[136:139], v7 offset:512
    ds_read_b128 v[140:143], v7 offset:528
    ds_read_b128 v[144:147], v7 offset:2816
    ds_read_b128 v[148:151], v7 offset:2832
    buffer_load_dwordx4 v[88:91], v3, s[24:27], s58 offen offset:0
    buffer_load_dwordx4 v[92:95], v3, s[24:27], s58 offen offset:1024
    s_waitcnt vmcnt(10)
    v_lshlrev_b32 v40, 16, v28
    v_and_b32 v41, 0xffff0000, v28
    v_lshlrev_b32 v42, 16, v29
    v_and_b32 v43, 0xffff0000, v29
    v_lshlrev_b32 v44, 16, v30
    v_and_b32 v45, 0xffff0000, v30
    v_lshlrev_b32 v46, 16, v31
    v_and_b32 v47, 0xffff0000, v31
    v_fma_f32 v40, v40, v13, v14
    v_fma_f32 v41, v41, v13, v14
    v_fma_f32 v42, v42, v13, v14
    v_fma_f32 v43, v43, v13, v14
    v_fma_f32 v44, v44, v13, v14
    v_fma_f32 v45, v45, v13, v14
    v_fma_f32 v46, v46, v13, v14
    v_fma_f32 v47, v47, v13, v14
    s_waitcnt lgkmcnt(4)
    v_pk_fma_f32 v[40:41], v[40:41], v[160:161], v[152:153]
    v_pk_fma_f32 v[42:43], v[42:43], v[162:163], v[154:155]
    v_pk_fma_f32 v[44:45], v[44:45], v[164:165], v[156:157]
    v_pk_fma_f32 v[46:47], v[46:47], v[166:167], v[158:159]
    v_cvt_pk_bf16_f32 v28, v40, v41
    v_cvt_pk_bf16_f32 v29, v42, v43
    v_cvt_pk_bf16_f32 v30, v44, v45
    v_cvt_pk_bf16_f32 v31, v46, v47
    ds_write_b128 v8, v[28:31] offset:3072
    ds_read_b128 v[152:155], v7 offset:640
    ds_read_b128 v[156:159], v7 offset:656
    ds_read_b128 v[160:163], v7 offset:2944
    ds_read_b128 v[164:167], v7 offset:2960
    buffer_load_dwordx4 v[96:99], v3, s[24:27], s58 offen offset:2048
    s_add_u32 s58, s58, 3072
    s_waitcnt vmcnt(10)
    v_lshlrev_b32 v40, 16, v32
    v_and_b32 v41, 0xffff0000, v32
    v_lshlrev_b32 v42, 16, v33
    v_and_b32 v43, 0xffff0000, v33
    v_lshlrev_b32 v44, 16, v34
    v_and_b32 v45, 0xffff0000, v34
    v_lshlrev_b32 v46, 16, v35
    v_and_b32 v47, 0xffff0000, v35
    v_fma_f32 v40, v40, v13, v14
    v_fma_f32 v41, v41, v13, v14
    v_fma_f32 v42, v42, v13, v14
    v_fma_f32 v43, v43, v13, v14
    v_fma_f32 v44, v44, v13, v14
    v_fma_f32 v45, v45, v13, v14
    v_fma_f32 v46, v46, v13, v14
    v_fma_f32 v47, v47, v13, v14
    s_waitcnt lgkmcnt(4)
    v_pk_fma_f32 v[40:41], v[40:41], v[144:145], v[136:137]
    v_pk_fma_f32 v[42:43], v[42:43], v[146:147], v[138:139]
    v_pk_fma_f32 v[44:45], v[44:45], v[148:149], v[140:141]
    v_pk_fma_f32 v[46:47], v[46:47], v[150:151], v[142:143]
    v_cvt_pk_bf16_f32 v32, v40, v41
    v_cvt_pk_bf16_f32 v33, v42, v43
    v_cvt_pk_bf16_f32 v34, v44, v45
    v_cvt_pk_bf16_f32 v35, v46, v47
    ds_write_b128 v8, v[32:35] offset:4096
    s_waitcnt vmcnt(9)
    v_lshlrev_b32 v40, 16, v36
    v_and_b32 v41, 0xffff0000, v36
    v_lshlrev_b32 v42, 16, v37
    v_and_b32 v43, 0xffff0000, v37
    v_lshlrev_b32 v44, 16, v38
    v_and_b32 v45, 0xffff0000, v38
    v_lshlrev_b32 v46, 16, v39
    v_and_b32 v47, 0xffff0000, v39
    v_fma_f32 v40, v40, v13, v14
    v_fma_f32 v41, v41, v13, v14
    v_fma_f32 v42, v42, v13, v14
    v_fma_f32 v43, v43, v13, v14
    v_fma_f32 v44, v44, v13, v14
    v_fma_f32 v45, v45, v13, v14
    v_fma_f32 v46, v46, v13, v14
    v_fma_f32 v47, v47, v13, v14
    s_waitcnt lgkmcnt(0)
    v_pk_fma_f32 v[40:41], v[40:41], v[160:161], v[152:153]
    v_pk_fma_f32 v[42:43], v[42:43], v[162:163], v[154:155]
    v_pk_fma_f32 v[44:45], v[44:45], v[164:165], v[156:157]
    v_pk_fma_f32 v[46:47], v[46:47], v[166:167], v[158:159]
    v_cvt_pk_bf16_f32 v36, v40, v41
    v_cvt_pk_bf16_f32 v37, v42, v43
    v_cvt_pk_bf16_f32 v38, v44, v45
    v_cvt_pk_bf16_f32 v39, v46, v47
    ds_write_b128 v8, v[36:39] offset:5120
    s_waitcnt lgkmcnt(0)
    s_barrier
    v_add_u32 v9, 0, v3
    v_add_u32 v11, 36864, v3
    v_mov_b32 v16, 0
    v_mov_b32 v17, 0
    v_mov_b32 v18, 0
    v_mov_b32 v19, 0
    v_mov_b32 v20, 0
    v_mov_b32 v21, 0
    v_mov_b32 v22, 0
    v_mov_b32 v23, 0
    v_mov_b32 v24, 0
    v_mov_b32 v25, 0
    v_mov_b32 v26, 0
    v_mov_b32 v27, 0
    v_mov_b32 v28, 0
    v_mov_b32 v29, 0
    v_mov_b32 v30, 0
    v_mov_b32 v31, 0
    v_mov_b32 v32, 0
    v_mov_b32 v33, 0
    v_mov_b32 v34, 0
    v_mov_b32 v35, 0
    v_mov_b32 v36, 0
    v_mov_b32 v37, 0
    v_mov_b32 v38, 0
    v_mov_b32 v39, 0
    v_mov_b32 v40, 0
    v_mov_b32 v41, 0
    v_mov_b32 v42, 0
    v_mov_b32 v43, 0
    v_mov_b32 v44, 0
    v_mov_b32 v45, 0
    v_mov_b32 v46, 0
    v_mov_b32 v47, 0
    v_mov_b32 v48, 0
    v_mov_b32 v49, 0
    v_mov_b32 v50, 0
    v_mov_b32 v51, 0
    v_mov_b32 v52, 0
    v_mov_b32 v53, 0
    v_mov_b32 v54, 0
    v_mov_b32 v55, 0
    v_mov_b32 v56, 0
    v_mov_b32 v57, 0
    v_mov_b32 v58, 0
    v_mov_b32 v59, 0
    v_mov_b32 v60, 0
    v_mov_b32 v61, 0
    v_mov_b32 v62, 0
    v_mov_b32 v63, 0
    ds_read_b128 v[136:139], v9 offset:0
    ds_read_b128 v[140:143], v9 offset:18432
    ds_read_b128 v[144:147], v11 offset:0
    ds_read_b128 v[148:151], v11 offset:18432
    buffer_load_dwordx4 v[100:103], v3, s[24:27], s58 offen offset:0
    buffer_load_dwordx4 v[104:107], v3, s[24:27], s58 offen offset:1024
    buffer_load_dwordx4 v[108:111], v3, s[24:27], s58 offen offset:2048
    s_add_u32 s58, s58, 3072
    ds_read_b128 v[152:155], v9 offset:1024
    ds_read_b128 v[156:159], v9 offset:19456
    ds_read_b128 v[160:163], v11 offset:1024
    ds_read_b128 v[164:167], v11 offset:19456
    s_waitcnt vmcnt(9) lgkmcnt(4)
    v_mfma_f32_16x16x32_bf16 v[16:19], v[64:67], v[136:139], v[16:19]
    v_mfma_f32_16x16x32_bf16 v[32:35], v[68:71], v[136:139], v[32:35]
    v_mfma_f32_16x16x32_bf16 v[48:51], v[72:75], v[136:139], v[48:51]
    v_mfma_f32_16x16x32_bf16 v[20:23], v[64:67], v[140:143], v[20:23]
    v_mfma_f32_16x16x32_bf16 v[36:39], v[68:71], v[140:143], v[36:39]
    v_mfma_f32_16x16x32_bf16 v[52:55], v[72:75], v[140:143], v[52:55]
    v_mfma_f32_16x16x32_bf16 v[24:27], v[64:67], v[144:147], v[24:27]
    v_mfma_f32_16x16x32_bf16 v[40:43], v[68:71], v[144:147], v[40:43]
    v_mfma_f32_16x16x32_bf16 v[56:59], v[72:75], v[144:147], v[56:59]
    v_mfma_f32_16x16x32_bf16 v[28:31], v[64:67], v[148:151], v[28:31]
    v_mfma_f32_16x16x32_bf16 v[44:47], v[68:71], v[148:151], v[44:47]
    v_mfma_f32_16x16x32_bf16 v[60:63], v[72:75], v[148:151], v[60:63]
    buffer_load_dwordx4 v[112:115], v3, s[24:27], s58 offen offset:0
    buffer_load_dwordx4 v[116:119], v3, s[24:27], s58 offen offset:1024
    buffer_load_dwordx4 v[120:123], v3, s[24:27], s58 offen offset:2048
    s_add_u32 s58, s58, 3072
    ds_read_b128 v[136:139], v9 offset:2048
    ds_read_b128 v[140:143], v9 offset:20480
    ds_read_b128 v[144:147], v11 offset:2048
    ds_read_b128 v[148:151], v11 offset:20480
    s_waitcnt vmcnt(9) lgkmcnt(4)
    v_mfma_f32_16x16x32_bf16 v[16:19], v[76:79], v[152:155], v[16:19]
    v_mfma_f32_16x16x32_bf16 v[32:35], v[80:83], v[152:155], v[32:35]
    v_mfma_f32_16x16x32_bf16 v[48:51], v[84:87], v[152:155], v[48:51]
    v_mfma_f32_16x16x32_bf16 v[20:23], v[76:79], v[156:159], v[20:23]
    v_mfma_f32_16x16x32_bf16 v[36:39], v[80:83], v[156:159], v[36:39]
    v_mfma_f32_16x16x32_bf16 v[52:55], v[84:87], v[156:159], v[52:55]
    v_mfma_f32_16x16x32_bf16 v[24:27], v[76:79], v[160:163], v[24:27]
    v_mfma_f32_16x16x32_bf16 v[40:43], v[80:83], v[160:163], v[40:43]
    v_mfma_f32_16x16x32_bf16 v[56:59], v[84:87], v[160:163], v[56:59]
    v_mfma_f32_16x16x32_bf16 v[28:31], v[76:79], v[164:167], v[28:31]
    v_mfma_f32_16x16x32_bf16 v[44:47], v[80:83], v[164:167], v[44:47]
    v_mfma_f32_16x16x32_bf16 v[60:63], v[84:87], v[164:167], v[60:63]
    buffer_load_dwordx4 v[124:127], v3, s[24:27], s58 offen offset:0
    buffer_load_dwordx4 v[128:131], v3, s[24:27], s58 offen offset:1024
    buffer_load_dwordx4 v[132:135], v3, s[24:27], s58 offen offset:2048
    s_add_u32 s58, s58, 3072
    ds_read_b128 v[152:155], v9 offset:3072
    ds_read_b128 v[156:159], v9 offset:21504
    ds_read_b128 v[160:163], v11 offset:3072
    ds_read_b128 v[164:167], v11 offset:21504
    s_waitcnt vmcnt(9) lgkmcnt(4)
    v_mfma_f32_16x16x32_bf16 v[16:19], v[88:91], v[136:139], v[16:19]
    v_mfma_f32_16x16x32_bf16 v[32:35], v[92:95], v[136:139], v[32:35]
    v_mfma_f32_16x16x32_bf16 v[48:51], v[96:99], v[136:139], v[48:51]
    v_mfma_f32_16x16x32_bf16 v[20:23], v[88:91], v[140:143], v[20:23]
    v_mfma_f32_16x16x32_bf16 v[36:39], v[92:95], v[140:143], v[36:39]
    v_mfma_f32_16x16x32_bf16 v[52:55], v[96:99], v[140:143], v[52:55]
    v_mfma_f32_16x16x32_bf16 v[24:27], v[88:91], v[144:147], v[24:27]
    v_mfma_f32_16x16x32_bf16 v[40:43], v[92:95], v[144:147], v[40:43]
    v_mfma_f32_16x16x32_bf16 v[56:59], v[96:99], v[144:147], v[56:59]
    v_mfma_f32_16x16x32_bf16 v[28:31], v[88:91], v[148:151], v[28:31]
    v_mfma_f32_16x16x32_bf16 v[44:47], v[92:95], v[148:151], v[44:47]
    v_mfma_f32_16x16x32_bf16 v[60:63], v[96:99], v[148:151], v[60:63]
    buffer_load_dwordx4 v[64:67], v3, s[24:27], s58 offen offset:0
    buffer_load_dwordx4 v[68:71], v3, s[24:27], s58 offen offset:1024
    buffer_load_dwordx4 v[72:75], v3, s[24:27], s58 offen offset:2048
    s_add_u32 s58, s58, 3072
    ds_read_b128 v[136:139], v9 offset:4096
    ds_read_b128 v[140:143], v9 offset:22528
    ds_read_b128 v[144:147], v11 offset:4096
    ds_read_b128 v[148:151], v11 offset:22528
    s_waitcnt vmcnt(9) lgkmcnt(4)
    v_mfma_f32_16x16x32_bf16 v[16:19], v[100:103], v[152:155], v[16:19]
    v_mfma_f32_16x16x32_bf16 v[32:35], v[104:107], v[152:155], v[32:35]
    v_mfma_f32_16x16x32_bf16 v[48:51], v[108:111], v[152:155], v[48:51]
    v_mfma_f32_16x16x32_bf16 v[20:23], v[100:103], v[156:159], v[20:23]
    v_mfma_f32_16x16x32_bf16 v[36:39], v[104:107], v[156:159], v[36:39]
    v_mfma_f32_16x16x32_bf16 v[52:55], v[108:111], v[156:159], v[52:55]
    v_mfma_f32_16x16x32_bf16 v[24:27], v[100:103], v[160:163], v[24:27]
    v_mfma_f32_16x16x32_bf16 v[40:43], v[104:107], v[160:163], v[40:43]
    v_mfma_f32_16x16x32_bf16 v[56:59], v[108:111], v[160:163], v[56:59]
    v_mfma_f32_16x16x32_bf16 v[28:31], v[100:103], v[164:167], v[28:31]
    v_mfma_f32_16x16x32_bf16 v[44:47], v[104:107], v[164:167], v[44:47]
    v_mfma_f32_16x16x32_bf16 v[60:63], v[108:111], v[164:167], v[60:63]
    buffer_load_dwordx4 v[76:79], v3, s[24:27], s58 offen offset:0
    buffer_load_dwordx4 v[80:83], v3, s[24:27], s58 offen offset:1024
    buffer_load_dwordx4 v[84:87], v3, s[24:27], s58 offen offset:2048
    s_add_u32 s58, s58, 3072
    ds_read_b128 v[152:155], v9 offset:5120
    ds_read_b128 v[156:159], v9 offset:23552
    ds_read_b128 v[160:163], v11 offset:5120
    ds_read_b128 v[164:167], v11 offset:23552
    s_waitcnt vmcnt(9) lgkmcnt(4)
    v_mfma_f32_16x16x32_bf16 v[16:19], v[112:115], v[136:139], v[16:19]
    v_mfma_f32_16x16x32_bf16 v[32:35], v[116:119], v[136:139], v[32:35]
    v_mfma_f32_16x16x32_bf16 v[48:51], v[120:123], v[136:139], v[48:51]
    v_mfma_f32_16x16x32_bf16 v[20:23], v[112:115], v[140:143], v[20:23]
    v_mfma_f32_16x16x32_bf16 v[36:39], v[116:119], v[140:143], v[36:39]
    v_mfma_f32_16x16x32_bf16 v[52:55], v[120:123], v[140:143], v[52:55]
    v_mfma_f32_16x16x32_bf16 v[24:27], v[112:115], v[144:147], v[24:27]
    v_mfma_f32_16x16x32_bf16 v[40:43], v[116:119], v[144:147], v[40:43]
    v_mfma_f32_16x16x32_bf16 v[56:59], v[120:123], v[144:147], v[56:59]
    v_mfma_f32_16x16x32_bf16 v[28:31], v[112:115], v[148:151], v[28:31]
    v_mfma_f32_16x16x32_bf16 v[44:47], v[116:119], v[148:151], v[44:47]
    v_mfma_f32_16x16x32_bf16 v[60:63], v[120:123], v[148:151], v[60:63]
    buffer_load_dwordx4 v[88:91], v3, s[24:27], s58 offen offset:0
    buffer_load_dwordx4 v[92:95], v3, s[24:27], s58 offen offset:1024
    buffer_load_dwordx4 v[96:99], v3, s[24:27], s58 offen offset:2048
    s_add_u32 s58, s58, 3072
    ds_read_b128 v[136:139], v9 offset:6144
    ds_read_b128 v[140:143], v9 offset:24576
    ds_read_b128 v[144:147], v11 offset:6144
    ds_read_b128 v[148:151], v11 offset:24576
    s_waitcnt vmcnt(9) lgkmcnt(4)
    v_mfma_f32_16x16x32_bf16 v[16:19], v[124:127], v[152:155], v[16:19]
    v_mfma_f32_16x16x32_bf16 v[32:35], v[128:131], v[152:155], v[32:35]
    v_mfma_f32_16x16x32_bf16 v[48:51], v[132:135], v[152:155], v[48:51]
    v_mfma_f32_16x16x32_bf16 v[20:23], v[124:127], v[156:159], v[20:23]
    v_mfma_f32_16x16x32_bf16 v[36:39], v[128:131], v[156:159], v[36:39]
    v_mfma_f32_16x16x32_bf16 v[52:55], v[132:135], v[156:159], v[52:55]
    v_mfma_f32_16x16x32_bf16 v[24:27], v[124:127], v[160:163], v[24:27]
    v_mfma_f32_16x16x32_bf16 v[40:43], v[128:131], v[160:163], v[40:43]
    v_mfma_f32_16x16x32_bf16 v[56:59], v[132:135], v[160:163], v[56:59]
    v_mfma_f32_16x16x32_bf16 v[28:31], v[124:127], v[164:167], v[28:31]
    v_mfma_f32_16x16x32_bf16 v[44:47], v[128:131], v[164:167], v[44:47]
    v_mfma_f32_16x16x32_bf16 v[60:63], v[132:135], v[164:167], v[60:63]
    buffer_load_dwordx4 v[100:103], v3, s[24:27], s58 offen offset:0
    buffer_load_dwordx4 v[104:107], v3, s[24:27], s58 offen offset:1024
    buffer_load_dwordx4 v[108:111], v3, s[24:27], s58 offen offset:2048
    s_add_u32 s58, s58, 3072
    ds_read_b128 v[152:155], v9 offset:7168
    ds_read_b128 v[156:159], v9 offset:25600
    ds_read_b128 v[160:163], v11 offset:7168
    ds_read_b128 v[164:167], v11 offset:25600
    s_waitcnt vmcnt(9) lgkmcnt(4)
    v_mfma_f32_16x16x32_bf16 v[16:19], v[64:67], v[136:139], v[16:19]
    v_mfma_f32_16x16x32_bf16 v[32:35], v[68:71], v[136:139], v[32:35]
    v_mfma_f32_16x16x32_bf16 v[48:51], v[72:75], v[136:139], v[48:51]
    v_mfma_f32_16x16x32_bf16 v[20:23], v[64:67], v[140:143], v[20:23]
    v_mfma_f32_16x16x32_bf16 v[36:39], v[68:71], v[140:143], v[36:39]
    v_mfma_f32_16x16x32_bf16 v[52:55], v[72:75], v[140:143], v[52:55]
    v_mfma_f32_16x16x32_bf16 v[24:27], v[64:67], v[144:147], v[24:27]
    v_mfma_f32_16x16x32_bf16 v[40:43], v[68:71], v[144:147], v[40:43]
    v_mfma_f32_16x16x32_bf16 v[56:59], v[72:75], v[144:147], v[56:59]
    v_mfma_f32_16x16x32_bf16 v[28:31], v[64:67], v[148:151], v[28:31]
    v_mfma_f32_16x16x32_bf16 v[44:47], v[68:71], v[148:151], v[44:47]
    v_mfma_f32_16x16x32_bf16 v[60:63], v[72:75], v[148:151], v[60:63]
    buffer_load_dwordx4 v[112:115], v3, s[24:27], s58 offen offset:0
    buffer_load_dwordx4 v[116:119], v3, s[24:27], s58 offen offset:1024
    buffer_load_dwordx4 v[120:123], v3, s[24:27], s58 offen offset:2048
    s_add_u32 s58, s58, 3072
    ds_read_b128 v[136:139], v9 offset:8192
    ds_read_b128 v[140:143], v9 offset:26624
    ds_read_b128 v[144:147], v11 offset:8192
    ds_read_b128 v[148:151], v11 offset:26624
    s_waitcnt vmcnt(9) lgkmcnt(4)
    v_mfma_f32_16x16x32_bf16 v[16:19], v[76:79], v[152:155], v[16:19]
    v_mfma_f32_16x16x32_bf16 v[32:35], v[80:83], v[152:155], v[32:35]
    v_mfma_f32_16x16x32_bf16 v[48:51], v[84:87], v[152:155], v[48:51]
    v_mfma_f32_16x16x32_bf16 v[20:23], v[76:79], v[156:159], v[20:23]
    v_mfma_f32_16x16x32_bf16 v[36:39], v[80:83], v[156:159], v[36:39]
    v_mfma_f32_16x16x32_bf16 v[52:55], v[84:87], v[156:159], v[52:55]
    v_mfma_f32_16x16x32_bf16 v[24:27], v[76:79], v[160:163], v[24:27]
    v_mfma_f32_16x16x32_bf16 v[40:43], v[80:83], v[160:163], v[40:43]
    v_mfma_f32_16x16x32_bf16 v[56:59], v[84:87], v[160:163], v[56:59]
    v_mfma_f32_16x16x32_bf16 v[28:31], v[76:79], v[164:167], v[28:31]
    v_mfma_f32_16x16x32_bf16 v[44:47], v[80:83], v[164:167], v[44:47]
    v_mfma_f32_16x16x32_bf16 v[60:63], v[84:87], v[164:167], v[60:63]
    buffer_load_dwordx4 v[124:127], v3, s[24:27], s58 offen offset:0
    buffer_load_dwordx4 v[128:131], v3, s[24:27], s58 offen offset:1024
    buffer_load_dwordx4 v[132:135], v3, s[24:27], s58 offen offset:2048
    s_add_u32 s58, s58, 3072
    ds_read_b128 v[152:155], v9 offset:9216
    ds_read_b128 v[156:159], v9 offset:27648
    ds_read_b128 v[160:163], v11 offset:9216
    ds_read_b128 v[164:167], v11 offset:27648
    s_waitcnt vmcnt(9) lgkmcnt(4)
    v_mfma_f32_16x16x32_bf16 v[16:19], v[88:91], v[136:139], v[16:19]
    v_mfma_f32_16x16x32_bf16 v[32:35], v[92:95], v[136:139], v[32:35]
    v_mfma_f32_16x16x32_bf16 v[48:51], v[96:99], v[136:139], v[48:51]
    v_mfma_f32_16x16x32_bf16 v[20:23], v[88:91], v[140:143], v[20:23]
    v_mfma_f32_16x16x32_bf16 v[36:39], v[92:95], v[140:143], v[36:39]
    v_mfma_f32_16x16x32_bf16 v[52:55], v[96:99], v[140:143], v[52:55]
    v_mfma_f32_16x16x32_bf16 v[24:27], v[88:91], v[144:147], v[24:27]
    v_mfma_f32_16x16x32_bf16 v[40:43], v[92:95], v[144:147], v[40:43]
    v_mfma_f32_16x16x32_bf16 v[56:59], v[96:99], v[144:147], v[56:59]
    v_mfma_f32_16x16x32_bf16 v[28:31], v[88:91], v[148:151], v[28:31]
    v_mfma_f32_16x16x32_bf16 v[44:47], v[92:95], v[148:151], v[44:47]
    v_mfma_f32_16x16x32_bf16 v[60:63], v[96:99], v[148:151], v[60:63]
    buffer_load_dwordx4 v[64:67], v3, s[24:27], s58 offen offset:0
    buffer_load_dwordx4 v[68:71], v3, s[24:27], s58 offen offset:1024
    buffer_load_dwordx4 v[72:75], v3, s[24:27], s58 offen offset:2048
    s_add_u32 s58, s58, 3072
    ds_read_b128 v[136:139], v9 offset:10240
    ds_read_b128 v[140:143], v9 offset:28672
    ds_read_b128 v[144:147], v11 offset:10240
    ds_read_b128 v[148:151], v11 offset:28672
    s_waitcnt vmcnt(9) lgkmcnt(4)
    v_mfma_f32_16x16x32_bf16 v[16:19], v[100:103], v[152:155], v[16:19]
    v_mfma_f32_16x16x32_bf16 v[32:35], v[104:107], v[152:155], v[32:35]
    v_mfma_f32_16x16x32_bf16 v[48:51], v[108:111], v[152:155], v[48:51]
    v_mfma_f32_16x16x32_bf16 v[20:23], v[100:103], v[156:159], v[20:23]
    v_mfma_f32_16x16x32_bf16 v[36:39], v[104:107], v[156:159], v[36:39]
    v_mfma_f32_16x16x32_bf16 v[52:55], v[108:111], v[156:159], v[52:55]
    v_mfma_f32_16x16x32_bf16 v[24:27], v[100:103], v[160:163], v[24:27]
    v_mfma_f32_16x16x32_bf16 v[40:43], v[104:107], v[160:163], v[40:43]
    v_mfma_f32_16x16x32_bf16 v[56:59], v[108:111], v[160:163], v[56:59]
    v_mfma_f32_16x16x32_bf16 v[28:31], v[100:103], v[164:167], v[28:31]
    v_mfma_f32_16x16x32_bf16 v[44:47], v[104:107], v[164:167], v[44:47]
    v_mfma_f32_16x16x32_bf16 v[60:63], v[108:111], v[164:167], v[60:63]
    buffer_load_dwordx4 v[76:79], v3, s[24:27], s58 offen offset:0
    buffer_load_dwordx4 v[80:83], v3, s[24:27], s58 offen offset:1024
    buffer_load_dwordx4 v[84:87], v3, s[24:27], s58 offen offset:2048
    s_add_u32 s58, s58, 3072
    ds_read_b128 v[152:155], v9 offset:11264
    ds_read_b128 v[156:159], v9 offset:29696
    ds_read_b128 v[160:163], v11 offset:11264
    ds_read_b128 v[164:167], v11 offset:29696
    s_waitcnt vmcnt(9) lgkmcnt(4)
    v_mfma_f32_16x16x32_bf16 v[16:19], v[112:115], v[136:139], v[16:19]
    v_mfma_f32_16x16x32_bf16 v[32:35], v[116:119], v[136:139], v[32:35]
    v_mfma_f32_16x16x32_bf16 v[48:51], v[120:123], v[136:139], v[48:51]
    v_mfma_f32_16x16x32_bf16 v[20:23], v[112:115], v[140:143], v[20:23]
    v_mfma_f32_16x16x32_bf16 v[36:39], v[116:119], v[140:143], v[36:39]
    v_mfma_f32_16x16x32_bf16 v[52:55], v[120:123], v[140:143], v[52:55]
    v_mfma_f32_16x16x32_bf16 v[24:27], v[112:115], v[144:147], v[24:27]
    v_mfma_f32_16x16x32_bf16 v[40:43], v[116:119], v[144:147], v[40:43]
    v_mfma_f32_16x16x32_bf16 v[56:59], v[120:123], v[144:147], v[56:59]
    v_mfma_f32_16x16x32_bf16 v[28:31], v[112:115], v[148:151], v[28:31]
    v_mfma_f32_16x16x32_bf16 v[44:47], v[116:119], v[148:151], v[44:47]
    v_mfma_f32_16x16x32_bf16 v[60:63], v[120:123], v[148:151], v[60:63]
    buffer_load_dwordx4 v[88:91], v3, s[24:27], s58 offen offset:0
    buffer_load_dwordx4 v[92:95], v3, s[24:27], s58 offen offset:1024
    buffer_load_dwordx4 v[96:99], v3, s[24:27], s58 offen offset:2048
    s_add_u32 s58, s58, 3072
    ds_read_b128 v[136:139], v9 offset:12288
    ds_read_b128 v[140:143], v9 offset:30720
    ds_read_b128 v[144:147], v11 offset:12288
    ds_read_b128 v[148:151], v11 offset:30720
    s_waitcnt vmcnt(9) lgkmcnt(4)
    v_mfma_f32_16x16x32_bf16 v[16:19], v[124:127], v[152:155], v[16:19]
    v_mfma_f32_16x16x32_bf16 v[32:35], v[128:131], v[152:155], v[32:35]
    v_mfma_f32_16x16x32_bf16 v[48:51], v[132:135], v[152:155], v[48:51]
    v_mfma_f32_16x16x32_bf16 v[20:23], v[124:127], v[156:159], v[20:23]
    v_mfma_f32_16x16x32_bf16 v[36:39], v[128:131], v[156:159], v[36:39]
    v_mfma_f32_16x16x32_bf16 v[52:55], v[132:135], v[156:159], v[52:55]
    v_mfma_f32_16x16x32_bf16 v[24:27], v[124:127], v[160:163], v[24:27]
    v_mfma_f32_16x16x32_bf16 v[40:43], v[128:131], v[160:163], v[40:43]
    v_mfma_f32_16x16x32_bf16 v[56:59], v[132:135], v[160:163], v[56:59]
    v_mfma_f32_16x16x32_bf16 v[28:31], v[124:127], v[164:167], v[28:31]
    v_mfma_f32_16x16x32_bf16 v[44:47], v[128:131], v[164:167], v[44:47]
    v_mfma_f32_16x16x32_bf16 v[60:63], v[132:135], v[164:167], v[60:63]
    buffer_load_dwordx4 v[100:103], v3, s[24:27], s58 offen offset:0
    buffer_load_dwordx4 v[104:107], v3, s[24:27], s58 offen offset:1024
    buffer_load_dwordx4 v[108:111], v3, s[24:27], s58 offen offset:2048
    s_add_u32 s58, s58, 3072
    ds_read_b128 v[152:155], v9 offset:13312
    ds_read_b128 v[156:159], v9 offset:31744
    ds_read_b128 v[160:163], v11 offset:13312
    ds_read_b128 v[164:167], v11 offset:31744
    s_waitcnt vmcnt(9) lgkmcnt(4)
    v_mfma_f32_16x16x32_bf16 v[16:19], v[64:67], v[136:139], v[16:19]
    v_mfma_f32_16x16x32_bf16 v[32:35], v[68:71], v[136:139], v[32:35]
    v_mfma_f32_16x16x32_bf16 v[48:51], v[72:75], v[136:139], v[48:51]
    v_mfma_f32_16x16x32_bf16 v[20:23], v[64:67], v[140:143], v[20:23]
    v_mfma_f32_16x16x32_bf16 v[36:39], v[68:71], v[140:143], v[36:39]
    v_mfma_f32_16x16x32_bf16 v[52:55], v[72:75], v[140:143], v[52:55]
    v_mfma_f32_16x16x32_bf16 v[24:27], v[64:67], v[144:147], v[24:27]
    v_mfma_f32_16x16x32_bf16 v[40:43], v[68:71], v[144:147], v[40:43]
    v_mfma_f32_16x16x32_bf16 v[56:59], v[72:75], v[144:147], v[56:59]
    v_mfma_f32_16x16x32_bf16 v[28:31], v[64:67], v[148:151], v[28:31]
    v_mfma_f32_16x16x32_bf16 v[44:47], v[68:71], v[148:151], v[44:47]
    v_mfma_f32_16x16x32_bf16 v[60:63], v[72:75], v[148:151], v[60:63]
    buffer_load_dwordx4 v[112:115], v3, s[24:27], s58 offen offset:0
    buffer_load_dwordx4 v[116:119], v3, s[24:27], s58 offen offset:1024
    buffer_load_dwordx4 v[120:123], v3, s[24:27], s58 offen offset:2048
    s_add_u32 s58, s58, 3072
    ds_read_b128 v[136:139], v9 offset:14336
    ds_read_b128 v[140:143], v9 offset:32768
    ds_read_b128 v[144:147], v11 offset:14336
    ds_read_b128 v[148:151], v11 offset:32768
    s_waitcnt vmcnt(9) lgkmcnt(4)
    v_mfma_f32_16x16x32_bf16 v[16:19], v[76:79], v[152:155], v[16:19]
    v_mfma_f32_16x16x32_bf16 v[32:35], v[80:83], v[152:155], v[32:35]
    v_mfma_f32_16x16x32_bf16 v[48:51], v[84:87], v[152:155], v[48:51]
    v_mfma_f32_16x16x32_bf16 v[20:23], v[76:79], v[156:159], v[20:23]
    v_mfma_f32_16x16x32_bf16 v[36:39], v[80:83], v[156:159], v[36:39]
    v_mfma_f32_16x16x32_bf16 v[52:55], v[84:87], v[156:159], v[52:55]
    v_mfma_f32_16x16x32_bf16 v[24:27], v[76:79], v[160:163], v[24:27]
    v_mfma_f32_16x16x32_bf16 v[40:43], v[80:83], v[160:163], v[40:43]
    v_mfma_f32_16x16x32_bf16 v[56:59], v[84:87], v[160:163], v[56:59]
    v_mfma_f32_16x16x32_bf16 v[28:31], v[76:79], v[164:167], v[28:31]
    v_mfma_f32_16x16x32_bf16 v[44:47], v[80:83], v[164:167], v[44:47]
    v_mfma_f32_16x16x32_bf16 v[60:63], v[84:87], v[164:167], v[60:63]
    buffer_load_dwordx4 v[124:127], v3, s[24:27], s58 offen offset:0
    buffer_load_dwordx4 v[128:131], v3, s[24:27], s58 offen offset:1024
    buffer_load_dwordx4 v[132:135], v3, s[24:27], s58 offen offset:2048
    s_add_u32 s58, s58, 3072
    ds_read_b128 v[152:155], v9 offset:15360
    ds_read_b128 v[156:159], v9 offset:33792
    ds_read_b128 v[160:163], v11 offset:15360
    ds_read_b128 v[164:167], v11 offset:33792
    s_waitcnt vmcnt(9) lgkmcnt(4)
    v_mfma_f32_16x16x32_bf16 v[16:19], v[88:91], v[136:139], v[16:19]
    v_mfma_f32_16x16x32_bf16 v[32:35], v[92:95], v[136:139], v[32:35]
    v_mfma_f32_16x16x32_bf16 v[48:51], v[96:99], v[136:139], v[48:51]
    v_mfma_f32_16x16x32_bf16 v[20:23], v[88:91], v[140:143], v[20:23]
    v_mfma_f32_16x16x32_bf16 v[36:39], v[92:95], v[140:143], v[36:39]
    v_mfma_f32_16x16x32_bf16 v[52:55], v[96:99], v[140:143], v[52:55]
    v_mfma_f32_16x16x32_bf16 v[24:27], v[88:91], v[144:147], v[24:27]
    v_mfma_f32_16x16x32_bf16 v[40:43], v[92:95], v[144:147], v[40:43]
    v_mfma_f32_16x16x32_bf16 v[56:59], v[96:99], v[144:147], v[56:59]
    v_mfma_f32_16x16x32_bf16 v[28:31], v[88:91], v[148:151], v[28:31]
    v_mfma_f32_16x16x32_bf16 v[44:47], v[92:95], v[148:151], v[44:47]
    v_mfma_f32_16x16x32_bf16 v[60:63], v[96:99], v[148:151], v[60:63]
    buffer_load_dwordx4 v[64:67], v3, s[28:31], s59 offen offset:0
    buffer_load_dwordx4 v[68:71], v3, s[28:31], s59 offen offset:1024
    buffer_load_dwordx4 v[72:75], v3, s[28:31], s59 offen offset:2048
    s_add_u32 s59, s59, 3072
    ds_read_b128 v[136:139], v9 offset:16384
    ds_read_b128 v[140:143], v9 offset:34816
    ds_read_b128 v[144:147], v11 offset:16384
    ds_read_b128 v[148:151], v11 offset:34816
    s_waitcnt vmcnt(9) lgkmcnt(4)
    v_mfma_f32_16x16x32_bf16 v[16:19], v[100:103], v[152:155], v[16:19]
    v_mfma_f32_16x16x32_bf16 v[32:35], v[104:107], v[152:155], v[32:35]
    v_mfma_f32_16x16x32_bf16 v[48:51], v[108:111], v[152:155], v[48:51]
    v_mfma_f32_16x16x32_bf16 v[20:23], v[100:103], v[156:159], v[20:23]
    v_mfma_f32_16x16x32_bf16 v[36:39], v[104:107], v[156:159], v[36:39]
    v_mfma_f32_16x16x32_bf16 v[52:55], v[108:111], v[156:159], v[52:55]
    v_mfma_f32_16x16x32_bf16 v[24:27], v[100:103], v[160:163], v[24:27]
    v_mfma_f32_16x16x32_bf16 v[40:43], v[104:107], v[160:163], v[40:43]
    v_mfma_f32_16x16x32_bf16 v[56:59], v[108:111], v[160:163], v[56:59]
    v_mfma_f32_16x16x32_bf16 v[28:31], v[100:103], v[164:167], v[28:31]
    v_mfma_f32_16x16x32_bf16 v[44:47], v[104:107], v[164:167], v[44:47]
    v_mfma_f32_16x16x32_bf16 v[60:63], v[108:111], v[164:167], v[60:63]
    buffer_load_dwordx4 v[76:79], v3, s[28:31], s59 offen offset:0
    buffer_load_dwordx4 v[80:83], v3, s[28:31], s59 offen offset:1024
    buffer_load_dwordx4 v[84:87], v3, s[28:31], s59 offen offset:2048
    s_add_u32 s59, s59, 3072
    ds_read_b128 v[152:155], v9 offset:17408
    ds_read_b128 v[156:159], v9 offset:35840
    ds_read_b128 v[160:163], v11 offset:17408
    ds_read_b128 v[164:167], v11 offset:35840
    s_waitcnt vmcnt(9) lgkmcnt(4)
    v_mfma_f32_16x16x32_bf16 v[16:19], v[112:115], v[136:139], v[16:19]
    v_mfma_f32_16x16x32_bf16 v[32:35], v[116:119], v[136:139], v[32:35]
    v_mfma_f32_16x16x32_bf16 v[48:51], v[120:123], v[136:139], v[48:51]
    v_mfma_f32_16x16x32_bf16 v[20:23], v[112:115], v[140:143], v[20:23]
    v_mfma_f32_16x16x32_bf16 v[36:39], v[116:119], v[140:143], v[36:39]
    v_mfma_f32_16x16x32_bf16 v[52:55], v[120:123], v[140:143], v[52:55]
    v_mfma_f32_16x16x32_bf16 v[24:27], v[112:115], v[144:147], v[24:27]
    v_mfma_f32_16x16x32_bf16 v[40:43], v[116:119], v[144:147], v[40:43]
    v_mfma_f32_16x16x32_bf16 v[56:59], v[120:123], v[144:147], v[56:59]
    v_mfma_f32_16x16x32_bf16 v[28:31], v[112:115], v[148:151], v[28:31]
    v_mfma_f32_16x16x32_bf16 v[44:47], v[116:119], v[148:151], v[44:47]
    v_mfma_f32_16x16x32_bf16 v[60:63], v[120:123], v[148:151], v[60:63]
    buffer_load_dwordx4 v[88:91], v3, s[28:31], s59 offen offset:0
    buffer_load_dwordx4 v[92:95], v3, s[28:31], s59 offen offset:1024
    buffer_load_dwordx4 v[96:99], v3, s[28:31], s59 offen offset:2048
    s_add_u32 s59, s59, 3072
    s_waitcnt vmcnt(9) lgkmcnt(0)
    v_mfma_f32_16x16x32_bf16 v[16:19], v[124:127], v[152:155], v[16:19]
    v_mfma_f32_16x16x32_bf16 v[32:35], v[128:131], v[152:155], v[32:35]
    v_mfma_f32_16x16x32_bf16 v[48:51], v[132:135], v[152:155], v[48:51]
    v_mfma_f32_16x16x32_bf16 v[20:23], v[124:127], v[156:159], v[20:23]
    v_mfma_f32_16x16x32_bf16 v[36:39], v[128:131], v[156:159], v[36:39]
    v_mfma_f32_16x16x32_bf16 v[52:55], v[132:135], v[156:159], v[52:55]
    v_mfma_f32_16x16x32_bf16 v[24:27], v[124:127], v[160:163], v[24:27]
    v_mfma_f32_16x16x32_bf16 v[40:43], v[128:131], v[160:163], v[40:43]
    v_mfma_f32_16x16x32_bf16 v[56:59], v[132:135], v[160:163], v[56:59]
    v_mfma_f32_16x16x32_bf16 v[28:31], v[124:127], v[164:167], v[28:31]
    v_mfma_f32_16x16x32_bf16 v[44:47], v[128:131], v[164:167], v[44:47]
    v_mfma_f32_16x16x32_bf16 v[60:63], v[132:135], v[164:167], v[60:63]
    s_nop 7
    s_mov_b32 s60, 0xbfb8aa3b
    s_mul_i32 s61, s3, 3
    s_add_u32 s62, s61, 0
    s_lshr_b32 s63, s62, 1
    s_lshl_b32 s63, s63, 10
    s_and_b32 s62, s62, 1
    s_lshl_b32 s62, s62, 3
    s_add_u32 s63, s63, s62
    s_add_u32 s63, s63, 73728
    v_add_u32 v10, s63, v3
    v_mul_f32 v136, s60, v16
    v_mul_f32 v137, s60, v17
    v_mul_f32 v138, s60, v18
    v_mul_f32 v139, s60, v19
    v_exp_f32 v136, v136
    v_exp_f32 v137, v137
    v_exp_f32 v138, v138
    v_exp_f32 v139, v139
    v_add_f32 v136, 1.0, v136
    v_add_f32 v137, 1.0, v137
    v_add_f32 v138, 1.0, v138
    v_add_f32 v139, 1.0, v139
    v_rcp_f32 v136, v136
    v_rcp_f32 v137, v137
    v_rcp_f32 v138, v138
    v_rcp_f32 v139, v139
    v_mul_f32 v16, v16, v136
    v_mul_f32 v17, v17, v137
    v_mul_f32 v18, v18, v138
    v_mul_f32 v19, v19, v139
    v_cvt_pk_bf16_f32 v140, v16, v17
    v_cvt_pk_bf16_f32 v141, v18, v19
    ds_write_b64 v10, v[140:141] offset:0
    v_mul_f32 v144, s60, v20
    v_mul_f32 v145, s60, v21
    v_mul_f32 v146, s60, v22
    v_mul_f32 v147, s60, v23
    v_exp_f32 v144, v144
    v_exp_f32 v145, v145
    v_exp_f32 v146, v146
    v_exp_f32 v147, v147
    v_add_f32 v144, 1.0, v144
    v_add_f32 v145, 1.0, v145
    v_add_f32 v146, 1.0, v146
    v_add_f32 v147, 1.0, v147
    v_rcp_f32 v144, v144
    v_rcp_f32 v145, v145
    v_rcp_f32 v146, v146
    v_rcp_f32 v147, v147
    v_mul_f32 v20, v20, v144
    v_mul_f32 v21, v21, v145
    v_mul_f32 v22, v22, v146
    v_mul_f32 v23, v23, v147
    v_cvt_pk_bf16_f32 v148, v20, v21
    v_cvt_pk_bf16_f32 v149, v22, v23
    ds_write_b64 v10, v[148:149] offset:18432
    v_mul_f32 v136, s60, v24
    v_mul_f32 v137, s60, v25
    v_mul_f32 v138, s60, v26
    v_mul_f32 v139, s60, v27
    v_exp_f32 v136, v136
    v_exp_f32 v137, v137
    v_exp_f32 v138, v138
    v_exp_f32 v139, v139
    v_add_f32 v136, 1.0, v136
    v_add_f32 v137, 1.0, v137
    v_add_f32 v138, 1.0, v138
    v_add_f32 v139, 1.0, v139
    v_rcp_f32 v136, v136
    v_rcp_f32 v137, v137
    v_rcp_f32 v138, v138
    v_rcp_f32 v139, v139
    v_mul_f32 v24, v24, v136
    v_mul_f32 v25, v25, v137
    v_mul_f32 v26, v26, v138
    v_mul_f32 v27, v27, v139
    v_cvt_pk_bf16_f32 v140, v24, v25
    v_cvt_pk_bf16_f32 v141, v26, v27
    ds_write_b64 v10, v[140:141] offset:36864
    v_mul_f32 v144, s60, v28
    v_mul_f32 v145, s60, v29
    v_mul_f32 v146, s60, v30
    v_mul_f32 v147, s60, v31
    v_exp_f32 v144, v144
    v_exp_f32 v145, v145
    v_exp_f32 v146, v146
    v_exp_f32 v147, v147
    v_add_f32 v144, 1.0, v144
    v_add_f32 v145, 1.0, v145
    v_add_f32 v146, 1.0, v146
    v_add_f32 v147, 1.0, v147
    v_rcp_f32 v144, v144
    v_rcp_f32 v145, v145
    v_rcp_f32 v146, v146
    v_rcp_f32 v147, v147
    v_mul_f32 v28, v28, v144
    v_mul_f32 v29, v29, v145
    v_mul_f32 v30, v30, v146
    v_mul_f32 v31, v31, v147
    v_cvt_pk_bf16_f32 v148, v28, v29
    v_cvt_pk_bf16_f32 v149, v30, v31
    ds_write_b64 v10, v[148:149] offset:55296
    s_add_u32 s62, s61, 1
    s_lshr_b32 s63, s62, 1
    s_lshl_b32 s63, s63, 10
    s_and_b32 s62, s62, 1
    s_lshl_b32 s62, s62, 3
    s_add_u32 s63, s63, s62
    s_add_u32 s63, s63, 73728
    v_add_u32 v10, s63, v3
    v_mul_f32 v136, s60, v32
    v_mul_f32 v137, s60, v33
    v_mul_f32 v138, s60, v34
    v_mul_f32 v139, s60, v35
    v_exp_f32 v136, v136
    v_exp_f32 v137, v137
    v_exp_f32 v138, v138
    v_exp_f32 v139, v139
    v_add_f32 v136, 1.0, v136
    v_add_f32 v137, 1.0, v137
    v_add_f32 v138, 1.0, v138
    v_add_f32 v139, 1.0, v139
    v_rcp_f32 v136, v136
    v_rcp_f32 v137, v137
    v_rcp_f32 v138, v138
    v_rcp_f32 v139, v139
    v_mul_f32 v32, v32, v136
    v_mul_f32 v33, v33, v137
    v_mul_f32 v34, v34, v138
    v_mul_f32 v35, v35, v139
    v_cvt_pk_bf16_f32 v140, v32, v33
    v_cvt_pk_bf16_f32 v141, v34, v35
    ds_write_b64 v10, v[140:141] offset:0
    v_mul_f32 v144, s60, v36
    v_mul_f32 v145, s60, v37
    v_mul_f32 v146, s60, v38
    v_mul_f32 v147, s60, v39
    v_exp_f32 v144, v144
    v_exp_f32 v145, v145
    v_exp_f32 v146, v146
    v_exp_f32 v147, v147
    v_add_f32 v144, 1.0, v144
    v_add_f32 v145, 1.0, v145
    v_add_f32 v146, 1.0, v146
    v_add_f32 v147, 1.0, v147
    v_rcp_f32 v144, v144
    v_rcp_f32 v145, v145
    v_rcp_f32 v146, v146
    v_rcp_f32 v147, v147
    v_mul_f32 v36, v36, v144
    v_mul_f32 v37, v37, v145
    v_mul_f32 v38, v38, v146
    v_mul_f32 v39, v39, v147
    v_cvt_pk_bf16_f32 v148, v36, v37
    v_cvt_pk_bf16_f32 v149, v38, v39
    ds_write_b64 v10, v[148:149] offset:18432
    v_mul_f32 v136, s60, v40
    v_mul_f32 v137, s60, v41
    v_mul_f32 v138, s60, v42
    v_mul_f32 v139, s60, v43
    v_exp_f32 v136, v136
    v_exp_f32 v137, v137
    v_exp_f32 v138, v138
    v_exp_f32 v139, v139
    v_add_f32 v136, 1.0, v136
    v_add_f32 v137, 1.0, v137
    v_add_f32 v138, 1.0, v138
    v_add_f32 v139, 1.0, v139
    v_rcp_f32 v136, v136
    v_rcp_f32 v137, v137
    v_rcp_f32 v138, v138
    v_rcp_f32 v139, v139
    v_mul_f32 v40, v40, v136
    v_mul_f32 v41, v41, v137
    v_mul_f32 v42, v42, v138
    v_mul_f32 v43, v43, v139
    v_cvt_pk_bf16_f32 v140, v40, v41
    v_cvt_pk_bf16_f32 v141, v42, v43
    ds_write_b64 v10, v[140:141] offset:36864
    v_mul_f32 v144, s60, v44
    v_mul_f32 v145, s60, v45
    v_mul_f32 v146, s60, v46
    v_mul_f32 v147, s60, v47
    v_exp_f32 v144, v144
    v_exp_f32 v145, v145
    v_exp_f32 v146, v146
    v_exp_f32 v147, v147
    v_add_f32 v144, 1.0, v144
    v_add_f32 v145, 1.0, v145
    v_add_f32 v146, 1.0, v146
    v_add_f32 v147, 1.0, v147
    v_rcp_f32 v144, v144
    v_rcp_f32 v145, v145
    v_rcp_f32 v146, v146
    v_rcp_f32 v147, v147
    v_mul_f32 v44, v44, v144
    v_mul_f32 v45, v45, v145
    v_mul_f32 v46, v46, v146
    v_mul_f32 v47, v47, v147
    v_cvt_pk_bf16_f32 v148, v44, v45
    v_cvt_pk_bf16_f32 v149, v46, v47
    ds_write_b64 v10, v[148:149] offset:55296
    s_add_u32 s62, s61, 2
    s_lshr_b32 s63, s62, 1
    s_lshl_b32 s63, s63, 10
    s_and_b32 s62, s62, 1
    s_lshl_b32 s62, s62, 3
    s_add_u32 s63, s63, s62
    s_add_u32 s63, s63, 73728
    v_add_u32 v10, s63, v3
    v_mul_f32 v136, s60, v48
    v_mul_f32 v137, s60, v49
    v_mul_f32 v138, s60, v50
    v_mul_f32 v139, s60, v51
    v_exp_f32 v136, v136
    v_exp_f32 v137, v137
    v_exp_f32 v138, v138
    v_exp_f32 v139, v139
    v_add_f32 v136, 1.0, v136
    v_add_f32 v137, 1.0, v137
    v_add_f32 v138, 1.0, v138
    v_add_f32 v139, 1.0, v139
    v_rcp_f32 v136, v136
    v_rcp_f32 v137, v137
    v_rcp_f32 v138, v138
    v_rcp_f32 v139, v139
    v_mul_f32 v48, v48, v136
    v_mul_f32 v49, v49, v137
    v_mul_f32 v50, v50, v138
    v_mul_f32 v51, v51, v139
    v_cvt_pk_bf16_f32 v140, v48, v49
    v_cvt_pk_bf16_f32 v141, v50, v51
    ds_write_b64 v10, v[140:141] offset:0
    v_mul_f32 v144, s60, v52
    v_mul_f32 v145, s60, v53
    v_mul_f32 v146, s60, v54
    v_mul_f32 v147, s60, v55
    v_exp_f32 v144, v144
    v_exp_f32 v145, v145
    v_exp_f32 v146, v146
    v_exp_f32 v147, v147
    v_add_f32 v144, 1.0, v144
    v_add_f32 v145, 1.0, v145
    v_add_f32 v146, 1.0, v146
    v_add_f32 v147, 1.0, v147
    v_rcp_f32 v144, v144
    v_rcp_f32 v145, v145
    v_rcp_f32 v146, v146
    v_rcp_f32 v147, v147
    v_mul_f32 v52, v52, v144
    v_mul_f32 v53, v53, v145
    v_mul_f32 v54, v54, v146
    v_mul_f32 v55, v55, v147
    v_cvt_pk_bf16_f32 v148, v52, v53
    v_cvt_pk_bf16_f32 v149, v54, v55
    ds_write_b64 v10, v[148:149] offset:18432
    v_mul_f32 v136, s60, v56
    v_mul_f32 v137, s60, v57
    v_mul_f32 v138, s60, v58
    v_mul_f32 v139, s60, v59
    v_exp_f32 v136, v136
    v_exp_f32 v137, v137
    v_exp_f32 v138, v138
    v_exp_f32 v139, v139
    v_add_f32 v136, 1.0, v136
    v_add_f32 v137, 1.0, v137
    v_add_f32 v138, 1.0, v138
    v_add_f32 v139, 1.0, v139
    v_rcp_f32 v136, v136
    v_rcp_f32 v137, v137
    v_rcp_f32 v138, v138
    v_rcp_f32 v139, v139
    v_mul_f32 v56, v56, v136
    v_mul_f32 v57, v57, v137
    v_mul_f32 v58, v58, v138
    v_mul_f32 v59, v59, v139
    v_cvt_pk_bf16_f32 v140, v56, v57
    v_cvt_pk_bf16_f32 v141, v58, v59
    ds_write_b64 v10, v[140:141] offset:36864
    v_mul_f32 v144, s60, v60
    v_mul_f32 v145, s60, v61
    v_mul_f32 v146, s60, v62
    v_mul_f32 v147, s60, v63
    v_exp_f32 v144, v144
    v_exp_f32 v145, v145
    v_exp_f32 v146, v146
    v_exp_f32 v147, v147
    v_add_f32 v144, 1.0, v144
    v_add_f32 v145, 1.0, v145
    v_add_f32 v146, 1.0, v146
    v_add_f32 v147, 1.0, v147
    v_rcp_f32 v144, v144
    v_rcp_f32 v145, v145
    v_rcp_f32 v146, v146
    v_rcp_f32 v147, v147
    v_mul_f32 v60, v60, v144
    v_mul_f32 v61, v61, v145
    v_mul_f32 v62, v62, v146
    v_mul_f32 v63, v63, v147
    v_cvt_pk_bf16_f32 v148, v60, v61
    v_cvt_pk_bf16_f32 v149, v62, v63
    ds_write_b64 v10, v[148:149] offset:55296
    s_waitcnt lgkmcnt(0)
    s_lshr_b32 s62, s3, 2
    s_lshl_b32 s62, s62, 2
    s_add_u32 s62, s62, 152064
    v_mov_b32 v12, s62
    v_mov_b32 v13, 1
    s_mov_b64 s[50:51], exec
    s_mov_b64 exec, 1
    ds_add_u32 v12, v13
    s_mov_b64 exec, s[50:51]
    v_add_u32 v9, 73728, v3
    v_add_u32 v11, 110592, v3
    v_mov_b32 v16, 0
    v_mov_b32 v17, 0
    v_mov_b32 v18, 0
    v_mov_b32 v19, 0
    v_mov_b32 v20, 0
    v_mov_b32 v21, 0
    v_mov_b32 v22, 0
    v_mov_b32 v23, 0
    v_mov_b32 v24, 0
    v_mov_b32 v25, 0
    v_mov_b32 v26, 0
    v_mov_b32 v27, 0
    v_mov_b32 v28, 0
    v_mov_b32 v29, 0
    v_mov_b32 v30, 0
    v_mov_b32 v31, 0
    v_mov_b32 v32, 0
    v_mov_b32 v33, 0
    v_mov_b32 v34, 0
    v_mov_b32 v35, 0
    v_mov_b32 v36, 0
    v_mov_b32 v37, 0
    v_mov_b32 v38, 0
    v_mov_b32 v39, 0
    v_mov_b32 v40, 0
    v_mov_b32 v41, 0
    v_mov_b32 v42, 0
    v_mov_b32 v43, 0
    v_mov_b32 v44, 0
    v_mov_b32 v45, 0
    v_mov_b32 v46, 0
    v_mov_b32 v47, 0
    v_mov_b32 v48, 0
    v_mov_b32 v49, 0
    v_mov_b32 v50, 0
    v_mov_b32 v51, 0
    v_mov_b32 v52, 0
    v_mov_b32 v53, 0
    v_mov_b32 v54, 0
    v_mov_b32 v55, 0
    v_mov_b32 v56, 0
    v_mov_b32 v57, 0
    v_mov_b32 v58, 0
    v_mov_b32 v59, 0
    v_mov_b32 v60, 0
    v_mov_b32 v61, 0
    v_mov_b32 v62, 0
    v_mov_b32 v63, 0
    v_mov_b32 v12, 152064
L_gp_43:
    ds_read_b32 v13, v12
    s_waitcnt lgkmcnt(0)
    v_readfirstlane_b32 s62, v13
    s_cmp_ge_u32 s62, 4
    s_cbranch_scc1 L_gd_44
    s_sleep 1
    s_branch L_gp_43
L_gd_44:
    ds_read_b128 v[136:139], v9 offset:0
    ds_read_b128 v[140:143], v9 offset:18432
    ds_read_b128 v[144:147], v11 offset:0
    ds_read_b128 v[148:151], v11 offset:18432
    buffer_load_dwordx4 v[100:103], v3, s[28:31], s59 offen offset:0
    buffer_load_dwordx4 v[104:107], v3, s[28:31], s59 offen offset:1024
    buffer_load_dwordx4 v[108:111], v3, s[28:31], s59 offen offset:2048
    s_add_u32 s59, s59, 3072
    ds_read_b128 v[152:155], v9 offset:1024
    ds_read_b128 v[156:159], v9 offset:19456
    ds_read_b128 v[160:163], v11 offset:1024
    ds_read_b128 v[164:167], v11 offset:19456
    s_waitcnt vmcnt(9) lgkmcnt(4)
    v_mfma_f32_16x16x32_bf16 v[16:19], v[64:67], v[136:139], v[16:19]
    v_mfma_f32_16x16x32_bf16 v[32:35], v[68:71], v[136:139], v[32:35]
    v_mfma_f32_16x16x32_bf16 v[48:51], v[72:75], v[136:139], v[48:51]
    v_mfma_f32_16x16x32_bf16 v[20:23], v[64:67], v[140:143], v[20:23]
    v_mfma_f32_16x16x32_bf16 v[36:39], v[68:71], v[140:143], v[36:39]
    v_mfma_f32_16x16x32_bf16 v[52:55], v[72:75], v[140:143], v[52:55]
    v_mfma_f32_16x16x32_bf16 v[24:27], v[64:67], v[144:147], v[24:27]
    v_mfma_f32_16x16x32_bf16 v[40:43], v[68:71], v[144:147], v[40:43]
    v_mfma_f32_16x16x32_bf16 v[56:59], v[72:75], v[144:147], v[56:59]
    v_mfma_f32_16x16x32_bf16 v[28:31], v[64:67], v[148:151], v[28:31]
    v_mfma_f32_16x16x32_bf16 v[44:47], v[68:71], v[148:151], v[44:47]
    v_mfma_f32_16x16x32_bf16 v[60:63], v[72:75], v[148:151], v[60:63]
    buffer_load_dwordx4 v[112:115], v3, s[28:31], s59 offen offset:0
    buffer_load_dwordx4 v[116:119], v3, s[28:31], s59 offen offset:1024
    buffer_load_dwordx4 v[120:123], v3, s[28:31], s59 offen offset:2048
    s_add_u32 s59, s59, 3072
    ds_read_b128 v[136:139], v9 offset:2048
    ds_read_b128 v[140:143], v9 offset:20480
    ds_read_b128 v[144:147], v11 offset:2048
    ds_read_b128 v[148:151], v11 offset:20480
    s_waitcnt vmcnt(9) lgkmcnt(4)
    v_mfma_f32_16x16x32_bf16 v[16:19], v[76:79], v[152:155], v[16:19]
    v_mfma_f32_16x16x32_bf16 v[32:35], v[80:83], v[152:155], v[32:35]
    v_mfma_f32_16x16x32_bf16 v[48:51], v[84:87], v[152:155], v[48:51]
    v_mfma_f32_16x16x32_bf16 v[20:23], v[76:79], v[156:159], v[20:23]
    v_mfma_f32_16x16x32_bf16 v[36:39], v[80:83], v[156:159], v[36:39]
    v_mfma_f32_16x16x32_bf16 v[52:55], v[84:87], v[156:159], v[52:55]
    v_mfma_f32_16x16x32_bf16 v[24:27], v[76:79], v[160:163], v[24:27]
    v_mfma_f32_16x16x32_bf16 v[40:43], v[80:83], v[160:163], v[40:43]
    v_mfma_f32_16x16x32_bf16 v[56:59], v[84:87], v[160:163], v[56:59]
    v_mfma_f32_16x16x32_bf16 v[28:31], v[76:79], v[164:167], v[28:31]
    v_mfma_f32_16x16x32_bf16 v[44:47], v[80:83], v[164:167], v[44:47]
    v_mfma_f32_16x16x32_bf16 v[60:63], v[84:87], v[164:167], v[60:63]
    buffer_load_dwordx4 v[124:127], v3, s[28:31], s59 offen offset:0
    buffer_load_dwordx4 v[128:131], v3, s[28:31], s59 offen offset:1024
    buffer_load_dwordx4 v[132:135], v3, s[28:31], s59 offen offset:2048
    s_add_u32 s59, s59, 3072
    ds_read_b128 v[152:155], v9 offset:3072
    ds_read_b128 v[156:159], v9 offset:21504
    ds_read_b128 v[160:163], v11 offset:3072
    ds_read_b128 v[164:167], v11 offset:21504
    s_waitcnt vmcnt(9) lgkmcnt(4)
    v_mfma_f32_16x16x32_bf16 v[16:19], v[88:91], v[136:139], v[16:19]
    v_mfma_f32_16x16x32_bf16 v[32:35], v[92:95], v[136:139], v[32:35]
    v_mfma_f32_16x16x32_bf16 v[48:51], v[96:99], v[136:139], v[48:51]
    v_mfma_f32_16x16x32_bf16 v[20:23], v[88:91], v[140:143], v[20:23]
    v_mfma_f32_16x16x32_bf16 v[36:39], v[92:95], v[140:143], v[36:39]
    v_mfma_f32_16x16x32_bf16 v[52:55], v[96:99], v[140:143], v[52:55]
    v_mfma_f32_16x16x32_bf16 v[24:27], v[88:91], v[144:147], v[24:27]
    v_mfma_f32_16x16x32_bf16 v[40:43], v[92:95], v[144:147], v[40:43]
    v_mfma_f32_16x16x32_bf16 v[56:59], v[96:99], v[144:147], v[56:59]
    v_mfma_f32_16x16x32_bf16 v[28:31], v[88:91], v[148:151], v[28:31]
    v_mfma_f32_16x16x32_bf16 v[44:47], v[92:95], v[148:151], v[44:47]
    v_mfma_f32_16x16x32_bf16 v[60:63], v[96:99], v[148:151], v[60:63]
    buffer_load_dwordx4 v[64:67], v3, s[28:31], s59 offen offset:0
    buffer_load_dwordx4 v[68:71], v3, s[28:31], s59 offen offset:1024
    buffer_load_dwordx4 v[72:75], v3, s[28:31], s59 offen offset:2048
    s_add_u32 s59, s59, 3072
    ds_read_b128 v[136:139], v9 offset:4096
    ds_read_b128 v[140:143], v9 offset:22528
    ds_read_b128 v[144:147], v11 offset:4096
    ds_read_b128 v[148:151], v11 offset:22528
    s_waitcnt vmcnt(9) lgkmcnt(4)
    v_mfma_f32_16x16x32_bf16 v[16:19], v[100:103], v[152:155], v[16:19]
    v_mfma_f32_16x16x32_bf16 v[32:35], v[104:107], v[152:155], v[32:35]
    v_mfma_f32_16x16x32_bf16 v[48:51], v[108:111], v[152:155], v[48:51]
    v_mfma_f32_16x16x32_bf16 v[20:23], v[100:103], v[156:159], v[20:23]
    v_mfma_f32_16x16x32_bf16 v[36:39], v[104:107], v[156:159], v[36:39]
    v_mfma_f32_16x16x32_bf16 v[52:55], v[108:111], v[156:159], v[52:55]
    v_mfma_f32_16x16x32_bf16 v[24:27], v[100:103], v[160:163], v[24:27]
    v_mfma_f32_16x16x32_bf16 v[40:43], v[104:107], v[160:163], v[40:43]
    v_mfma_f32_16x16x32_bf16 v[56:59], v[108:111], v[160:163], v[56:59]
    v_mfma_f32_16x16x32_bf16 v[28:31], v[100:103], v[164:167], v[28:31]
    v_mfma_f32_16x16x32_bf16 v[44:47], v[104:107], v[164:167], v[44:47]
    v_mfma_f32_16x16x32_bf16 v[60:63], v[108:111], v[164:167], v[60:63]
    buffer_load_dwordx4 v[76:79], v3, s[28:31], s59 offen offset:0
    buffer_load_dwordx4 v[80:83], v3, s[28:31], s59 offen offset:1024
    buffer_load_dwordx4 v[84:87], v3, s[28:31], s59 offen offset:2048
    s_add_u32 s59, s59, 3072
    ds_read_b128 v[152:155], v9 offset:5120
    ds_read_b128 v[156:159], v9 offset:23552
    ds_read_b128 v[160:163], v11 offset:5120
    ds_read_b128 v[164:167], v11 offset:23552
    s_waitcnt vmcnt(9) lgkmcnt(4)
    v_mfma_f32_16x16x32_bf16 v[16:19], v[112:115], v[136:139], v[16:19]
    v_mfma_f32_16x16x32_bf16 v[32:35], v[116:119], v[136:139], v[32:35]
    v_mfma_f32_16x16x32_bf16 v[48:51], v[120:123], v[136:139], v[48:51]
    v_mfma_f32_16x16x32_bf16 v[20:23], v[112:115], v[140:143], v[20:23]
    v_mfma_f32_16x16x32_bf16 v[36:39], v[116:119], v[140:143], v[36:39]
    v_mfma_f32_16x16x32_bf16 v[52:55], v[120:123], v[140:143], v[52:55]
    v_mfma_f32_16x16x32_bf16 v[24:27], v[112:115], v[144:147], v[24:27]
    v_mfma_f32_16x16x32_bf16 v[40:43], v[116:119], v[144:147], v[40:43]
    v_mfma_f32_16x16x32_bf16 v[56:59], v[120:123], v[144:147], v[56:59]
    v_mfma_f32_16x16x32_bf16 v[28:31], v[112:115], v[148:151], v[28:31]
    v_mfma_f32_16x16x32_bf16 v[44:47], v[116:119], v[148:151], v[44:47]
    v_mfma_f32_16x16x32_bf16 v[60:63], v[120:123], v[148:151], v[60:63]
    buffer_load_dwordx4 v[88:91], v3, s[28:31], s59 offen offset:0
    buffer_load_dwordx4 v[92:95], v3, s[28:31], s59 offen offset:1024
    buffer_load_dwordx4 v[96:99], v3, s[28:31], s59 offen offset:2048
    s_add_u32 s59, s59, 3072
    s_waitcnt vmcnt(9) lgkmcnt(0)
    v_mfma_f32_16x16x32_bf16 v[16:19], v[124:127], v[152:155], v[16:19]
    v_mfma_f32_16x16x32_bf16 v[32:35], v[128:131], v[152:155], v[32:35]
    v_mfma_f32_16x16x32_bf16 v[48:51], v[132:135], v[152:155], v[48:51]
    v_mfma_f32_16x16x32_bf16 v[20:23], v[124:127], v[156:159], v[20:23]
    v_mfma_f32_16x16x32_bf16 v[36:39], v[128:131], v[156:159], v[36:39]
    v_mfma_f32_16x16x32_bf16 v[52:55], v[132:135], v[156:159], v[52:55]
    v_mfma_f32_16x16x32_bf16 v[24:27], v[124:127], v[160:163], v[24:27]
    v_mfma_f32_16x16x32_bf16 v[40:43], v[128:131], v[160:163], v[40:43]
    v_mfma_f32_16x16x32_bf16 v[56:59], v[132:135], v[160:163], v[56:59]
    v_mfma_f32_16x16x32_bf16 v[28:31], v[124:127], v[164:167], v[28:31]
    v_mfma_f32_16x16x32_bf16 v[44:47], v[128:131], v[164:167], v[44:47]
    v_mfma_f32_16x16x32_bf16 v[60:63], v[132:135], v[164:167], v[60:63]
    v_mov_b32 v12, 152068
L_gp_45:
    ds_read_b32 v13, v12
    s_waitcnt lgkmcnt(0)
    v_readfirstlane_b32 s62, v13
    s_cmp_ge_u32 s62, 4
    s_cbranch_scc1 L_gd_46
    s_sleep 1
    s_branch L_gp_45
L_gd_46:
    ds_read_b128 v[136:139], v9 offset:6144
    ds_read_b128 v[140:143], v9 offset:24576
    ds_read_b128 v[144:147], v11 offset:6144
    ds_read_b128 v[148:151], v11 offset:24576
    buffer_load_dwordx4 v[100:103], v3, s[28:31], s59 offen offset:0
    buffer_load_dwordx4 v[104:107], v3, s[28:31], s59 offen offset:1024
    buffer_load_dwordx4 v[108:111], v3, s[28:31], s59 offen offset:2048
    s_add_u32 s59, s59, 3072
    ds_read_b128 v[152:155], v9 offset:7168
    ds_read_b128 v[156:159], v9 offset:25600
    ds_read_b128 v[160:163], v11 offset:7168
    ds_read_b128 v[164:167], v11 offset:25600
    s_waitcnt vmcnt(9) lgkmcnt(4)
    v_mfma_f32_16x16x32_bf16 v[16:19], v[64:67], v[136:139], v[16:19]
    v_mfma_f32_16x16x32_bf16 v[32:35], v[68:71], v[136:139], v[32:35]
    v_mfma_f32_16x16x32_bf16 v[48:51], v[72:75], v[136:139], v[48:51]
    v_mfma_f32_16x16x32_bf16 v[20:23], v[64:67], v[140:143], v[20:23]
    v_mfma_f32_16x16x32_bf16 v[36:39], v[68:71], v[140:143], v[36:39]
    v_mfma_f32_16x16x32_bf16 v[52:55], v[72:75], v[140:143], v[52:55]
    v_mfma_f32_16x16x32_bf16 v[24:27], v[64:67], v[144:147], v[24:27]
    v_mfma_f32_16x16x32_bf16 v[40:43], v[68:71], v[144:147], v[40:43]
    v_mfma_f32_16x16x32_bf16 v[56:59], v[72:75], v[144:147], v[56:59]
    v_mfma_f32_16x16x32_bf16 v[28:31], v[64:67], v[148:151], v[28:31]
    v_mfma_f32_16x16x32_bf16 v[44:47], v[68:71], v[148:151], v[44:47]
    v_mfma_f32_16x16x32_bf16 v[60:63], v[72:75], v[148:151], v[60:63]
    buffer_load_dwordx4 v[112:115], v3, s[28:31], s59 offen offset:0
    buffer_load_dwordx4 v[116:119], v3, s[28:31], s59 offen offset:1024
    buffer_load_dwordx4 v[120:123], v3, s[28:31], s59 offen offset:2048
    s_add_u32 s59, s59, 3072
    ds_read_b128 v[136:139], v9 offset:8192
    ds_read_b128 v[140:143], v9 offset:26624
    ds_read_b128 v[144:147], v11 offset:8192
    ds_read_b128 v[148:151], v11 offset:26624
    s_waitcnt vmcnt(9) lgkmcnt(4)
    v_mfma_f32_16x16x32_bf16 v[16:19], v[76:79], v[152:155], v[16:19]
    v_mfma_f32_16x16x32_bf16 v[32:35], v[80:83], v[152:155], v[32:35]
    v_mfma_f32_16x16x32_bf16 v[48:51], v[84:87], v[152:155], v[48:51]
    v_mfma_f32_16x16x32_bf16 v[20:23], v[76:79], v[156:159], v[20:23]
    v_mfma_f32_16x16x32_bf16 v[36:39], v[80:83], v[156:159], v[36:39]
    v_mfma_f32_16x16x32_bf16 v[52:55], v[84:87], v[156:159], v[52:55]
    v_mfma_f32_16x16x32_bf16 v[24:27], v[76:79], v[160:163], v[24:27]
    v_mfma_f32_16x16x32_bf16 v[40:43], v[80:83], v[160:163], v[40:43]
    v_mfma_f32_16x16x32_bf16 v[56:59], v[84:87], v[160:163], v[56:59]
    v_mfma_f32_16x16x32_bf16 v[28:31], v[76:79], v[164:167], v[28:31]
    v_mfma_f32_16x16x32_bf16 v[44:47], v[80:83], v[164:167], v[44:47]
    v_mfma_f32_16x16x32_bf16 v[60:63], v[84:87], v[164:167], v[60:63]
    buffer_load_dwordx4 v[124:127], v3, s[28:31], s59 offen offset:0
    buffer_load_dwordx4 v[128:131], v3, s[28:31], s59 offen offset:1024
    buffer_load_dwordx4 v[132:135], v3, s[28:31], s59 offen offset:2048
    s_add_u32 s59, s59, 3072
    ds_read_b128 v[152:155], v9 offset:9216
    ds_read_b128 v[156:159], v9 offset:27648
    ds_read_b128 v[160:163], v11 offset:9216
    ds_read_b128 v[164:167], v11 offset:27648
    s_waitcnt vmcnt(9) lgkmcnt(4)
    v_mfma_f32_16x16x32_bf16 v[16:19], v[88:91], v[136:139], v[16:19]
    v_mfma_f32_16x16x32_bf16 v[32:35], v[92:95], v[136:139], v[32:35]
    v_mfma_f32_16x16x32_bf16 v[48:51], v[96:99], v[136:139], v[48:51]
    v_mfma_f32_16x16x32_bf16 v[20:23], v[88:91], v[140:143], v[20:23]
    v_mfma_f32_16x16x32_bf16 v[36:39], v[92:95], v[140:143], v[36:39]
    v_mfma_f32_16x16x32_bf16 v[52:55], v[96:99], v[140:143], v[52:55]
    v_mfma_f32_16x16x32_bf16 v[24:27], v[88:91], v[144:147], v[24:27]
    v_mfma_f32_16x16x32_bf16 v[40:43], v[92:95], v[144:147], v[40:43]
    v_mfma_f32_16x16x32_bf16 v[56:59], v[96:99], v[144:147], v[56:59]
    v_mfma_f32_16x16x32_bf16 v[28:31], v[88:91], v[148:151], v[28:31]
    v_mfma_f32_16x16x32_bf16 v[44:47], v[92:95], v[148:151], v[44:47]
    v_mfma_f32_16x16x32_bf16 v[60:63], v[96:99], v[148:151], v[60:63]
    buffer_load_dwordx4 v[64:67], v3, s[28:31], s59 offen offset:0
    buffer_load_dwordx4 v[68:71], v3, s[28:31], s59 offen offset:1024
    buffer_load_dwordx4 v[72:75], v3, s[28:31], s59 offen offset:2048
    s_add_u32 s59, s59, 3072
    ds_read_b128 v[136:139], v9 offset:10240
    ds_read_b128 v[140:143], v9 offset:28672
    ds_read_b128 v[144:147], v11 offset:10240
    ds_read_b128 v[148:151], v11 offset:28672
    s_waitcnt vmcnt(9) lgkmcnt(4)
    v_mfma_f32_16x16x32_bf16 v[16:19], v[100:103], v[152:155], v[16:19]
    v_mfma_f32_16x16x32_bf16 v[32:35], v[104:107], v[152:155], v[32:35]
    v_mfma_f32_16x16x32_bf16 v[48:51], v[108:111], v[152:155], v[48:51]
    v_mfma_f32_16x16x32_bf16 v[20:23], v[100:103], v[156:159], v[20:23]
    v_mfma_f32_16x16x32_bf16 v[36:39], v[104:107], v[156:159], v[36:39]
    v_mfma_f32_16x16x32_bf16 v[52:55], v[108:111], v[156:159], v[52:55]
    v_mfma_f32_16x16x32_bf16 v[24:27], v[100:103], v[160:163], v[24:27]
    v_mfma_f32_16x16x32_bf16 v[40:43], v[104:107], v[160:163], v[40:43]
    v_mfma_f32_16x16x32_bf16 v[56:59], v[108:111], v[160:163], v[56:59]
    v_mfma_f32_16x16x32_bf16 v[28:31], v[100:103], v[164:167], v[28:31]
    v_mfma_f32_16x16x32_bf16 v[44:47], v[104:107], v[164:167], v[44:47]
    v_mfma_f32_16x16x32_bf16 v[60:63], v[108:111], v[164:167], v[60:63]
    buffer_load_dwordx4 v[76:79], v3, s[28:31], s59 offen offset:0
    buffer_load_dwordx4 v[80:83], v3, s[28:31], s59 offen offset:1024
    buffer_load_dwordx4 v[84:87], v3, s[28:31], s59 offen offset:2048
    s_add_u32 s59, s59, 3072
    ds_read_b128 v[152:155], v9 offset:11264
    ds_read_b128 v[156:159], v9 offset:29696
    ds_read_b128 v[160:163], v11 offset:11264
    ds_read_b128 v[164:167], v11 offset:29696
    s_waitcnt vmcnt(9) lgkmcnt(4)
    v_mfma_f32_16x16x32_bf16 v[16:19], v[112:115], v[136:139], v[16:19]
    v_mfma_f32_16x16x32_bf16 v[32:35], v[116:119], v[136:139], v[32:35]
    v_mfma_f32_16x16x32_bf16 v[48:51], v[120:123], v[136:139], v[48:51]
    v_mfma_f32_16x16x32_bf16 v[20:23], v[112:115], v[140:143], v[20:23]
    v_mfma_f32_16x16x32_bf16 v[36:39], v[116:119], v[140:143], v[36:39]
    v_mfma_f32_16x16x32_bf16 v[52:55], v[120:123], v[140:143], v[52:55]
    v_mfma_f32_16x16x32_bf16 v[24:27], v[112:115], v[144:147], v[24:27]
    v_mfma_f32_16x16x32_bf16 v[40:43], v[116:119], v[144:147], v[40:43]
    v_mfma_f32_16x16x32_bf16 v[56:59], v[120:123], v[144:147], v[56:59]
    v_mfma_f32_16x16x32_bf16 v[28:31], v[112:115], v[148:151], v[28:31]
    v_mfma_f32_16x16x32_bf16 v[44:47], v[116:119], v[148:151], v[44:47]
    v_mfma_f32_16x16x32_bf16 v[60:63], v[120:123], v[148:151], v[60:63]
    buffer_load_dwordx4 v[88:91], v3, s[28:31], s59 offen offset:0
    buffer_load_dwordx4 v[92:95], v3, s[28:31], s59 offen offset:1024
    buffer_load_dwordx4 v[96:99], v3, s[28:31], s59 offen offset:2048
    s_add_u32 s59, s59, 3072
    s_waitcnt vmcnt(9) lgkmcnt(0)
    v_mfma_f32_16x16x32_bf16 v[16:19], v[124:127], v[152:155], v[16:19]
    v_mfma_f32_16x16x32_bf16 v[32:35], v[128:131], v[152:155], v[32:35]
    v_mfma_f32_16x16x32_bf16 v[48:51], v[132:135], v[152:155], v[48:51]
    v_mfma_f32_16x16x32_bf16 v[20:23], v[124:127], v[156:159], v[20:23]
    v_mfma_f32_16x16x32_bf16 v[36:39], v[128:131], v[156:159], v[36:39]
    v_mfma_f32_16x16x32_bf16 v[52:55], v[132:135], v[156:159], v[52:55]
    v_mfma_f32_16x16x32_bf16 v[24:27], v[124:127], v[160:163], v[24:27]
    v_mfma_f32_16x16x32_bf16 v[40:43], v[128:131], v[160:163], v[40:43]
    v_mfma_f32_16x16x32_bf16 v[56:59], v[132:135], v[160:163], v[56:59]
    v_mfma_f32_16x16x32_bf16 v[28:31], v[124:127], v[164:167], v[28:31]
    v_mfma_f32_16x16x32_bf16 v[44:47], v[128:131], v[164:167], v[44:47]
    v_mfma_f32_16x16x32_bf16 v[60:63], v[132:135], v[164:167], v[60:63]
    v_mov_b32 v12, 152072
L_gp_47:
    ds_read_b32 v13, v12
    s_waitcnt lgkmcnt(0)
    v_readfirstlane_b32 s62, v13
    s_cmp_ge_u32 s62, 4
    s_cbranch_scc1 L_gd_48
    s_sleep 1
    s_branch L_gp_47
L_gd_48:
    ds_read_b128 v[136:139], v9 offset:12288
    ds_read_b128 v[140:143], v9 offset:30720
    ds_read_b128 v[144:147], v11 offset:12288
    ds_read_b128 v[148:151], v11 offset:30720
    buffer_load_dwordx4 v[100:103], v3, s[28:31], s59 offen offset:0
    buffer_load_dwordx4 v[104:107], v3, s[28:31], s59 offen offset:1024
    buffer_load_dwordx4 v[108:111], v3, s[28:31], s59 offen offset:2048
    s_add_u32 s59, s59, 3072
    ds_read_b128 v[152:155], v9 offset:13312
    ds_read_b128 v[156:159], v9 offset:31744
    ds_read_b128 v[160:163], v11 offset:13312
    ds_read_b128 v[164:167], v11 offset:31744
    s_waitcnt vmcnt(9) lgkmcnt(4)
    v_mfma_f32_16x16x32_bf16 v[16:19], v[64:67], v[136:139], v[16:19]
    v_mfma_f32_16x16x32_bf16 v[32:35], v[68:71], v[136:139], v[32:35]
    v_mfma_f32_16x16x32_bf16 v[48:51], v[72:75], v[136:139], v[48:51]
    v_mfma_f32_16x16x32_bf16 v[20:23], v[64:67], v[140:143], v[20:23]
    v_mfma_f32_16x16x32_bf16 v[36:39], v[68:71], v[140:143], v[36:39]
    v_mfma_f32_16x16x32_bf16 v[52:55], v[72:75], v[140:143], v[52:55]
    v_mfma_f32_16x16x32_bf16 v[24:27], v[64:67], v[144:147], v[24:27]
    v_mfma_f32_16x16x32_bf16 v[40:43], v[68:71], v[144:147], v[40:43]
    v_mfma_f32_16x16x32_bf16 v[56:59], v[72:75], v[144:147], v[56:59]
    v_mfma_f32_16x16x32_bf16 v[28:31], v[64:67], v[148:151], v[28:31]
    v_mfma_f32_16x16x32_bf16 v[44:47], v[68:71], v[148:151], v[44:47]
    v_mfma_f32_16x16x32_bf16 v[60:63], v[72:75], v[148:151], v[60:63]
    buffer_load_dwordx4 v[112:115], v3, s[28:31], s59 offen offset:0
    buffer_load_dwordx4 v[116:119], v3, s[28:31], s59 offen offset:1024
    buffer_load_dwordx4 v[120:123], v3, s[28:31], s59 offen offset:2048
    s_add_u32 s59, s59, 3072
    ds_read_b128 v[136:139], v9 offset:14336
    ds_read_b128 v[140:143], v9 offset:32768
    ds_read_b128 v[144:147], v11 offset:14336
    ds_read_b128 v[148:151], v11 offset:32768
    s_waitcnt vmcnt(9) lgkmcnt(4)
    v_mfma_f32_16x16x32_bf16 v[16:19], v[76:79], v[152:155], v[16:19]
    v_mfma_f32_16x16x32_bf16 v[32:35], v[80:83], v[152:155], v[32:35]
    v_mfma_f32_16x16x32_bf16 v[48:51], v[84:87], v[152:155], v[48:51]
    v_mfma_f32_16x16x32_bf16 v[20:23], v[76:79], v[156:159], v[20:23]
    v_mfma_f32_16x16x32_bf16 v[36:39], v[80:83], v[156:159], v[36:39]
    v_mfma_f32_16x16x32_bf16 v[52:55], v[84:87], v[156:159], v[52:55]
    v_mfma_f32_16x16x32_bf16 v[24:27], v[76:79], v[160:163], v[24:27]
    v_mfma_f32_16x16x32_bf16 v[40:43], v[80:83], v[160:163], v[40:43]
    v_mfma_f32_16x16x32_bf16 v[56:59], v[84:87], v[160:163], v[56:59]
    v_mfma_f32_16x16x32_bf16 v[28:31], v[76:79], v[164:167], v[28:31]
    v_mfma_f32_16x16x32_bf16 v[44:47], v[80:83], v[164:167], v[44:47]
    v_mfma_f32_16x16x32_bf16 v[60:63], v[84:87], v[164:167], v[60:63]
    buffer_load_dwordx4 v[124:127], v3, s[28:31], s59 offen offset:0
    buffer_load_dwordx4 v[128:131], v3, s[28:31], s59 offen offset:1024
    buffer_load_dwordx4 v[132:135], v3, s[28:31], s59 offen offset:2048
    s_add_u32 s59, s59, 3072
    ds_read_b128 v[152:155], v9 offset:15360
    ds_read_b128 v[156:159], v9 offset:33792
    ds_read_b128 v[160:163], v11 offset:15360
    ds_read_b128 v[164:167], v11 offset:33792
    s_waitcnt vmcnt(9) lgkmcnt(4)
    v_mfma_f32_16x16x32_bf16 v[16:19], v[88:91], v[136:139], v[16:19]
    v_mfma_f32_16x16x32_bf16 v[32:35], v[92:95], v[136:139], v[32:35]
    v_mfma_f32_16x16x32_bf16 v[48:51], v[96:99], v[136:139], v[48:51]
    v_mfma_f32_16x16x32_bf16 v[20:23], v[88:91], v[140:143], v[20:23]
    v_mfma_f32_16x16x32_bf16 v[36:39], v[92:95], v[140:143], v[36:39]
    v_mfma_f32_16x16x32_bf16 v[52:55], v[96:99], v[140:143], v[52:55]
    v_mfma_f32_16x16x32_bf16 v[24:27], v[88:91], v[144:147], v[24:27]
    v_mfma_f32_16x16x32_bf16 v[40:43], v[92:95], v[144:147], v[40:43]
    v_mfma_f32_16x16x32_bf16 v[56:59], v[96:99], v[144:147], v[56:59]
    v_mfma_f32_16x16x32_bf16 v[28:31], v[88:91], v[148:151], v[28:31]
    v_mfma_f32_16x16x32_bf16 v[44:47], v[92:95], v[148:151], v[44:47]
    v_mfma_f32_16x16x32_bf16 v[60:63], v[96:99], v[148:151], v[60:63]
    ds_read_b128 v[136:139], v9 offset:16384
    ds_read_b128 v[140:143], v9 offset:34816
    ds_read_b128 v[144:147], v11 offset:16384
    ds_read_b128 v[148:151], v11 offset:34816
    s_waitcnt vmcnt(6) lgkmcnt(4)
    v_mfma_f32_16x16x32_bf16 v[16:19], v[100:103], v[152:155], v[16:19]
    v_mfma_f32_16x16x32_bf16 v[32:35], v[104:107], v[152:155], v[32:35]
    v_mfma_f32_16x16x32_bf16 v[48:51], v[108:111], v[152:155], v[48:51]
    v_mfma_f32_16x16x32_bf16 v[20:23], v[100:103], v[156:159], v[20:23]
    v_mfma_f32_16x16x32_bf16 v[36:39], v[104:107], v[156:159], v[36:39]
    v_mfma_f32_16x16x32_bf16 v[52:55], v[108:111], v[156:159], v[52:55]
    v_mfma_f32_16x16x32_bf16 v[24:27], v[100:103], v[160:163], v[24:27]
    v_mfma_f32_16x16x32_bf16 v[40:43], v[104:107], v[160:163], v[40:43]
    v_mfma_f32_16x16x32_bf16 v[56:59], v[108:111], v[160:163], v[56:59]
    v_mfma_f32_16x16x32_bf16 v[28:31], v[100:103], v[164:167], v[28:31]
    v_mfma_f32_16x16x32_bf16 v[44:47], v[104:107], v[164:167], v[44:47]
    v_mfma_f32_16x16x32_bf16 v[60:63], v[108:111], v[164:167], v[60:63]
    ds_read_b128 v[152:155], v9 offset:17408
    ds_read_b128 v[156:159], v9 offset:35840
    ds_read_b128 v[160:163], v11 offset:17408
    ds_read_b128 v[164:167], v11 offset:35840
    s_waitcnt vmcnt(3) lgkmcnt(4)
    v_mfma_f32_16x16x32_bf16 v[16:19], v[112:115], v[136:139], v[16:19]
    v_mfma_f32_16x16x32_bf16 v[32:35], v[116:119], v[136:139], v[32:35]
    v_mfma_f32_16x16x32_bf16 v[48:51], v[120:123], v[136:139], v[48:51]
    v_mfma_f32_16x16x32_bf16 v[20:23], v[112:115], v[140:143], v[20:23]
    v_mfma_f32_16x16x32_bf16 v[36:39], v[116:119], v[140:143], v[36:39]
    v_mfma_f32_16x16x32_bf16 v[52:55], v[120:123], v[140:143], v[52:55]
    v_mfma_f32_16x16x32_bf16 v[24:27], v[112:115], v[144:147], v[24:27]
    v_mfma_f32_16x16x32_bf16 v[40:43], v[116:119], v[144:147], v[40:43]
    v_mfma_f32_16x16x32_bf16 v[56:59], v[120:123], v[144:147], v[56:59]
    v_mfma_f32_16x16x32_bf16 v[28:31], v[112:115], v[148:151], v[28:31]
    v_mfma_f32_16x16x32_bf16 v[44:47], v[116:119], v[148:151], v[44:47]
    v_mfma_f32_16x16x32_bf16 v[60:63], v[120:123], v[148:151], v[60:63]
    s_waitcnt vmcnt(0) lgkmcnt(0)
    v_mfma_f32_16x16x32_bf16 v[16:19], v[124:127], v[152:155], v[16:19]
    v_mfma_f32_16x16x32_bf16 v[32:35], v[128:131], v[152:155], v[32:35]
    v_mfma_f32_16x16x32_bf16 v[48:51], v[132:135], v[152:155], v[48:51]
    v_mfma_f32_16x16x32_bf16 v[20:23], v[124:127], v[156:159], v[20:23]
    v_mfma_f32_16x16x32_bf16 v[36:39], v[128:131], v[156:159], v[36:39]
    v_mfma_f32_16x16x32_bf16 v[52:55], v[132:135], v[156:159], v[52:55]
    v_mfma_f32_16x16x32_bf16 v[24:27], v[124:127], v[160:163], v[24:27]
    v_mfma_f32_16x16x32_bf16 v[40:43], v[128:131], v[160:163], v[40:43]
    v_mfma_f32_16x16x32_bf16 v[56:59], v[132:135], v[160:163], v[56:59]
    v_mfma_f32_16x16x32_bf16 v[28:31], v[124:127], v[164:167], v[28:31]
    v_mfma_f32_16x16x32_bf16 v[44:47], v[128:131], v[164:167], v[44:47]
    v_mfma_f32_16x16x32_bf16 v[60:63], v[132:135], v[164:167], v[60:63]
    s_nop 7
    s_add_u32 s8, s4, 28221440
    s_addc_u32 s9, s5, 0
    s_and_b32 s9, s9, 0xffff
    s_mov_b32 s10, 18874368
    s_mov_b32 s11, 0x20000
    s_lshl_b32 s60, s20, 5
    s_add_u32 s60, s60, s21
    s_mul_i32 s60, s60, 12
    s_add_u32 s60, s60, s3
    s_mul_i32 s60, s60, 6144
    s_add_u32 s61, s60, 4096
    s_mul_i32 s62, s3, 6
    s_sub_u32 s62, s20, s62
    s_and_b32 s62, s62, 7
    s_cmp_lg_u32 s62, 0
    s_cbranch_scc1 L_nx_50
    v_mov_b32 v152, v16
    v_mov_b32 v153, v17
    v_mov_b32 v154, v18
    v_mov_b32 v155, v19
    v_mov_b32 v156, v20
    v_mov_b32 v157, v21
    v_mov_b32 v158, v22
    v_mov_b32 v159, v23
    s_branch L_cpy_49
L_nx_50:
    s_cmp_lg_u32 s62, 1
    s_cbranch_scc1 L_nx_51
    v_mov_b32 v152, v24
    v_mov_b32 v153, v25
    v_mov_b32 v154, v26
    v_mov_b32 v155, v27
    v_mov_b32 v156, v28
    v_mov_b32 v157, v29
    v_mov_b32 v158, v30
    v_mov_b32 v159, v31
    s_branch L_cpy_49
L_nx_51:
    s_cmp_lg_u32 s62, 2
    s_cbranch_scc1 L_nx_52
    v_mov_b32 v152, v32
    v_mov_b32 v153, v33
    v_mov_b32 v154, v34
    v_mov_b32 v155, v35
    v_mov_b32 v156, v36
    v_mov_b32 v157, v37
    v_mov_b32 v158, v38
    v_mov_b32 v159, v39
    s_branch L_cpy_49
L_nx_52:
    s_cmp_lg_u32 s62, 3
    s_cbranch_scc1 L_nx_53
    v_mov_b32 v152, v40
    v_mov_b32 v153, v41
    v_mov_b32 v154, v42
    v_mov_b32 v155, v43
    v_mov_b32 v156, v44
    v_mov_b32 v157, v45
    v_mov_b32 v158, v46
    v_mov_b32 v159, v47
    s_branch L_cpy_49
L_nx_53:
    s_cmp_lg_u32 s62, 4
    s_cbranch_scc1 L_nx_54
    v_mov_b32 v152, v48
    v_mov_b32 v153, v49
    v_mov_b32 v154, v50
    v_mov_b32 v155, v51
    v_mov_b32 v156, v52
    v_mov_b32 v157, v53
    v_mov_b32 v158, v54
    v_mov_b32 v159, v55
    s_branch L_cpy_49
L_nx_54:
    s_cmp_lg_u32 s62, 5
    s_cbranch_scc1 L_nx_55
    v_mov_b32 v152, v56
    v_mov_b32 v153, v57
    v_mov_b32 v154, v58
    v_mov_b32 v155, v59
    v_mov_b32 v156, v60
    v_mov_b32 v157, v61
    v_mov_b32 v158, v62
    v_mov_b32 v159, v63
    s_branch L_cpy_49
L_nx_55:
L_cpy_49:
    v_cvt_pk_bf16_f32 v136, v16, v17
    v_cvt_pk_bf16_f32 v137, v18, v19
    v_cvt_pk_bf16_f32 v138, v20, v21
    v_cvt_pk_bf16_f32 v139, v22, v23
    s_cmp_eq_u32 s62, 0
    s_cselect_b32 s63, 0x7ff00000, s60
    buffer_store_dwordx4 v[136:139], v3, s[8:11], s63 offen offset:0 sc1
    s_nop 1
    v_cvt_pk_bf16_f32 v140, v24, v25
    v_cvt_pk_bf16_f32 v141, v26, v27
    v_cvt_pk_bf16_f32 v142, v28, v29
    v_cvt_pk_bf16_f32 v143, v30, v31
    s_cmp_eq_u32 s62, 1
    s_cselect_b32 s63, 0x7ff00000, s60
    buffer_store_dwordx4 v[140:143], v3, s[8:11], s63 offen offset:1024 sc1
    s_nop 1
    v_cvt_pk_bf16_f32 v136, v32, v33
    v_cvt_pk_bf16_f32 v137, v34, v35
    v_cvt_pk_bf16_f32 v138, v36, v37
    v_cvt_pk_bf16_f32 v139, v38, v39
    s_cmp_eq_u32 s62, 2
    s_cselect_b32 s63, 0x7ff00000, s60
    buffer_store_dwordx4 v[136:139], v3, s[8:11], s63 offen offset:2048 sc1
    s_nop 1
    v_cvt_pk_bf16_f32 v140, v40, v41
    v_cvt_pk_bf16_f32 v141, v42, v43
    v_cvt_pk_bf16_f32 v142, v44, v45
    v_cvt_pk_bf16_f32 v143, v46, v47
    s_cmp_eq_u32 s62, 3
    s_cselect_b32 s63, 0x7ff00000, s60
    buffer_store_dwordx4 v[140:143], v3, s[8:11], s63 offen offset:3072 sc1
    s_nop 1
    v_cvt_pk_bf16_f32 v136, v48, v49
    v_cvt_pk_bf16_f32 v137, v50, v51
    v_cvt_pk_bf16_f32 v138, v52, v53
    v_cvt_pk_bf16_f32 v139, v54, v55
    s_cmp_eq_u32 s62, 4
    s_cselect_b32 s63, 0x7ff00000, s61
    buffer_store_dwordx4 v[136:139], v3, s[8:11], s63 offen offset:0 sc1
    s_nop 1
    v_cvt_pk_bf16_f32 v140, v56, v57
    v_cvt_pk_bf16_f32 v141, v58, v59
    v_cvt_pk_bf16_f32 v142, v60, v61
    v_cvt_pk_bf16_f32 v143, v62, v63
    s_cmp_eq_u32 s62, 5
    s_cselect_b32 s63, 0x7ff00000, s61
    buffer_store_dwordx4 v[140:143], v3, s[8:11], s63 offen offset:1024 sc1
    s_nop 1
    s_mov_b32 s24, s54
    s_and_b32 s25, s55, 0xffff
    s_mov_b32 s26, 2359296
    s_mov_b32 s27, 0x20000
    s_mul_i32 s22, s3, 6
    s_add_u32 s22, s22, s62
    s_waitcnt vmcnt(0)
    s_lshl_b32 s48, s21, 8
    s_add_u32 s48, s48, 8192
    s_barrier
    s_cmp_lg_u32 s3, 0
    s_cbranch_scc1 L_g2_wait_59
    s_mov_b64 s[50:51], exec
    s_mov_b64 exec, 1
    v_mov_b32 v12, 1
    v_mov_b32 v13, 0
    buffer_atomic_add v12, v13, s[44:47], s48 offen sc1
    s_mov_b64 exec, s[50:51]
    s_mov_b64 exec, 1
    s_mov_b32 s49, 0
L_g2_poll_57:
    buffer_load_dword v14, v13, s[44:47], s48 offen sc1
    s_waitcnt vmcnt(0)
    v_readfirstlane_b32 s52, v14
    s_add_u32 s49, s49, 1
    s_cmp_ge_u32 s52, 8
    s_cbranch_scc1 L_g2_done_58
    s_cmp_ge_u32 s49, 1048576
    s_cbranch_scc1 L_g2_done_58
    s_sleep 4
    s_branch L_g2_poll_57
L_g2_done_58:
    s_mov_b64 exec, s[50:51]
    s_branch L_g2_join_60
L_g2_wait_59:
L_g2_join_60:
    s_barrier
    s_cmp_ge_u32 s62, 6
    s_cbranch_scc1 L_skip_56
    s_and_b32 s23, s22, 1
    s_lshr_b32 s56, s22, 1
    s_lshl_b32 s57, s21, 2
    s_lshl_b32 s58, s23, 1
    s_add_u32 s57, s57, s58
    s_mul_i32 s60, s21, 72
    s_add_u32 s60, s60, s22
    s_lshl_b32 s60, s60, 10
    s_cmp_eq_u32 s20, 0
    s_cselect_b32 s63, 0x7ff00000, s60
    buffer_load_dwordx4 v[16:19], v3, s[8:11], s63 offen sc1
    s_add_u32 s60, s60, 2359296
    s_cmp_eq_u32 s20, 1
    s_cselect_b32 s63, 0x7ff00000, s60
    buffer_load_dwordx4 v[20:23], v3, s[8:11], s63 offen sc1
    s_add_u32 s60, s60, 2359296
    s_cmp_eq_u32 s20, 2
    s_cselect_b32 s63, 0x7ff00000, s60
    buffer_load_dwordx4 v[24:27], v3, s[8:11], s63 offen sc1
    s_add_u32 s60, s60, 2359296
    s_cmp_eq_u32 s20, 3
    s_cselect_b32 s63, 0x7ff00000, s60
    buffer_load_dwordx4 v[28:31], v3, s[8:11], s63 offen sc1
    s_add_u32 s60, s60, 2359296
    s_cmp_eq_u32 s20, 4
    s_cselect_b32 s63, 0x7ff00000, s60
    buffer_load_dwordx4 v[32:35], v3, s[8:11], s63 offen sc1
    s_add_u32 s60, s60, 2359296
    s_cmp_eq_u32 s20, 5
    s_cselect_b32 s63, 0x7ff00000, s60
    buffer_load_dwordx4 v[36:39], v3, s[8:11], s63 offen sc1
    s_add_u32 s60, s60, 2359296
    s_cmp_eq_u32 s20, 6
    s_cselect_b32 s63, 0x7ff00000, s60
    buffer_load_dwordx4 v[40:43], v3, s[8:11], s63 offen sc1
    s_add_u32 s60, s60, 2359296
    s_cmp_eq_u32 s20, 7
    s_cselect_b32 s63, 0x7ff00000, s60
    buffer_load_dwordx4 v[44:47], v3, s[8:11], s63 offen sc1
    v_lshrrev_b32 v6, 1, v5
    v_lshlrev_b32 v6, 8, v6
    v_lshl_add_u32 v6, v4, 4, v6
    v_and_b32 v7, 1, v5
    v_lshl_add_u32 v6, v7, 3, v6
    s_mul_i32 s60, s57, 18
    s_lshr_b32 s61, s56, 1
    s_add_u32 s60, s60, s61
    s_lshl_b32 s60, s60, 10
    s_and_b32 s61, s56, 1
    s_lshl_b32 s61, s61, 9
    s_add_u32 s60, s60, s61
    buffer_load_dwordx2 v[48:49], v6, s[36:39], s60 offen sc1
    s_add_u32 s60, s60, 18432
    buffer_load_dwordx2 v[50:51], v6, s[36:39], s60 offen sc1
    v_lshlrev_b32 v7, 4, v5
    s_lshl_b32 s60, s56, 6
    s_add_u32 s60, s60, 11520
    buffer_load_dwordx4 v[52:55], v7, s[32:35], s60 offen
    v_mul_u32_u24 v8, 1152, v4
    v_lshl_add_u32 v8, v5, 3, v8
    s_mul_i32 s60, s57, 18432
    s_lshl_b32 s61, s56, 5
    s_add_u32 s60, s60, s61
    v_mov_b32 v60, v152
    v_mov_b32 v61, v153
    v_mov_b32 v62, v154
    v_mov_b32 v63, v155
    v_mov_b32 v64, v156
    v_mov_b32 v65, v157
    v_mov_b32 v66, v158
    v_mov_b32 v67, v159
    s_waitcnt vmcnt(10)
    v_lshlrev_b32 v56, 16, v16
    v_and_b32 v57, 0xffff0000, v16
    v_add_f32 v60, v60, v56
    v_add_f32 v61, v61, v57
    v_lshlrev_b32 v56, 16, v17
    v_and_b32 v57, 0xffff0000, v17
    v_add_f32 v62, v62, v56
    v_add_f32 v63, v63, v57
    v_lshlrev_b32 v56, 16, v18
    v_and_b32 v57, 0xffff0000, v18
    v_add_f32 v64, v64, v56
    v_add_f32 v65, v65, v57
    v_lshlrev_b32 v56, 16, v19
    v_and_b32 v57, 0xffff0000, v19
    v_add_f32 v66, v66, v56
    v_add_f32 v67, v67, v57
    s_waitcnt vmcnt(9)
    v_lshlrev_b32 v56, 16, v20
    v_and_b32 v57, 0xffff0000, v20
    v_add_f32 v60, v60, v56
    v_add_f32 v61, v61, v57
    v_lshlrev_b32 v56, 16, v21
    v_and_b32 v57, 0xffff0000, v21
    v_add_f32 v62, v62, v56
    v_add_f32 v63, v63, v57
    v_lshlrev_b32 v56, 16, v22
    v_and_b32 v57, 0xffff0000, v22
    v_add_f32 v64, v64, v56
    v_add_f32 v65, v65, v57
    v_lshlrev_b32 v56, 16, v23
    v_and_b32 v57, 0xffff0000, v23
    v_add_f32 v66, v66, v56
    v_add_f32 v67, v67, v57
    s_waitcnt vmcnt(8)
    v_lshlrev_b32 v56, 16, v24
    v_and_b32 v57, 0xffff0000, v24
    v_add_f32 v60, v60, v56
    v_add_f32 v61, v61, v57
    v_lshlrev_b32 v56, 16, v25
    v_and_b32 v57, 0xffff0000, v25
    v_add_f32 v62, v62, v56
    v_add_f32 v63, v63, v57
    v_lshlrev_b32 v56, 16, v26
    v_and_b32 v57, 0xffff0000, v26
    v_add_f32 v64, v64, v56
    v_add_f32 v65, v65, v57
    v_lshlrev_b32 v56, 16, v27
    v_and_b32 v57, 0xffff0000, v27
    v_add_f32 v66, v66, v56
    v_add_f32 v67, v67, v57
    s_waitcnt vmcnt(7)
    v_lshlrev_b32 v56, 16, v28
    v_and_b32 v57, 0xffff0000, v28
    v_add_f32 v60, v60, v56
    v_add_f32 v61, v61, v57
    v_lshlrev_b32 v56, 16, v29
    v_and_b32 v57, 0xffff0000, v29
    v_add_f32 v62, v62, v56
    v_add_f32 v63, v63, v57
    v_lshlrev_b32 v56, 16, v30
    v_and_b32 v57, 0xffff0000, v30
    v_add_f32 v64, v64, v56
    v_add_f32 v65, v65, v57
    v_lshlrev_b32 v56, 16, v31
    v_and_b32 v57, 0xffff0000, v31
    v_add_f32 v66, v66, v56
    v_add_f32 v67, v67, v57
    s_waitcnt vmcnt(6)
    v_lshlrev_b32 v56, 16, v32
    v_and_b32 v57, 0xffff0000, v32
    v_add_f32 v60, v60, v56
    v_add_f32 v61, v61, v57
    v_lshlrev_b32 v56, 16, v33
    v_and_b32 v57, 0xffff0000, v33
    v_add_f32 v62, v62, v56
    v_add_f32 v63, v63, v57
    v_lshlrev_b32 v56, 16, v34
    v_and_b32 v57, 0xffff0000, v34
    v_add_f32 v64, v64, v56
    v_add_f32 v65, v65, v57
    v_lshlrev_b32 v56, 16, v35
    v_and_b32 v57, 0xffff0000, v35
    v_add_f32 v66, v66, v56
    v_add_f32 v67, v67, v57
    s_waitcnt vmcnt(5)
    v_lshlrev_b32 v56, 16, v36
    v_and_b32 v57, 0xffff0000, v36
    v_add_f32 v60, v60, v56
    v_add_f32 v61, v61, v57
    v_lshlrev_b32 v56, 16, v37
    v_and_b32 v57, 0xffff0000, v37
    v_add_f32 v62, v62, v56
    v_add_f32 v63, v63, v57
    v_lshlrev_b32 v56, 16, v38
    v_and_b32 v57, 0xffff0000, v38
    v_add_f32 v64, v64, v56
    v_add_f32 v65, v65, v57
    v_lshlrev_b32 v56, 16, v39
    v_and_b32 v57, 0xffff0000, v39
    v_add_f32 v66, v66, v56
    v_add_f32 v67, v67, v57
    s_waitcnt vmcnt(4)
    v_lshlrev_b32 v56, 16, v40
    v_and_b32 v57, 0xffff0000, v40
    v_add_f32 v60, v60, v56
    v_add_f32 v61, v61, v57
    v_lshlrev_b32 v56, 16, v41
    v_and_b32 v57, 0xffff0000, v41
    v_add_f32 v62, v62, v56
    v_add_f32 v63, v63, v57
    v_lshlrev_b32 v56, 16, v42
    v_and_b32 v57, 0xffff0000, v42
    v_add_f32 v64, v64, v56
    v_add_f32 v65, v65, v57
    v_lshlrev_b32 v56, 16, v43
    v_and_b32 v57, 0xffff0000, v43
    v_add_f32 v66, v66, v56
    v_add_f32 v67, v67, v57
    s_waitcnt vmcnt(3)
    v_lshlrev_b32 v56, 16, v44
    v_and_b32 v57, 0xffff0000, v44
    v_add_f32 v60, v60, v56
    v_add_f32 v61, v61, v57
    v_lshlrev_b32 v56, 16, v45
    v_and_b32 v57, 0xffff0000, v45
    v_add_f32 v62, v62, v56
    v_add_f32 v63, v63, v57
    v_lshlrev_b32 v56, 16, v46
    v_and_b32 v57, 0xffff0000, v46
    v_add_f32 v64, v64, v56
    v_add_f32 v65, v65, v57
    v_lshlrev_b32 v56, 16, v47
    v_and_b32 v57, 0xffff0000, v47
    v_add_f32 v66, v66, v56
    v_add_f32 v67, v67, v57
    s_waitcnt vmcnt(0)
    v_lshlrev_b32 v68, 16, v48
    v_and_b32 v69, 0xffff0000, v48
    v_lshlrev_b32 v70, 16, v49
    v_and_b32 v71, 0xffff0000, v49
    v_fmac_f32 v68, v60, v52
    v_fmac_f32 v69, v61, v53
    v_fmac_f32 v70, v62, v54
    v_fmac_f32 v71, v63, v55
    v_cvt_pk_bf16_f32 v72, v68, v69
    v_cvt_pk_bf16_f32 v73, v70, v71
    buffer_store_dwordx2 v[72:73], v8, s[24:27], s60 offen
    s_add_u32 s60, s60, 18432
    v_lshlrev_b32 v68, 16, v50
    v_and_b32 v69, 0xffff0000, v50
    v_lshlrev_b32 v70, 16, v51
    v_and_b32 v71, 0xffff0000, v51
    v_fmac_f32 v68, v64, v52
    v_fmac_f32 v69, v65, v53
    v_fmac_f32 v70, v66, v54
    v_fmac_f32 v71, v67, v55
    v_cvt_pk_bf16_f32 v74, v68, v69
    v_cvt_pk_bf16_f32 v75, v70, v71
    buffer_store_dwordx2 v[74:75], v8, s[24:27], s60 offen
L_skip_56:
L_end_42:
    s_endpgm
.section .rodata,"a"
.p2align 6
.amdhsa_kernel k45_kernel
.amdhsa_next_free_vgpr 168
.amdhsa_next_free_sgpr 102
.amdhsa_accum_offset 168
.amdhsa_group_segment_fixed_size 0
.amdhsa_kernarg_size 88
.amdhsa_user_sgpr_count 2
.amdhsa_user_sgpr_kernarg_segment_ptr 1
.amdhsa_system_sgpr_workgroup_id_x 1
.end_amdhsa_kernel
```
